```python
import torch

def _softmax(x, axis=-1):
    return torch.softmax(x, dim=axis)
def _gelu(x):
    return torch.nn.functional.gelu(x, approximate="tanh")
def _silu(x):
    return torch.nn.functional.silu(x)
def _sigmoid(x):
    return torch.sigmoid(x)
def _layernorm(x, axis=-1, eps=1e-5):
    m = x.mean(dim=axis, keepdim=True)
    v = x.var(dim=axis, keepdim=True, unbiased=False)
    return (x - m) / torch.sqrt(v + eps)
def _scatter_add(tgt, idx, src, axis=0):
    return tgt.clone().index_add_(axis, idx, src)
def _segment_sum(src, seg, n):
    out = torch.zeros((n,) + src.shape[1:], dtype=src.dtype)
    return out.index_add_(0, seg, src)
def _pad(x, pw):
    flat = tuple(v for pair in reversed(pw) for v in pair)
    return torch.nn.functional.pad(x, flat)

kernel_name = 'recurrent_scan__ssm_conv_s4__dense_activation_silu__prompt'

def setup_inputs():

    _w = (lambda a: (lambda t: t.to(torch.bfloat16) if t.is_floating_point() else t)(torch.as_tensor(a)))
    def _A_setup():
        B, L, D, N = 1, 2048, 576, 128
        A_re = -(lambda _x: torch.exp(torch.as_tensor(_x)))((lambda *s: torch.randn(*s, dtype=torch.bfloat16) * 3.2)(D, N))
        A_im = torch.pi * (lambda *s: torch.randn(*s, dtype=torch.bfloat16) * 0.2)(D, N)
        B_re = (lambda *s: torch.randn(*s, dtype=torch.bfloat16) * 0.2)(D, N)
        B_im = (lambda *s: torch.randn(*s, dtype=torch.bfloat16) * 0.2)(D, N)
        C_re = (lambda *s: torch.randn(*s, dtype=torch.bfloat16) * 0.2)(D, N)
        C_im = (lambda *s: torch.randn(*s, dtype=torch.bfloat16) * 0.2)(D, N)
        log_dt = (lambda *s: torch.randn(*s, dtype=torch.bfloat16) * 0.2)(D) * 0.5 - 4.0
        Dskip = (lambda *s: torch.randn(*s, dtype=torch.bfloat16) * 0.2)(D)
        return {
            "u": _w((lambda *s: torch.randn(*s, dtype=torch.bfloat16) * 0.05)(B, L, D)),
            "A_re": _w(A_re),
            "A_im": _w(A_im),
            "B_re": _w(B_re),
            "B_im": _w(B_im),
            "C_re": _w(C_re),
            "C_im": _w(C_im),
            "log_dt": _w(log_dt),
            "Dskip": _w(Dskip),
        }
    _A_in = _A_setup()

    def _B_setup():
        B, S, D, F = 1, 2048, 576, 4608
        return {
            "x": _w((lambda *s: torch.randn(*s, dtype=torch.bfloat16) * 0.05)(B, S, D)),
            "w1": _w((lambda *s: torch.randn(*s, dtype=torch.bfloat16) * 0.8)(D, F) * (D ** -0.5)),
            "w2": _w((lambda *s: torch.randn(*s, dtype=torch.bfloat16) * 0.1)(F, D) * (F ** -0.5)),
        }
    _B_in = _B_setup()

    return {
        "A_u": _A_in["u"],
        "A_A_re": _A_in["A_re"],
        "A_A_im": _A_in["A_im"],
        "A_B_re": _A_in["B_re"],
        "A_B_im": _A_in["B_im"],
        "A_C_re": _A_in["C_re"],
        "A_C_im": _A_in["C_im"],
        "A_log_dt": _A_in["log_dt"],
        "A_Dskip": _A_in["Dskip"],
        "B_x": _B_in["x"],
        "B_w1": _B_in["w1"],
        "B_w2": _B_in["w2"],
    }

def reference(A_u, A_A_re, A_A_im, A_B_re, A_B_im, A_C_re, A_C_im, A_log_dt, A_Dskip, B_x, B_w1, B_w2):
    def _A_ref(u, A_re, A_im, B_re, B_im, C_re, C_im, log_dt, Dskip):
        Bsz, L, D = u.shape
        dt = torch.exp(log_dt)[:, None]
        A = A_re + 1j * A_im
        Bc = B_re + 1j * B_im
        Cc = C_re + 1j * C_im
        logdA = dt * A
        dB = dt * Bc
        l = (lambda x, dt: x.to(dt))(torch.arange(L), A_re.dtype)
        P = torch.exp(logdA[:, :, None] * l[None, None, :])
        K = torch.einsum("dn,dnl,dn->dl", Cc, P, dB).real
        L2 = 2 * L
        Kp = _pad(K, ((0, 0), (0, L)))
        up = (lambda x, *d: x.permute(*d))(u, 0, 2, 1)
        up = _pad(up, ((0, 0), (0, 0), (0, L)))
        Kf = (lambda x, axes=(-2,-1): torch.fft.rfft2(x.float(), dim=axes))(Kp[:, None, :], axes=(-2, -1))
        Uf = (lambda x, axes=(-2,-1): torch.fft.rfft2(x.float(), dim=axes))(up[:, :, None, :], axes=(-2, -1))
        Yf = Uf * Kf[None, :, :, :]
        y = (lambda x, s, axes=(-2,-1): torch.fft.irfft2(x, s=s, dim=axes).to(torch.bfloat16))(Yf, (1, L2), axes=(-2, -1))[:, :, 0, :L]
        y = (lambda x, *d: x.permute(*d))(y, 0, 2, 1) + u * Dskip[None, None, :]
        return y

    def _B_ref(x, w1, w2):
        h = torch.einsum("bsd,df->bsf", x, w1)
        h = _silu(h)
        out = torch.einsum("bsf,fd->bsd", h, w2)
        return out

    x = A_u
    xn = _layernorm(x, axis=-1)
    s = _A_ref(xn, A_A_re, A_A_im, A_B_re, A_B_im, A_C_re, A_C_im, A_log_dt, A_Dskip)
    g = _silu(_B_ref(xn, B_w1, B_w2))
    return x + s * g
```

```asm
; @launch grid=(256,1,1) block=(512,1,1) lds=163840
.amdgcn_target "amdgcn-amd-amdhsa--gfx950"
.text
.globl recurrent_scan__ssm_conv_s4__dense_activation_silu__prompt_kernel
.p2align 8
.type recurrent_scan__ssm_conv_s4__dense_activation_silu__prompt_kernel,@function
recurrent_scan__ssm_conv_s4__dense_activation_silu__prompt_kernel:
s_cmp_ge_u32 s2, 256
s_cbranch_scc1 LB_end
s_load_dwordx2 s[20:21], s[0:1], 0
s_load_dwordx16 s[72:87], s[0:1], 8
s_load_dwordx4 s[4:7], s[0:1], 80
s_load_dwordx4 s[24:27], s[0:1], 96
s_load_dwordx2 s[16:17], s[0:1], 112
s_memrealtime s[70:71]
s_getpc_b64 s[94:95]
LLtop:
s_sub_u32 s94, s94, LLtop-recurrent_scan__ssm_conv_s4__dense_activation_silu__prompt_kernel
s_subb_u32 s95, s95, 0
s_lshr_b32 s33, s2, 3
s_lshl_b32 s33, s33, 4
v_lshrrev_b32 v248, 5, v0
v_add_u32 v248, s33, v248
v_lshlrev_b32 v248, 7, v248
v_min_u32 v248, code_end-recurrent_scan__ssm_conv_s4__dense_activation_silu__prompt_kernel-4, v248
s_mov_b32 exec_lo, 1
s_mov_b32 exec_hi, 1
global_load_dword v249, v248, s[94:95]
s_mov_b64 exec, -1
v_lshrrev_b32 v1, 6, v0
s_nop 0
v_readfirstlane_b32 s28, v1
v_and_b32 v2, 63, v0
s_and_b32 s30, s2, 7
s_lshr_b32 s32, s2, 3
s_and_b32 s31, s32, 3
s_lshr_b32 s32, s32, 2
s_and_b32 s29, s28, 3
s_mov_b32 s11, 0x20000
s_mov_b32 s15, 0x20000
s_mov_b32 s18, 51085312
s_mov_b32 s19, 0x20000
s_mov_b32 s22, 2359296
s_mov_b32 s23, 0x20000
v_lshlrev_b32 v3, 4, v2
s_lshl_b32 s37, s29, 10
s_lshl_b32 s36, s2, 3
s_add_u32 s36, s36, s28
s_lshl_b32 s3, s30, 8
s_andn2_b32 s33, s2, 7
s_add_u32 s3, s3, s33
s_add_u32 s3, s3, s28
s_cmp_ge_u32 s28, 4
s_cbranch_scc1 LB_B
s_setprio 2
s_lshl_b32 s33, s2, 3
v_and_b32 v20, 7, v2
v_add_u32 v21, s33, v20
v_mul_u32_u24 v21, 1152, v21
v_lshrrev_b32 v22, 3, v2
v_lshl_add_u32 v21, v22, 4, v21
s_lshl_b32 s38, s29, 7
s_waitcnt lgkmcnt(0)
buffer_load_dwordx4 v[32:35], v21, s[20:23], s38 offen
buffer_load_dwordx4 v[36:39], v21, s[20:23], s38 offen offset:512
s_mov_b32 s38, 1024
s_cmp_eq_u32 s29, 0
s_cselect_b32 s38, s38, 0x1000000
buffer_load_dwordx4 v[40:43], v21, s[20:23], s38 offen
s_mul_i32 s33, s30, 1152
s_mul_i32 s38, s31, 288
s_add_u32 s33, s33, s38
s_add_u32 s8, s4, s33
s_addc_u32 s9, s5, 0
s_sub_u32 s10, 5308416, s33
s_mul_i32 s33, s30, 663552
s_add_u32 s33, s33, s38
s_add_u32 s12, s6, s33
s_addc_u32 s13, s7, 0
s_sub_u32 s14, 5308416, s33
s_mov_b32 s92, s26
s_mov_b32 s93, s27
s_mov_b32 s26, 2359296
s_mov_b32 s27, 0x20000
v_mov_b32 v26, 163328
v_mov_b32 v25, 0
ds_write_b32 v26, v25
v_lshlrev_b32 v28, 2, v2
v_add_u32 v28, 163584, v28
ds_write_b32 v28, v25
global_load_dword v27, v25, s[92:93] sc0 sc1
s_getpc_b64 s[60:61]
LLpc_1:
s_add_u32 s60, s60, idx_table-LLpc_1
s_addc_u32 s61, s61, 0
s_lshl_b32 s33, s29, 11
v_lshl_add_u32 v136, v2, 5, s33
global_load_dwordx4 v[140:143], v136, s[60:61]
global_load_dwordx2 v[144:145], v136, s[60:61] offset:16
s_mov_b32 s38, 0x3f803f80
s_waitcnt vmcnt(3)
v_dot2_f32_bf16 v44, v32, s38, 0
v_dot2_f32_bf16 v45, v32, v32, 0
v_dot2_f32_bf16 v44, v33, s38, v44
v_dot2_f32_bf16 v45, v33, v33, v45
v_dot2_f32_bf16 v44, v34, s38, v44
v_dot2_f32_bf16 v45, v34, v34, v45
v_dot2_f32_bf16 v44, v35, s38, v44
v_dot2_f32_bf16 v45, v35, v35, v45
v_dot2_f32_bf16 v44, v36, s38, v44
v_dot2_f32_bf16 v45, v36, v36, v45
v_dot2_f32_bf16 v44, v37, s38, v44
v_dot2_f32_bf16 v45, v37, v37, v45
v_dot2_f32_bf16 v44, v38, s38, v44
v_dot2_f32_bf16 v45, v38, v38, v45
v_dot2_f32_bf16 v44, v39, s38, v44
v_dot2_f32_bf16 v45, v39, v39, v45
v_dot2_f32_bf16 v44, v40, s38, v44
v_dot2_f32_bf16 v45, v40, v40, v45
v_dot2_f32_bf16 v44, v41, s38, v44
v_dot2_f32_bf16 v45, v41, v41, v45
v_dot2_f32_bf16 v44, v42, s38, v44
v_dot2_f32_bf16 v45, v42, v42, v45
v_dot2_f32_bf16 v44, v43, s38, v44
v_dot2_f32_bf16 v45, v43, v43, v45
s_nop 1
v_add_f32_dpp v44, v44, v44 row_ror:8 row_mask:0xf bank_mask:0xf
v_mov_b32 v46, v44
s_nop 1
v_permlane16_swap_b32 v46, v44
v_add_f32 v44, v44, v46
v_mov_b32 v46, v44
s_nop 1
v_permlane32_swap_b32 v46, v44
v_add_f32 v44, v44, v46
v_add_f32_dpp v45, v45, v45 row_ror:8 row_mask:0xf bank_mask:0xf
v_mov_b32 v46, v45
s_nop 1
v_permlane16_swap_b32 v46, v45
v_add_f32 v45, v45, v46
v_mov_b32 v46, v45
s_nop 1
v_permlane32_swap_b32 v46, v45
v_add_f32 v45, v45, v46
v_lshlrev_b32 v46, 5, v20
s_lshl_b32 s33, s29, 3
s_add_u32 s33, s33, 162816
v_add_u32 v46, s33, v46
ds_write_b64 v46, v[44:45]
s_waitcnt lgkmcnt(0)
s_barrier
global_load_dword v27, v25, s[92:93] sc0 sc1
v_lshlrev_b32 v46, 5, v20
v_add_u32 v46, 162816, v46
ds_read_b128 v[48:51], v46
ds_read_b128 v[52:55], v46 offset:16
s_waitcnt lgkmcnt(0)
v_pk_add_f32 v[48:49], v[48:49], v[50:51]
v_pk_add_f32 v[52:53], v[52:53], v[54:55]
v_pk_add_f32 v[44:45], v[48:49], v[52:53]
s_mov_b32 s38, 0x3ae38e39
v_mul_f32 v44, s38, v44
v_mul_f32 v45, s38, v45
v_fma_f32 v45, -v44, v44, v45
v_max_f32 v45, 0, v45
v_cvt_pk_bf16_f32 v46, v44, v45
v_lshlrev_b32 v56, 16, v46
v_and_b32 v45, 0xffff0000, v46
v_add_f32 v45, 0x3727c5ac, v45
v_cvt_pk_bf16_f32 v45, v45, v45
v_lshlrev_b32 v45, 16, v45
v_sqrt_f32 v45, v45
s_nop 0
v_cvt_pk_bf16_f32 v45, v45, v45
v_lshlrev_b32 v45, 16, v45
v_rcp_f32 v58, v45
s_nop 0
v_mul_f32 v60, 0x3fb8aa3b, v58
s_lshr_b32 s33, s2, 1
s_mul_i32 s33, s33, 18432
s_and_b32 s38, s2, 1
s_lshl_b32 s38, s38, 7
s_add_u32 s33, s33, s38
s_lshl_b32 s38, s29, 11
s_add_u32 s60, s33, s38
v_lshlrev_b32 v80, 8, v22
v_lshl_add_u32 v80, v20, 4, v80
v_mul_u32_u24 v81, 144, v20
v_lshl_add_u32 v81, v22, 4, v81
s_mul_i32 s33, s29, 1152
s_add_u32 s33, s33, 138240
v_add_u32 v81, s33, v81
v_bfe_u32 v82, v2, 2, 2
v_mul_u32_u24 v82, 144, v82
v_lshrrev_b32 v46, 4, v2
v_lshl_add_u32 v82, v46, 5, v82
v_and_b32 v46, 3, v2
v_lshl_add_u32 v82, v46, 3, v82
v_add_u32 v82, s33, v82
s_mul_i32 s61, s2, 9216
s_add_u32 s61, s61, 2621440
s_add_u32 s61, s61, s37
v_lshlrev_b32 v62, 16, v32
v_and_b32 v63, 0xffff0000, v32
v_pk_add_f32 v[62:63], v[62:63], v[56:57] op_sel_hi:[1,0] neg_lo:[0,1] neg_hi:[0,1]
v_cvt_pk_bf16_f32 v32, v62, v63
v_lshlrev_b32 v62, 16, v32
v_and_b32 v63, 0xffff0000, v32
v_pk_mul_f32 v[62:63], v[62:63], v[60:61] op_sel_hi:[1,0]
v_cvt_pk_bf16_f32 v68, v62, v63
v_lshlrev_b32 v64, 16, v33
v_and_b32 v65, 0xffff0000, v33
v_pk_add_f32 v[64:65], v[64:65], v[56:57] op_sel_hi:[1,0] neg_lo:[0,1] neg_hi:[0,1]
v_cvt_pk_bf16_f32 v33, v64, v65
v_lshlrev_b32 v64, 16, v33
v_and_b32 v65, 0xffff0000, v33
v_pk_mul_f32 v[64:65], v[64:65], v[60:61] op_sel_hi:[1,0]
v_cvt_pk_bf16_f32 v69, v64, v65
v_lshlrev_b32 v62, 16, v34
v_and_b32 v63, 0xffff0000, v34
v_pk_add_f32 v[62:63], v[62:63], v[56:57] op_sel_hi:[1,0] neg_lo:[0,1] neg_hi:[0,1]
v_cvt_pk_bf16_f32 v34, v62, v63
v_lshlrev_b32 v62, 16, v34
v_and_b32 v63, 0xffff0000, v34
v_pk_mul_f32 v[62:63], v[62:63], v[60:61] op_sel_hi:[1,0]
v_cvt_pk_bf16_f32 v70, v62, v63
v_lshlrev_b32 v64, 16, v35
v_and_b32 v65, 0xffff0000, v35
v_pk_add_f32 v[64:65], v[64:65], v[56:57] op_sel_hi:[1,0] neg_lo:[0,1] neg_hi:[0,1]
v_cvt_pk_bf16_f32 v35, v64, v65
v_lshlrev_b32 v64, 16, v35
v_and_b32 v65, 0xffff0000, v35
v_pk_mul_f32 v[64:65], v[64:65], v[60:61] op_sel_hi:[1,0]
v_cvt_pk_bf16_f32 v71, v64, v65
s_add_u32 s33, s60, 0
buffer_store_dwordx4 v[68:71], v80, s[16:19], s33 offen sc1
v_lshlrev_b32 v62, 16, v36
v_and_b32 v63, 0xffff0000, v36
v_pk_add_f32 v[62:63], v[62:63], v[56:57] op_sel_hi:[1,0] neg_lo:[0,1] neg_hi:[0,1]
v_cvt_pk_bf16_f32 v36, v62, v63
v_lshlrev_b32 v62, 16, v36
v_and_b32 v63, 0xffff0000, v36
v_pk_mul_f32 v[62:63], v[62:63], v[60:61] op_sel_hi:[1,0]
v_cvt_pk_bf16_f32 v72, v62, v63
v_lshlrev_b32 v64, 16, v37
v_and_b32 v65, 0xffff0000, v37
v_pk_add_f32 v[64:65], v[64:65], v[56:57] op_sel_hi:[1,0] neg_lo:[0,1] neg_hi:[0,1]
v_cvt_pk_bf16_f32 v37, v64, v65
v_lshlrev_b32 v64, 16, v37
v_and_b32 v65, 0xffff0000, v37
v_pk_mul_f32 v[64:65], v[64:65], v[60:61] op_sel_hi:[1,0]
v_cvt_pk_bf16_f32 v73, v64, v65
v_lshlrev_b32 v62, 16, v38
v_and_b32 v63, 0xffff0000, v38
v_pk_add_f32 v[62:63], v[62:63], v[56:57] op_sel_hi:[1,0] neg_lo:[0,1] neg_hi:[0,1]
v_cvt_pk_bf16_f32 v38, v62, v63
v_lshlrev_b32 v62, 16, v38
v_and_b32 v63, 0xffff0000, v38
v_pk_mul_f32 v[62:63], v[62:63], v[60:61] op_sel_hi:[1,0]
v_cvt_pk_bf16_f32 v74, v62, v63
v_lshlrev_b32 v64, 16, v39
v_and_b32 v65, 0xffff0000, v39
v_pk_add_f32 v[64:65], v[64:65], v[56:57] op_sel_hi:[1,0] neg_lo:[0,1] neg_hi:[0,1]
v_cvt_pk_bf16_f32 v39, v64, v65
v_lshlrev_b32 v64, 16, v39
v_and_b32 v65, 0xffff0000, v39
v_pk_mul_f32 v[64:65], v[64:65], v[60:61] op_sel_hi:[1,0]
v_cvt_pk_bf16_f32 v75, v64, v65
s_add_u32 s33, s60, 8192
buffer_store_dwordx4 v[72:75], v80, s[16:19], s33 offen sc1
s_cmp_lg_u32 s29, 0
s_cbranch_scc1 Ln_2
v_lshlrev_b32 v62, 16, v40
v_and_b32 v63, 0xffff0000, v40
v_pk_add_f32 v[62:63], v[62:63], v[56:57] op_sel_hi:[1,0] neg_lo:[0,1] neg_hi:[0,1]
v_cvt_pk_bf16_f32 v40, v62, v63
v_lshlrev_b32 v62, 16, v40
v_and_b32 v63, 0xffff0000, v40
v_pk_mul_f32 v[62:63], v[62:63], v[60:61] op_sel_hi:[1,0]
v_cvt_pk_bf16_f32 v76, v62, v63
v_lshlrev_b32 v64, 16, v41
v_and_b32 v65, 0xffff0000, v41
v_pk_add_f32 v[64:65], v[64:65], v[56:57] op_sel_hi:[1,0] neg_lo:[0,1] neg_hi:[0,1]
v_cvt_pk_bf16_f32 v41, v64, v65
v_lshlrev_b32 v64, 16, v41
v_and_b32 v65, 0xffff0000, v41
v_pk_mul_f32 v[64:65], v[64:65], v[60:61] op_sel_hi:[1,0]
v_cvt_pk_bf16_f32 v77, v64, v65
v_lshlrev_b32 v62, 16, v42
v_and_b32 v63, 0xffff0000, v42
v_pk_add_f32 v[62:63], v[62:63], v[56:57] op_sel_hi:[1,0] neg_lo:[0,1] neg_hi:[0,1]
v_cvt_pk_bf16_f32 v42, v62, v63
v_lshlrev_b32 v62, 16, v42
v_and_b32 v63, 0xffff0000, v42
v_pk_mul_f32 v[62:63], v[62:63], v[60:61] op_sel_hi:[1,0]
v_cvt_pk_bf16_f32 v78, v62, v63
v_lshlrev_b32 v64, 16, v43
v_and_b32 v65, 0xffff0000, v43
v_pk_add_f32 v[64:65], v[64:65], v[56:57] op_sel_hi:[1,0] neg_lo:[0,1] neg_hi:[0,1]
v_cvt_pk_bf16_f32 v43, v64, v65
v_lshlrev_b32 v64, 16, v43
v_and_b32 v65, 0xffff0000, v43
v_pk_mul_f32 v[64:65], v[64:65], v[60:61] op_sel_hi:[1,0]
v_cvt_pk_bf16_f32 v79, v64, v65
s_add_u32 s33, s60, 16384
buffer_store_dwordx4 v[76:79], v80, s[16:19], s33 offen sc1
Ln_2:
s_lshl_b32 s33, s29, 6
s_add_u32 s33, s33, 0
v_add_u32 v20, s33, v2
s_mov_b32 s33, 0xe38e38f
v_mul_hi_u32 v21, v20, s33
v_mul_u32_u24 v22, 18, v21
v_sub_u32 v22, v20, v22
v_lshlrev_b32 v22, 4, v22
v_mul_u32_u24 v23, 1152, v21
v_add_u32 v14, v23, v22
v_and_b32 v23, 3, v21
v_bfe_u32 v24, v21, 2, 2
v_lshl_add_u32 v23, v24, 3, v23
v_lshrrev_b32 v24, 4, v21
v_lshl_add_u32 v23, v24, 2, v23
v_mul_u32_u24 v23, 9216, v23
v_add_u32 v11, v23, v22
s_lshl_b32 s33, s29, 6
s_add_u32 s33, s33, 256
v_add_u32 v20, s33, v2
s_mov_b32 s33, 0xe38e38f
v_mul_hi_u32 v21, v20, s33
v_mul_u32_u24 v22, 18, v21
v_sub_u32 v22, v20, v22
v_lshlrev_b32 v22, 4, v22
v_mul_u32_u24 v23, 1152, v21
v_add_u32 v15, v23, v22
v_and_b32 v23, 3, v21
v_bfe_u32 v24, v21, 2, 2
v_lshl_add_u32 v23, v24, 3, v23
v_lshrrev_b32 v24, 4, v21
v_lshl_add_u32 v23, v24, 2, v23
v_mul_u32_u24 v23, 9216, v23
v_add_u32 v12, v23, v22
s_mov_b32 s33, 512
v_add_u32 v20, s33, v2
s_mov_b32 s33, 0xe38e38f
v_mul_hi_u32 v21, v20, s33
v_mul_u32_u24 v22, 18, v21
v_sub_u32 v22, v20, v22
v_lshlrev_b32 v22, 4, v22
v_mul_u32_u24 v23, 1152, v21
v_add_u32 v16, v23, v22
v_and_b32 v23, 3, v21
v_bfe_u32 v24, v21, 2, 2
v_lshl_add_u32 v23, v24, 3, v23
v_lshrrev_b32 v24, 4, v21
v_lshl_add_u32 v23, v24, 2, v23
v_mul_u32_u24 v23, 9216, v23
v_add_u32 v13, v23, v22
s_lshl_b32 s38, s2, 2
s_add_u32 s59, s38, s29
s_waitcnt vmcnt(0)
s_mov_b32 s58, 0x8000
LLn_3:
v_readfirstlane_b32 s68, v27
s_nop 1
s_cmp_lg_u32 s68, 0
s_cbranch_scc1 LBo_4
global_load_dword v27, v25, s[92:93] sc0 sc1
s_sub_u32 s58, s58, 1
s_waitcnt vmcnt(0)
s_cmp_gt_i32 s58, 0
s_cbranch_scc1 LLn_3
LBo_4:
s_lshl_b32 s33, s59, 2
s_add_u32 s33, s33, 50921472
v_mov_b32 v30, 0
v_mov_b32 v31, s68
s_mov_b64 exec, 1
buffer_store_dword v31, v30, s[16:19], s33 offen sc1
s_mov_b64 exec, -1
ds_write_b32 v26, v27
s_setprio 0
s_mov_b32 s39, 0
s_add_u32 m0, s37, 0
s_nop 0
buffer_load_dwordx4 v11, s[8:11], s39 offen lds
s_add_u32 m0, s37, 4096
s_nop 0
buffer_load_dwordx4 v12, s[8:11], s39 offen lds
s_mov_b32 m0, 8192
s_cmp_lg_u32 s29, 0
s_cbranch_scc1 Ld_5
buffer_load_dwordx4 v13, s[8:11], s39 offen lds
Ld_5:
s_mov_b32 s39, 294912
s_add_u32 m0, s37, 9216
s_nop 0
buffer_load_dwordx4 v11, s[8:11], s39 offen lds
s_add_u32 m0, s37, 13312
s_nop 0
buffer_load_dwordx4 v12, s[8:11], s39 offen lds
s_mov_b32 m0, 17408
s_cmp_lg_u32 s29, 1
s_cbranch_scc1 Ld_6
buffer_load_dwordx4 v13, s[8:11], s39 offen lds
Ld_6:
s_mov_b32 s39, 589824
s_add_u32 m0, s37, 18432
s_nop 0
buffer_load_dwordx4 v11, s[8:11], s39 offen lds
s_add_u32 m0, s37, 22528
s_nop 0
buffer_load_dwordx4 v12, s[8:11], s39 offen lds
s_mov_b32 m0, 26624
s_cmp_lg_u32 s29, 2
s_cbranch_scc1 Ld_7
buffer_load_dwordx4 v13, s[8:11], s39 offen lds
Ld_7:
s_mov_b32 s39, 884736
s_add_u32 m0, s37, 27648
s_nop 0
buffer_load_dwordx4 v11, s[8:11], s39 offen lds
s_add_u32 m0, s37, 31744
s_nop 0
buffer_load_dwordx4 v12, s[8:11], s39 offen lds
s_mov_b32 m0, 35840
s_cmp_lg_u32 s29, 3
s_cbranch_scc1 Ld_8
buffer_load_dwordx4 v13, s[8:11], s39 offen lds
Ld_8:
s_mov_b32 s39, 1179648
s_add_u32 m0, s37, 36864
s_nop 0
buffer_load_dwordx4 v11, s[8:11], s39 offen lds
s_add_u32 m0, s37, 40960
s_nop 0
buffer_load_dwordx4 v12, s[8:11], s39 offen lds
s_mov_b32 m0, 45056
s_cmp_lg_u32 s29, 0
s_cbranch_scc1 Ld_9
buffer_load_dwordx4 v13, s[8:11], s39 offen lds
Ld_9:
s_mov_b32 s39, 1474560
s_add_u32 m0, s37, 46080
s_nop 0
buffer_load_dwordx4 v11, s[8:11], s39 offen lds
s_add_u32 m0, s37, 50176
s_nop 0
buffer_load_dwordx4 v12, s[8:11], s39 offen lds
s_mov_b32 m0, 54272
s_cmp_lg_u32 s29, 1
s_cbranch_scc1 Ld_10
buffer_load_dwordx4 v13, s[8:11], s39 offen lds
Ld_10:
s_mov_b32 s39, 1769472
s_add_u32 m0, s37, 55296
s_nop 0
buffer_load_dwordx4 v11, s[8:11], s39 offen lds
s_add_u32 m0, s37, 59392
s_nop 0
buffer_load_dwordx4 v12, s[8:11], s39 offen lds
s_mov_b32 m0, 63488
s_cmp_lg_u32 s29, 2
s_cbranch_scc1 Ld_11
buffer_load_dwordx4 v13, s[8:11], s39 offen lds
Ld_11:
s_lshl_b32 s33, s32, 7
s_lshl_b32 s38, s28, 4
s_add_u32 s33, s33, s38
s_add_u32 s33, s33, 12730368
v_add_lshl_u32 v22, s33, v2, 2
s_mov_b64 exec, 0xffff
buffer_load_dword v23, v22, s[16:19], 0 offen sc1
s_mov_b64 exec, -1
v_add_u32 v4, 4096, v3
v_add_u32 v5, 8192, v3
v_add_u32 v6, 12288, v3
v_add_u32 v7, 16384, v3
s_lshl_b32 s33, s32, 4
s_lshl_b32 s34, s28, 1
s_add_u32 s33, s33, s34
s_mul_i32 s34, s33, 18432
s_add_u32 s35, s34, 18432
v_lshrrev_b32 v20, 2, v2
v_mul_u32_u24 v20, 288, v20
v_and_b32 v21, 3, v2
v_lshl_add_u32 v8, v21, 3, v20
v_add_u32 v9, 55296, v8
v_add_u32 v10, 110592, v8
s_add_u32 s40, s31, 0
s_and_b32 s40, s40, 3
s_sub_u32 s33, s40, s31
s_lshl_b32 s33, s33, 3
s_add_u32 s33, s33, s3
s_mul_i32 s44, s33, 9216
s_add_u32 s44, s44, 9437184
s_mul_i32 s33, s30, 4352
s_add_u32 s44, s44, s33
s_mul_i32 s48, s40, 165888
s_add_u32 s41, s31, 1
s_and_b32 s41, s41, 3
s_sub_u32 s33, s41, s31
s_lshl_b32 s33, s33, 3
s_add_u32 s33, s33, s3
s_mul_i32 s45, s33, 9216
s_add_u32 s45, s45, 9437184
s_mul_i32 s33, s30, 4352
s_add_u32 s45, s45, s33
s_mul_i32 s49, s41, 165888
s_add_u32 s42, s31, 2
s_and_b32 s42, s42, 3
s_sub_u32 s33, s42, s31
s_lshl_b32 s33, s33, 3
s_add_u32 s33, s33, s3
s_mul_i32 s46, s33, 9216
s_add_u32 s46, s46, 9437184
s_mul_i32 s33, s30, 4352
s_add_u32 s46, s46, s33
s_mul_i32 s50, s42, 165888
s_add_u32 s43, s31, 3
s_and_b32 s43, s43, 3
s_sub_u32 s33, s43, s31
s_lshl_b32 s33, s33, 3
s_add_u32 s33, s33, s3
s_mul_i32 s47, s33, 9216
s_add_u32 s47, s47, 9437184
s_mul_i32 s33, s30, 4352
s_add_u32 s47, s47, s33
s_mul_i32 s51, s43, 165888
s_lshl_b32 s96, s32, 3
s_add_u32 s96, s96, s30
s_lshl_b32 s96, s96, 3
s_add_u32 s96, s96, s28
s_lshl_b32 s96, s96, 2
s_add_u32 s96, s96, s31
s_andn2_b32 s97, s2, 7
s_add_u32 s97, s97, s28
s_lshl_b32 s97, s97, 5
s_lshl_b32 s33, s30, 0
s_add_u32 s97, s97, s33
s_lshr_b32 s98, s30, 1
s_lshl_b32 s98, s98, 6
s_lshr_b32 s33, s2, 3
s_lshl_b32 s33, s33, 1
s_add_u32 s98, s98, s33
s_and_b32 s33, s30, 1
s_add_u32 s98, s98, s33
s_mul_i32 s53, s30, 72
s_mul_i32 s52, s32, 9
s_add_u32 s53, s53, s52
s_lshl_b32 s52, s31, 1
s_add_u32 s52, s52, s53
s_add_u32 s53, s53, 8
v_lshlrev_b32 v62, 16, v32
v_and_b32 v63, 0xffff0000, v32
v_pk_mul_f32 v[62:63], v[62:63], v[58:59] op_sel_hi:[1,0]
v_cvt_pk_bf16_f32 v32, v62, v63
v_lshlrev_b32 v64, 16, v33
v_and_b32 v65, 0xffff0000, v33
v_pk_mul_f32 v[64:65], v[64:65], v[58:59] op_sel_hi:[1,0]
v_cvt_pk_bf16_f32 v33, v64, v65
v_lshlrev_b32 v62, 16, v34
v_and_b32 v63, 0xffff0000, v34
v_pk_mul_f32 v[62:63], v[62:63], v[58:59] op_sel_hi:[1,0]
v_cvt_pk_bf16_f32 v34, v62, v63
v_lshlrev_b32 v64, 16, v35
v_and_b32 v65, 0xffff0000, v35
v_pk_mul_f32 v[64:65], v[64:65], v[58:59] op_sel_hi:[1,0]
v_cvt_pk_bf16_f32 v35, v64, v65
ds_write_b128 v81, v[32:35] offset:0
ds_read_b64_tr_b16 v[32:33], v82 offset:0
ds_read_b64_tr_b16 v[34:35], v82 offset:576
s_add_u32 s33, s61, 0
s_waitcnt lgkmcnt(0)
buffer_store_dwordx4 v[32:35], v3, s[16:19], s33 offen sc1
v_lshlrev_b32 v62, 16, v36
v_and_b32 v63, 0xffff0000, v36
v_pk_mul_f32 v[62:63], v[62:63], v[58:59] op_sel_hi:[1,0]
v_cvt_pk_bf16_f32 v36, v62, v63
v_lshlrev_b32 v64, 16, v37
v_and_b32 v65, 0xffff0000, v37
v_pk_mul_f32 v[64:65], v[64:65], v[58:59] op_sel_hi:[1,0]
v_cvt_pk_bf16_f32 v37, v64, v65
v_lshlrev_b32 v62, 16, v38
v_and_b32 v63, 0xffff0000, v38
v_pk_mul_f32 v[62:63], v[62:63], v[58:59] op_sel_hi:[1,0]
v_cvt_pk_bf16_f32 v38, v62, v63
v_lshlrev_b32 v64, 16, v39
v_and_b32 v65, 0xffff0000, v39
v_pk_mul_f32 v[64:65], v[64:65], v[58:59] op_sel_hi:[1,0]
v_cvt_pk_bf16_f32 v39, v64, v65
ds_write_b128 v81, v[36:39] offset:4608
ds_read_b64_tr_b16 v[36:37], v82 offset:4608
ds_read_b64_tr_b16 v[38:39], v82 offset:5184
s_add_u32 s33, s61, 4096
s_waitcnt lgkmcnt(0)
buffer_store_dwordx4 v[36:39], v3, s[16:19], s33 offen sc1
s_cmp_lg_u32 s29, 0
s_cbranch_scc1 Ln_12
v_lshlrev_b32 v62, 16, v40
v_and_b32 v63, 0xffff0000, v40
v_pk_mul_f32 v[62:63], v[62:63], v[58:59] op_sel_hi:[1,0]
v_cvt_pk_bf16_f32 v40, v62, v63
v_lshlrev_b32 v64, 16, v41
v_and_b32 v65, 0xffff0000, v41
v_pk_mul_f32 v[64:65], v[64:65], v[58:59] op_sel_hi:[1,0]
v_cvt_pk_bf16_f32 v41, v64, v65
v_lshlrev_b32 v62, 16, v42
v_and_b32 v63, 0xffff0000, v42
v_pk_mul_f32 v[62:63], v[62:63], v[58:59] op_sel_hi:[1,0]
v_cvt_pk_bf16_f32 v42, v62, v63
v_lshlrev_b32 v64, 16, v43
v_and_b32 v65, 0xffff0000, v43
v_pk_mul_f32 v[64:65], v[64:65], v[58:59] op_sel_hi:[1,0]
v_cvt_pk_bf16_f32 v43, v64, v65
ds_write_b128 v81, v[40:43] offset:9216
ds_read_b64_tr_b16 v[40:41], v82 offset:9216
ds_read_b64_tr_b16 v[42:43], v82 offset:9792
s_add_u32 s33, s61, 8192
s_waitcnt lgkmcnt(0)
buffer_store_dwordx4 v[40:43], v3, s[16:19], s33 offen sc1
Ln_12:
v_and_b32 v240, 0xffff, v140
v_lshrrev_b32 v241, 16, v140
v_and_b32 v242, 0xffff, v141
v_lshrrev_b32 v243, 16, v141
v_and_b32 v244, 0xffff, v142
v_lshrrev_b32 v245, 16, v142
v_and_b32 v246, 0xffff, v143
v_lshrrev_b32 v247, 16, v143
v_and_b32 v248, 0xffff, v144
v_lshrrev_b32 v249, 16, v144
v_and_b32 v250, 0xffff, v145
v_add_u32 v240, 152064, v240
v_add_u32 v241, 152064, v241
v_add_u32 v242, 152064, v242
v_add_u32 v243, 152064, v243
v_add_u32 v244, 152064, v244
v_add_u32 v245, 152064, v245
v_add_u32 v246, 152064, v246
v_add_u32 v247, 152064, v247
v_add_u32 v248, 152064, v248
v_add_u32 v249, 152064, v249
v_add_u32 v250, 152064, v250
s_add_u32 s33, s37, 82944
v_add_u32 v251, s33, v3
v_and_b32 v136, 15, v2
v_sub_u32 v137, 3, v136
v_and_b32 v137, 3, v137
v_lshrrev_b32 v138, 4, v2
v_lshlrev_b32 v139, 3, v138
v_sub_u32 v139, v139, v136
v_sub_u32 v139, v139, v137
v_add_u32 v139, 2031, v139
v_lshlrev_b32 v139, 1, v139
v_mul_u32_u24 v137, 4160, v137
v_add_u32 v139, v139, v137
s_lshl_b32 s33, s29, 6
s_sub_u32 s33, 79104, s33
v_add_u32 v252, s33, v139
v_lshl_add_u32 v139, v136, 1, v138
v_mul_u32_u24 v139, 48, v139
s_mul_i32 s33, s29, 192
s_sub_u32 s33, 138816, s33
v_add_u32 v253, s33, v139
v_add_u32 v254, s37, v3
v_lshrrev_b32 v136, 1, v2
v_mul_u32_u24 v136, 4160, v136
v_and_b32 v137, 1, v2
v_lshl_add_u32 v136, v137, 4, v136
s_mul_i32 s33, s29, 18432
s_add_u32 s33, s33, 87040
v_add_u32 v255, s33, v136
s_mul_i32 s38, s29, 192
s_mov_b32 s33, 0x55555556
s_sub_u32 s39, s53, s52
v_add_u32 v136, s38, v2
v_add_u32 v136, 0, v136
v_mul_hi_u32 v137, v136, s33
v_mul_u32_u24 v138, 3, v137
v_sub_u32 v136, v136, v138
v_mov_b32 v138, s39
v_cmp_gt_u32 vcc, 2, v136
s_nop 1
v_cndmask_b32 v136, v138, v136, vcc
v_mul_u32_u24 v137, 9216, v137
v_lshl_add_u32 v232, v136, 4, v137
v_add_u32 v136, s38, v2
v_add_u32 v136, 64, v136
v_mul_hi_u32 v137, v136, s33
v_mul_u32_u24 v138, 3, v137
v_sub_u32 v136, v136, v138
v_mov_b32 v138, s39
v_cmp_gt_u32 vcc, 2, v136
s_nop 1
v_cndmask_b32 v136, v138, v136, vcc
v_mul_u32_u24 v137, 9216, v137
v_lshl_add_u32 v233, v136, 4, v137
v_add_u32 v136, s38, v2
v_add_u32 v136, 128, v136
v_mul_hi_u32 v137, v136, s33
v_mul_u32_u24 v138, 3, v137
v_sub_u32 v136, v136, v138
v_mov_b32 v138, s39
v_cmp_gt_u32 vcc, 2, v136
s_nop 1
v_cndmask_b32 v136, v138, v136, vcc
v_mul_u32_u24 v137, 9216, v137
v_lshl_add_u32 v234, v136, 4, v137
s_sub_u32 s33, s51, 18432
v_mov_b32 v136, s50
v_mov_b32 v137, s33
v_cmp_gt_u32 vcc, 18432, v14
s_nop 1
v_cndmask_b32 v136, v137, v136, vcc
v_add_u32 v17, v136, v14
v_mov_b32 v136, s50
v_mov_b32 v137, s33
v_cmp_gt_u32 vcc, 18432, v15
s_nop 1
v_cndmask_b32 v136, v137, v136, vcc
v_add_u32 v18, v136, v15
v_mov_b32 v136, s50
v_mov_b32 v137, s33
v_cmp_gt_u32 vcc, 18432, v16
s_nop 1
v_cndmask_b32 v136, v137, v136, vcc
v_add_u32 v19, v136, v16
s_lshl_b32 s100, 1, s29
s_mov_b32 s101, 0
v_lshlrev_b32 v0, 2, v2
v_add_u32 v0, 163584, v0
s_waitcnt vmcnt(2)
s_mov_b64 exec, 0xffff
s_mov_b32 s58, 0x8000
LLp_13:
v_cmp_ne_u32 vcc, s68, v23
s_nop 4
s_cbranch_vccz LBq_14
buffer_load_dword v23, v22, s[16:19], 0 offen sc1
s_sub_u32 s58, s58, 1
s_waitcnt vmcnt(0)
s_cmp_gt_i32 s58, 0
s_cbranch_scc1 LLp_13
LBq_14:
s_mov_b64 exec, -1
buffer_load_dwordx4 v[136:139], v3, s[16:19], s34 offen offset:0 sc1
buffer_load_dwordx4 v[140:143], v3, s[16:19], s35 offen offset:0 sc1
buffer_load_dwordx4 v[144:147], v3, s[16:19], s34 offen offset:1024 sc1
buffer_load_dwordx4 v[148:151], v3, s[16:19], s35 offen offset:1024 sc1
buffer_load_dwordx4 v[152:155], v3, s[16:19], s34 offen offset:2048 sc1
buffer_load_dwordx4 v[156:159], v3, s[16:19], s35 offen offset:2048 sc1
buffer_load_dwordx4 v[160:163], v3, s[16:19], s34 offen offset:3072 sc1
buffer_load_dwordx4 v[164:167], v3, s[16:19], s35 offen offset:3072 sc1
s_waitcnt vmcnt(8)
s_barrier
ds_read_b64_tr_b16 v[104:105], v8 offset:0
ds_read_b64_tr_b16 v[106:107], v8 offset:4608
ds_read_b64_tr_b16 v[108:109], v8 offset:32
ds_read_b64_tr_b16 v[110:111], v8 offset:4640
ds_read_b64_tr_b16 v[112:113], v8 offset:64
ds_read_b64_tr_b16 v[114:115], v8 offset:4672
ds_read_b64_tr_b16 v[116:117], v8 offset:96
ds_read_b64_tr_b16 v[118:119], v8 offset:4704
s_waitcnt vmcnt(6)
s_waitcnt lgkmcnt(4)
v_mfma_f32_16x16x32_bf16 v[32:35], v[104:107], v[136:139], 0
ds_read_b64_tr_b16 v[120:121], v8 offset:128
buffer_load_dwordx4 v[168:171], v4, s[16:19], s34 offen offset:0 sc1
v_mfma_f32_16x16x32_bf16 v[36:39], v[104:107], v[140:143], 0
ds_read_b64_tr_b16 v[122:123], v8 offset:4736
buffer_load_dwordx4 v[172:175], v4, s[16:19], s35 offen offset:0 sc1
v_mfma_f32_16x16x32_bf16 v[44:47], v[108:111], v[140:143], 0
ds_read_b64_tr_b16 v[124:125], v8 offset:160
buffer_load_dwordx4 v[176:179], v4, s[16:19], s34 offen offset:1024 sc1
v_mfma_f32_16x16x32_bf16 v[40:43], v[108:111], v[136:139], 0
ds_read_b64_tr_b16 v[126:127], v8 offset:4768
s_waitcnt lgkmcnt(4)
v_mfma_f32_16x16x32_bf16 v[48:51], v[112:115], v[136:139], 0
ds_read_b64_tr_b16 v[128:129], v8 offset:192
buffer_load_dwordx4 v[180:183], v4, s[16:19], s35 offen offset:1024 sc1
v_mfma_f32_16x16x32_bf16 v[52:55], v[112:115], v[140:143], 0
ds_read_b64_tr_b16 v[130:131], v8 offset:4800
v_mfma_f32_16x16x32_bf16 v[60:63], v[116:119], v[140:143], 0
ds_read_b64_tr_b16 v[132:133], v8 offset:224
v_mfma_f32_16x16x32_bf16 v[56:59], v[116:119], v[136:139], 0
ds_read_b64_tr_b16 v[134:135], v8 offset:4832
s_waitcnt lgkmcnt(4)
v_mfma_f32_16x16x32_bf16 v[64:67], v[120:123], v[136:139], 0
ds_read_b64_tr_b16 v[104:105], v8 offset:256
v_mfma_f32_16x16x32_bf16 v[68:71], v[120:123], v[140:143], 0
ds_read_b64_tr_b16 v[106:107], v8 offset:4864
v_mfma_f32_16x16x32_bf16 v[76:79], v[124:127], v[140:143], 0
ds_read_b64_tr_b16 v[108:109], v8 offset:9216
v_mfma_f32_16x16x32_bf16 v[72:75], v[124:127], v[136:139], 0
ds_read_b64_tr_b16 v[110:111], v8 offset:13824
s_waitcnt lgkmcnt(4)
v_mfma_f32_16x16x32_bf16 v[80:83], v[128:131], v[136:139], 0
ds_read_b64_tr_b16 v[112:113], v8 offset:9248
v_mfma_f32_16x16x32_bf16 v[84:87], v[128:131], v[140:143], 0
ds_read_b64_tr_b16 v[114:115], v8 offset:13856
v_mfma_f32_16x16x32_bf16 v[92:95], v[132:135], v[140:143], 0
ds_read_b64_tr_b16 v[116:117], v8 offset:9280
v_mfma_f32_16x16x32_bf16 v[88:91], v[132:135], v[136:139], 0
ds_read_b64_tr_b16 v[118:119], v8 offset:13888
s_waitcnt lgkmcnt(4)
v_mfma_f32_16x16x32_bf16 v[96:99], v[104:107], v[136:139], 0
ds_read_b64_tr_b16 v[120:121], v8 offset:9312
v_mfma_f32_16x16x32_bf16 v[100:103], v[104:107], v[140:143], 0
ds_read_b64_tr_b16 v[122:123], v8 offset:13920
s_waitcnt vmcnt(8)
v_mfma_f32_16x16x32_bf16 v[36:39], v[108:111], v[148:151], v[36:39]
ds_read_b64_tr_b16 v[124:125], v8 offset:9344
s_cmp_lg_u32 s29, 0
s_cbranch_scc1 Lz_15
s_lshl_b32 s33, s2, 2
s_add_u32 s33, s33, 50888704
v_mov_b32 v30, 0
v_mov_b32 v31, s68
s_mov_b64 exec, 1
buffer_store_dword v31, v30, s[16:19], s33 offen sc1
s_mov_b64 exec, -1
Lz_15:
v_mfma_f32_16x16x32_bf16 v[32:35], v[108:111], v[144:147], v[32:35]
ds_read_b64_tr_b16 v[126:127], v8 offset:13952
s_waitcnt lgkmcnt(4)
v_mfma_f32_16x16x32_bf16 v[40:43], v[112:115], v[144:147], v[40:43]
ds_read_b64_tr_b16 v[128:129], v8 offset:9376
buffer_load_dwordx4 v[184:187], v4, s[16:19], s34 offen offset:2048 sc1
v_mfma_f32_16x16x32_bf16 v[44:47], v[112:115], v[148:151], v[44:47]
ds_read_b64_tr_b16 v[130:131], v8 offset:13984
buffer_load_dwordx4 v[188:191], v4, s[16:19], s35 offen offset:2048 sc1
v_mfma_f32_16x16x32_bf16 v[52:55], v[116:119], v[148:151], v[52:55]
ds_read_b64_tr_b16 v[132:133], v8 offset:9408
v_mfma_f32_16x16x32_bf16 v[48:51], v[116:119], v[144:147], v[48:51]
ds_read_b64_tr_b16 v[134:135], v8 offset:14016
s_waitcnt lgkmcnt(4)
v_mfma_f32_16x16x32_bf16 v[56:59], v[120:123], v[144:147], v[56:59]
ds_read_b64_tr_b16 v[104:105], v8 offset:9440
v_mfma_f32_16x16x32_bf16 v[60:63], v[120:123], v[148:151], v[60:63]
ds_read_b64_tr_b16 v[106:107], v8 offset:14048
v_mfma_f32_16x16x32_bf16 v[68:71], v[124:127], v[148:151], v[68:71]
ds_read_b64_tr_b16 v[108:109], v8 offset:9472
v_mfma_f32_16x16x32_bf16 v[64:67], v[124:127], v[144:147], v[64:67]
ds_read_b64_tr_b16 v[110:111], v8 offset:14080
s_waitcnt lgkmcnt(4)
v_mfma_f32_16x16x32_bf16 v[72:75], v[128:131], v[144:147], v[72:75]
ds_read_b64_tr_b16 v[112:113], v8 offset:18432
v_mfma_f32_16x16x32_bf16 v[76:79], v[128:131], v[148:151], v[76:79]
ds_read_b64_tr_b16 v[114:115], v8 offset:23040
v_mfma_f32_16x16x32_bf16 v[84:87], v[132:135], v[148:151], v[84:87]
ds_read_b64_tr_b16 v[116:117], v8 offset:18464
v_mfma_f32_16x16x32_bf16 v[80:83], v[132:135], v[144:147], v[80:83]
ds_read_b64_tr_b16 v[118:119], v8 offset:23072
s_waitcnt lgkmcnt(4)
v_mfma_f32_16x16x32_bf16 v[88:91], v[104:107], v[144:147], v[88:91]
ds_read_b64_tr_b16 v[120:121], v8 offset:18496
v_mfma_f32_16x16x32_bf16 v[92:95], v[104:107], v[148:151], v[92:95]
ds_read_b64_tr_b16 v[122:123], v8 offset:23104
v_mfma_f32_16x16x32_bf16 v[100:103], v[108:111], v[148:151], v[100:103]
ds_read_b64_tr_b16 v[124:125], v8 offset:18528
v_mfma_f32_16x16x32_bf16 v[96:99], v[108:111], v[144:147], v[96:99]
ds_read_b64_tr_b16 v[126:127], v8 offset:23136
s_waitcnt vmcnt(8)
s_waitcnt lgkmcnt(4)
v_mfma_f32_16x16x32_bf16 v[32:35], v[112:115], v[152:155], v[32:35]
ds_read_b64_tr_b16 v[128:129], v8 offset:18560
buffer_load_dwordx4 v[192:195], v4, s[16:19], s34 offen offset:3072 sc1
v_mfma_f32_16x16x32_bf16 v[36:39], v[112:115], v[156:159], v[36:39]
ds_read_b64_tr_b16 v[130:131], v8 offset:23168
buffer_load_dwordx4 v[196:199], v4, s[16:19], s35 offen offset:3072 sc1
v_mfma_f32_16x16x32_bf16 v[44:47], v[116:119], v[156:159], v[44:47]
ds_read_b64_tr_b16 v[132:133], v8 offset:18592
v_mfma_f32_16x16x32_bf16 v[40:43], v[116:119], v[152:155], v[40:43]
ds_read_b64_tr_b16 v[134:135], v8 offset:23200
s_waitcnt lgkmcnt(4)
v_mfma_f32_16x16x32_bf16 v[48:51], v[120:123], v[152:155], v[48:51]
ds_read_b64_tr_b16 v[104:105], v8 offset:18624
v_mfma_f32_16x16x32_bf16 v[52:55], v[120:123], v[156:159], v[52:55]
ds_read_b64_tr_b16 v[106:107], v8 offset:23232
v_mfma_f32_16x16x32_bf16 v[60:63], v[124:127], v[156:159], v[60:63]
ds_read_b64_tr_b16 v[108:109], v8 offset:18656
v_mfma_f32_16x16x32_bf16 v[56:59], v[124:127], v[152:155], v[56:59]
ds_read_b64_tr_b16 v[110:111], v8 offset:23264
s_waitcnt lgkmcnt(4)
v_mfma_f32_16x16x32_bf16 v[64:67], v[128:131], v[152:155], v[64:67]
ds_read_b64_tr_b16 v[112:113], v8 offset:18688
v_mfma_f32_16x16x32_bf16 v[68:71], v[128:131], v[156:159], v[68:71]
ds_read_b64_tr_b16 v[114:115], v8 offset:23296
v_mfma_f32_16x16x32_bf16 v[76:79], v[132:135], v[156:159], v[76:79]
ds_read_b64_tr_b16 v[116:117], v8 offset:27648
v_mfma_f32_16x16x32_bf16 v[72:75], v[132:135], v[152:155], v[72:75]
ds_read_b64_tr_b16 v[118:119], v8 offset:32256
s_waitcnt lgkmcnt(4)
v_mfma_f32_16x16x32_bf16 v[80:83], v[104:107], v[152:155], v[80:83]
ds_read_b64_tr_b16 v[120:121], v8 offset:27680
v_mfma_f32_16x16x32_bf16 v[84:87], v[104:107], v[156:159], v[84:87]
ds_read_b64_tr_b16 v[122:123], v8 offset:32288
v_mfma_f32_16x16x32_bf16 v[92:95], v[108:111], v[156:159], v[92:95]
ds_read_b64_tr_b16 v[124:125], v8 offset:27712
v_mfma_f32_16x16x32_bf16 v[88:91], v[108:111], v[152:155], v[88:91]
ds_read_b64_tr_b16 v[126:127], v8 offset:32320
s_waitcnt lgkmcnt(4)
v_mfma_f32_16x16x32_bf16 v[96:99], v[112:115], v[152:155], v[96:99]
ds_read_b64_tr_b16 v[128:129], v8 offset:27744
v_mfma_f32_16x16x32_bf16 v[100:103], v[112:115], v[156:159], v[100:103]
ds_read_b64_tr_b16 v[130:131], v8 offset:32352
s_waitcnt vmcnt(8)
v_mfma_f32_16x16x32_bf16 v[36:39], v[116:119], v[164:167], v[36:39]
ds_read_b64_tr_b16 v[132:133], v8 offset:27776
buffer_load_dwordx4 v[200:203], v5, s[16:19], s34 offen offset:0 sc1
v_mfma_f32_16x16x32_bf16 v[32:35], v[116:119], v[160:163], v[32:35]
ds_read_b64_tr_b16 v[134:135], v8 offset:32384
s_waitcnt lgkmcnt(4)
v_mfma_f32_16x16x32_bf16 v[40:43], v[120:123], v[160:163], v[40:43]
ds_read_b64_tr_b16 v[104:105], v8 offset:27808
buffer_load_dwordx4 v[204:207], v5, s[16:19], s35 offen offset:0 sc1
v_mfma_f32_16x16x32_bf16 v[44:47], v[120:123], v[164:167], v[44:47]
ds_read_b64_tr_b16 v[106:107], v8 offset:32416
v_mfma_f32_16x16x32_bf16 v[52:55], v[124:127], v[164:167], v[52:55]
ds_read_b64_tr_b16 v[108:109], v8 offset:27840
v_mfma_f32_16x16x32_bf16 v[48:51], v[124:127], v[160:163], v[48:51]
ds_read_b64_tr_b16 v[110:111], v8 offset:32448
s_waitcnt lgkmcnt(4)
v_mfma_f32_16x16x32_bf16 v[56:59], v[128:131], v[160:163], v[56:59]
ds_read_b64_tr_b16 v[112:113], v8 offset:27872
v_mfma_f32_16x16x32_bf16 v[60:63], v[128:131], v[164:167], v[60:63]
ds_read_b64_tr_b16 v[114:115], v8 offset:32480
v_mfma_f32_16x16x32_bf16 v[68:71], v[132:135], v[164:167], v[68:71]
ds_read_b64_tr_b16 v[116:117], v8 offset:27904
v_mfma_f32_16x16x32_bf16 v[64:67], v[132:135], v[160:163], v[64:67]
ds_read_b64_tr_b16 v[118:119], v8 offset:32512
s_waitcnt lgkmcnt(4)
v_mfma_f32_16x16x32_bf16 v[72:75], v[104:107], v[160:163], v[72:75]
ds_read_b64_tr_b16 v[120:121], v8 offset:36864
v_mfma_f32_16x16x32_bf16 v[76:79], v[104:107], v[164:167], v[76:79]
ds_read_b64_tr_b16 v[122:123], v8 offset:41472
v_mfma_f32_16x16x32_bf16 v[84:87], v[108:111], v[164:167], v[84:87]
ds_read_b64_tr_b16 v[124:125], v8 offset:36896
v_mfma_f32_16x16x32_bf16 v[80:83], v[108:111], v[160:163], v[80:83]
ds_read_b64_tr_b16 v[126:127], v8 offset:41504
s_waitcnt lgkmcnt(4)
v_mfma_f32_16x16x32_bf16 v[88:91], v[112:115], v[160:163], v[88:91]
ds_read_b64_tr_b16 v[128:129], v8 offset:36928
v_mfma_f32_16x16x32_bf16 v[92:95], v[112:115], v[164:167], v[92:95]
ds_read_b64_tr_b16 v[130:131], v8 offset:41536
v_mfma_f32_16x16x32_bf16 v[100:103], v[116:119], v[164:167], v[100:103]
ds_read_b64_tr_b16 v[132:133], v8 offset:36960
v_mfma_f32_16x16x32_bf16 v[96:99], v[116:119], v[160:163], v[96:99]
ds_read_b64_tr_b16 v[134:135], v8 offset:41568
s_waitcnt vmcnt(8)
s_waitcnt lgkmcnt(4)
v_mfma_f32_16x16x32_bf16 v[32:35], v[120:123], v[168:171], v[32:35]
ds_read_b64_tr_b16 v[104:105], v8 offset:36992
buffer_load_dwordx4 v[208:211], v5, s[16:19], s34 offen offset:1024 sc1
v_mfma_f32_16x16x32_bf16 v[36:39], v[120:123], v[172:175], v[36:39]
ds_read_b64_tr_b16 v[106:107], v8 offset:41600
buffer_load_dwordx4 v[212:215], v5, s[16:19], s35 offen offset:1024 sc1
v_mfma_f32_16x16x32_bf16 v[44:47], v[124:127], v[172:175], v[44:47]
ds_read_b64_tr_b16 v[108:109], v8 offset:37024
v_mfma_f32_16x16x32_bf16 v[40:43], v[124:127], v[168:171], v[40:43]
ds_read_b64_tr_b16 v[110:111], v8 offset:41632
s_waitcnt lgkmcnt(4)
v_mfma_f32_16x16x32_bf16 v[48:51], v[128:131], v[168:171], v[48:51]
ds_read_b64_tr_b16 v[112:113], v8 offset:37056
v_mfma_f32_16x16x32_bf16 v[52:55], v[128:131], v[172:175], v[52:55]
ds_read_b64_tr_b16 v[114:115], v8 offset:41664
v_mfma_f32_16x16x32_bf16 v[60:63], v[132:135], v[172:175], v[60:63]
ds_read_b64_tr_b16 v[116:117], v8 offset:37088
v_mfma_f32_16x16x32_bf16 v[56:59], v[132:135], v[168:171], v[56:59]
ds_read_b64_tr_b16 v[118:119], v8 offset:41696
s_waitcnt lgkmcnt(4)
v_mfma_f32_16x16x32_bf16 v[64:67], v[104:107], v[168:171], v[64:67]
ds_read_b64_tr_b16 v[120:121], v8 offset:37120
v_mfma_f32_16x16x32_bf16 v[68:71], v[104:107], v[172:175], v[68:71]
ds_read_b64_tr_b16 v[122:123], v8 offset:41728
v_mfma_f32_16x16x32_bf16 v[76:79], v[108:111], v[172:175], v[76:79]
ds_read_b64_tr_b16 v[124:125], v8 offset:46080
v_mfma_f32_16x16x32_bf16 v[72:75], v[108:111], v[168:171], v[72:75]
ds_read_b64_tr_b16 v[126:127], v8 offset:50688
s_waitcnt lgkmcnt(4)
v_mfma_f32_16x16x32_bf16 v[80:83], v[112:115], v[168:171], v[80:83]
ds_read_b64_tr_b16 v[128:129], v8 offset:46112
v_mfma_f32_16x16x32_bf16 v[84:87], v[112:115], v[172:175], v[84:87]
ds_read_b64_tr_b16 v[130:131], v8 offset:50720
v_mfma_f32_16x16x32_bf16 v[92:95], v[116:119], v[172:175], v[92:95]
ds_read_b64_tr_b16 v[132:133], v8 offset:46144
v_mfma_f32_16x16x32_bf16 v[88:91], v[116:119], v[168:171], v[88:91]
ds_read_b64_tr_b16 v[134:135], v8 offset:50752
s_waitcnt lgkmcnt(4)
v_mfma_f32_16x16x32_bf16 v[96:99], v[120:123], v[168:171], v[96:99]
ds_read_b64_tr_b16 v[104:105], v8 offset:46176
v_mfma_f32_16x16x32_bf16 v[100:103], v[120:123], v[172:175], v[100:103]
ds_read_b64_tr_b16 v[106:107], v8 offset:50784
s_waitcnt vmcnt(8)
v_mfma_f32_16x16x32_bf16 v[36:39], v[124:127], v[180:183], v[36:39]
ds_read_b64_tr_b16 v[108:109], v8 offset:46208
buffer_load_dwordx4 v[216:219], v5, s[16:19], s34 offen offset:2048 sc1
v_mfma_f32_16x16x32_bf16 v[32:35], v[124:127], v[176:179], v[32:35]
ds_read_b64_tr_b16 v[110:111], v8 offset:50816
s_waitcnt lgkmcnt(4)
v_mfma_f32_16x16x32_bf16 v[40:43], v[128:131], v[176:179], v[40:43]
ds_read_b64_tr_b16 v[112:113], v8 offset:46240
buffer_load_dwordx4 v[220:223], v5, s[16:19], s35 offen offset:2048 sc1
v_mfma_f32_16x16x32_bf16 v[44:47], v[128:131], v[180:183], v[44:47]
ds_read_b64_tr_b16 v[114:115], v8 offset:50848
v_mfma_f32_16x16x32_bf16 v[52:55], v[132:135], v[180:183], v[52:55]
ds_read_b64_tr_b16 v[116:117], v8 offset:46272
v_mfma_f32_16x16x32_bf16 v[48:51], v[132:135], v[176:179], v[48:51]
ds_read_b64_tr_b16 v[118:119], v8 offset:50880
s_waitcnt lgkmcnt(4)
v_mfma_f32_16x16x32_bf16 v[56:59], v[104:107], v[176:179], v[56:59]
ds_read_b64_tr_b16 v[120:121], v8 offset:46304
v_mfma_f32_16x16x32_bf16 v[60:63], v[104:107], v[180:183], v[60:63]
ds_read_b64_tr_b16 v[122:123], v8 offset:50912
v_mfma_f32_16x16x32_bf16 v[68:71], v[108:111], v[180:183], v[68:71]
ds_read_b64_tr_b16 v[124:125], v8 offset:46336
v_mfma_f32_16x16x32_bf16 v[64:67], v[108:111], v[176:179], v[64:67]
ds_read_b64_tr_b16 v[126:127], v8 offset:50944
s_waitcnt lgkmcnt(4)
v_mfma_f32_16x16x32_bf16 v[72:75], v[112:115], v[176:179], v[72:75]
ds_read_b64_tr_b16 v[128:129], v9 offset:0
v_mfma_f32_16x16x32_bf16 v[76:79], v[112:115], v[180:183], v[76:79]
ds_read_b64_tr_b16 v[130:131], v9 offset:4608
v_mfma_f32_16x16x32_bf16 v[84:87], v[116:119], v[180:183], v[84:87]
ds_read_b64_tr_b16 v[132:133], v9 offset:32
v_mfma_f32_16x16x32_bf16 v[80:83], v[116:119], v[176:179], v[80:83]
ds_read_b64_tr_b16 v[134:135], v9 offset:4640
s_waitcnt lgkmcnt(4)
v_mfma_f32_16x16x32_bf16 v[88:91], v[120:123], v[176:179], v[88:91]
ds_read_b64_tr_b16 v[104:105], v9 offset:64
v_mfma_f32_16x16x32_bf16 v[92:95], v[120:123], v[180:183], v[92:95]
ds_read_b64_tr_b16 v[106:107], v9 offset:4672
v_mfma_f32_16x16x32_bf16 v[100:103], v[124:127], v[180:183], v[100:103]
ds_read_b64_tr_b16 v[108:109], v9 offset:96
v_mfma_f32_16x16x32_bf16 v[96:99], v[124:127], v[176:179], v[96:99]
ds_read_b64_tr_b16 v[110:111], v9 offset:4704
s_mov_b32 s58, 0x100000
LLs_16:
ds_read_b32 v31, v0 offset:16
s_sub_u32 s58, s58, 1
s_waitcnt lgkmcnt(0)
v_cmp_gt_u32 vcc, 1, v31
s_nop 1
s_and_b32 s33, vcc_lo, 15
s_cbranch_scc0 LBs_17
s_sleep 2
s_cmp_gt_i32 s58, 0
s_cbranch_scc1 LLs_16
LBs_17:
s_waitcnt vmcnt(8)
s_waitcnt lgkmcnt(4)
v_mfma_f32_16x16x32_bf16 v[32:35], v[128:131], v[184:187], v[32:35]
ds_read_b64_tr_b16 v[112:113], v9 offset:128
buffer_load_dwordx4 v[224:227], v5, s[16:19], s34 offen offset:3072 sc1
v_mfma_f32_16x16x32_bf16 v[36:39], v[128:131], v[188:191], v[36:39]
ds_read_b64_tr_b16 v[114:115], v9 offset:4736
buffer_load_dwordx4 v[228:231], v5, s[16:19], s35 offen offset:3072 sc1
v_mfma_f32_16x16x32_bf16 v[44:47], v[132:135], v[188:191], v[44:47]
ds_read_b64_tr_b16 v[116:117], v9 offset:160
v_mfma_f32_16x16x32_bf16 v[40:43], v[132:135], v[184:187], v[40:43]
ds_read_b64_tr_b16 v[118:119], v9 offset:4768
s_waitcnt lgkmcnt(4)
v_mfma_f32_16x16x32_bf16 v[48:51], v[104:107], v[184:187], v[48:51]
ds_read_b64_tr_b16 v[120:121], v9 offset:192
v_mfma_f32_16x16x32_bf16 v[52:55], v[104:107], v[188:191], v[52:55]
ds_read_b64_tr_b16 v[122:123], v9 offset:4800
v_mfma_f32_16x16x32_bf16 v[60:63], v[108:111], v[188:191], v[60:63]
ds_read_b64_tr_b16 v[124:125], v9 offset:224
v_mfma_f32_16x16x32_bf16 v[56:59], v[108:111], v[184:187], v[56:59]
ds_read_b64_tr_b16 v[126:127], v9 offset:4832
s_waitcnt lgkmcnt(4)
v_mfma_f32_16x16x32_bf16 v[64:67], v[112:115], v[184:187], v[64:67]
ds_read_b64_tr_b16 v[128:129], v9 offset:256
v_mfma_f32_16x16x32_bf16 v[68:71], v[112:115], v[188:191], v[68:71]
ds_read_b64_tr_b16 v[130:131], v9 offset:4864
v_mfma_f32_16x16x32_bf16 v[76:79], v[116:119], v[188:191], v[76:79]
ds_read_b64_tr_b16 v[132:133], v9 offset:9216
v_mfma_f32_16x16x32_bf16 v[72:75], v[116:119], v[184:187], v[72:75]
ds_read_b64_tr_b16 v[134:135], v9 offset:13824
s_waitcnt lgkmcnt(4)
v_mfma_f32_16x16x32_bf16 v[80:83], v[120:123], v[184:187], v[80:83]
ds_read_b64_tr_b16 v[104:105], v9 offset:9248
v_mfma_f32_16x16x32_bf16 v[84:87], v[120:123], v[188:191], v[84:87]
ds_read_b64_tr_b16 v[106:107], v9 offset:13856
v_mfma_f32_16x16x32_bf16 v[92:95], v[124:127], v[188:191], v[92:95]
ds_read_b64_tr_b16 v[108:109], v9 offset:9280
v_mfma_f32_16x16x32_bf16 v[88:91], v[124:127], v[184:187], v[88:91]
ds_read_b64_tr_b16 v[110:111], v9 offset:13888
s_waitcnt lgkmcnt(4)
v_mfma_f32_16x16x32_bf16 v[96:99], v[128:131], v[184:187], v[96:99]
ds_read_b64_tr_b16 v[112:113], v9 offset:9312
v_mfma_f32_16x16x32_bf16 v[100:103], v[128:131], v[188:191], v[100:103]
ds_read_b64_tr_b16 v[114:115], v9 offset:13920
s_waitcnt vmcnt(8)
v_mfma_f32_16x16x32_bf16 v[36:39], v[132:135], v[196:199], v[36:39]
ds_read_b64_tr_b16 v[116:117], v9 offset:9344
buffer_load_dwordx4 v[136:139], v6, s[16:19], s34 offen offset:0 sc1
v_mfma_f32_16x16x32_bf16 v[32:35], v[132:135], v[192:195], v[32:35]
ds_read_b64_tr_b16 v[118:119], v9 offset:13952
s_waitcnt lgkmcnt(4)
v_mfma_f32_16x16x32_bf16 v[40:43], v[104:107], v[192:195], v[40:43]
ds_read_b64_tr_b16 v[120:121], v9 offset:9376
buffer_load_dwordx4 v[140:143], v6, s[16:19], s35 offen offset:0 sc1
v_mfma_f32_16x16x32_bf16 v[44:47], v[104:107], v[196:199], v[44:47]
ds_read_b64_tr_b16 v[122:123], v9 offset:13984
v_mfma_f32_16x16x32_bf16 v[52:55], v[108:111], v[196:199], v[52:55]
ds_read_b64_tr_b16 v[124:125], v9 offset:9408
v_mfma_f32_16x16x32_bf16 v[48:51], v[108:111], v[192:195], v[48:51]
ds_read_b64_tr_b16 v[126:127], v9 offset:14016
s_waitcnt lgkmcnt(4)
v_mfma_f32_16x16x32_bf16 v[56:59], v[112:115], v[192:195], v[56:59]
ds_read_b64_tr_b16 v[128:129], v9 offset:9440
v_mfma_f32_16x16x32_bf16 v[60:63], v[112:115], v[196:199], v[60:63]
ds_read_b64_tr_b16 v[130:131], v9 offset:14048
v_mfma_f32_16x16x32_bf16 v[68:71], v[116:119], v[196:199], v[68:71]
ds_read_b64_tr_b16 v[132:133], v9 offset:9472
v_mfma_f32_16x16x32_bf16 v[64:67], v[116:119], v[192:195], v[64:67]
ds_read_b64_tr_b16 v[134:135], v9 offset:14080
s_waitcnt lgkmcnt(4)
v_mfma_f32_16x16x32_bf16 v[72:75], v[120:123], v[192:195], v[72:75]
ds_read_b64_tr_b16 v[104:105], v9 offset:18432
v_mfma_f32_16x16x32_bf16 v[76:79], v[120:123], v[196:199], v[76:79]
ds_read_b64_tr_b16 v[106:107], v9 offset:23040
v_mfma_f32_16x16x32_bf16 v[84:87], v[124:127], v[196:199], v[84:87]
ds_read_b64_tr_b16 v[108:109], v9 offset:18464
v_mfma_f32_16x16x32_bf16 v[80:83], v[124:127], v[192:195], v[80:83]
ds_read_b64_tr_b16 v[110:111], v9 offset:23072
s_waitcnt lgkmcnt(4)
v_mfma_f32_16x16x32_bf16 v[88:91], v[128:131], v[192:195], v[88:91]
ds_read_b64_tr_b16 v[112:113], v9 offset:18496
v_mfma_f32_16x16x32_bf16 v[92:95], v[128:131], v[196:199], v[92:95]
ds_read_b64_tr_b16 v[114:115], v9 offset:23104
v_mfma_f32_16x16x32_bf16 v[100:103], v[132:135], v[196:199], v[100:103]
ds_read_b64_tr_b16 v[116:117], v9 offset:18528
v_mfma_f32_16x16x32_bf16 v[96:99], v[132:135], v[192:195], v[96:99]
ds_read_b64_tr_b16 v[118:119], v9 offset:23136
s_waitcnt vmcnt(8)
s_waitcnt lgkmcnt(4)
v_mfma_f32_16x16x32_bf16 v[32:35], v[104:107], v[200:203], v[32:35]
ds_read_b64_tr_b16 v[120:121], v9 offset:18560
buffer_load_dwordx4 v[144:147], v6, s[16:19], s34 offen offset:1024 sc1
v_mfma_f32_16x16x32_bf16 v[36:39], v[104:107], v[204:207], v[36:39]
ds_read_b64_tr_b16 v[122:123], v9 offset:23168
buffer_load_dwordx4 v[148:151], v6, s[16:19], s35 offen offset:1024 sc1
v_mfma_f32_16x16x32_bf16 v[44:47], v[108:111], v[204:207], v[44:47]
ds_read_b64_tr_b16 v[124:125], v9 offset:18592
v_mfma_f32_16x16x32_bf16 v[40:43], v[108:111], v[200:203], v[40:43]
ds_read_b64_tr_b16 v[126:127], v9 offset:23200
s_waitcnt lgkmcnt(4)
v_mfma_f32_16x16x32_bf16 v[48:51], v[112:115], v[200:203], v[48:51]
ds_read_b64_tr_b16 v[128:129], v9 offset:18624
v_mfma_f32_16x16x32_bf16 v[52:55], v[112:115], v[204:207], v[52:55]
ds_read_b64_tr_b16 v[130:131], v9 offset:23232
v_mfma_f32_16x16x32_bf16 v[60:63], v[116:119], v[204:207], v[60:63]
ds_read_b64_tr_b16 v[132:133], v9 offset:18656
v_mfma_f32_16x16x32_bf16 v[56:59], v[116:119], v[200:203], v[56:59]
ds_read_b64_tr_b16 v[134:135], v9 offset:23264
s_waitcnt lgkmcnt(4)
v_mfma_f32_16x16x32_bf16 v[64:67], v[120:123], v[200:203], v[64:67]
ds_read_b64_tr_b16 v[104:105], v9 offset:18688
v_mfma_f32_16x16x32_bf16 v[68:71], v[120:123], v[204:207], v[68:71]
ds_read_b64_tr_b16 v[106:107], v9 offset:23296
v_mfma_f32_16x16x32_bf16 v[76:79], v[124:127], v[204:207], v[76:79]
ds_read_b64_tr_b16 v[108:109], v9 offset:27648
v_mfma_f32_16x16x32_bf16 v[72:75], v[124:127], v[200:203], v[72:75]
ds_read_b64_tr_b16 v[110:111], v9 offset:32256
s_waitcnt lgkmcnt(4)
v_mfma_f32_16x16x32_bf16 v[80:83], v[128:131], v[200:203], v[80:83]
ds_read_b64_tr_b16 v[112:113], v9 offset:27680
v_mfma_f32_16x16x32_bf16 v[84:87], v[128:131], v[204:207], v[84:87]
ds_read_b64_tr_b16 v[114:115], v9 offset:32288
v_mfma_f32_16x16x32_bf16 v[92:95], v[132:135], v[204:207], v[92:95]
ds_read_b64_tr_b16 v[116:117], v9 offset:27712
v_mfma_f32_16x16x32_bf16 v[88:91], v[132:135], v[200:203], v[88:91]
ds_read_b64_tr_b16 v[118:119], v9 offset:32320
s_waitcnt lgkmcnt(4)
v_mfma_f32_16x16x32_bf16 v[96:99], v[104:107], v[200:203], v[96:99]
ds_read_b64_tr_b16 v[120:121], v9 offset:27744
v_mfma_f32_16x16x32_bf16 v[100:103], v[104:107], v[204:207], v[100:103]
ds_read_b64_tr_b16 v[122:123], v9 offset:32352
s_mov_b32 s58, 0x100000
LLs_18:
ds_read_b32 v31, v0 offset:16
s_sub_u32 s58, s58, 1
s_waitcnt lgkmcnt(0)
v_cmp_gt_u32 vcc, 2, v31
s_nop 1
s_and_b32 s33, vcc_lo, 15
s_cbranch_scc0 LBs_19
s_sleep 2
s_cmp_gt_i32 s58, 0
s_cbranch_scc1 LLs_18
LBs_19:
s_waitcnt vmcnt(8)
v_mfma_f32_16x16x32_bf16 v[36:39], v[108:111], v[212:215], v[36:39]
ds_read_b64_tr_b16 v[124:125], v9 offset:27776
buffer_load_dwordx4 v[152:155], v6, s[16:19], s34 offen offset:2048 sc1
v_mfma_f32_16x16x32_bf16 v[32:35], v[108:111], v[208:211], v[32:35]
ds_read_b64_tr_b16 v[126:127], v9 offset:32384
s_waitcnt lgkmcnt(4)
v_mfma_f32_16x16x32_bf16 v[40:43], v[112:115], v[208:211], v[40:43]
ds_read_b64_tr_b16 v[128:129], v9 offset:27808
buffer_load_dwordx4 v[156:159], v6, s[16:19], s35 offen offset:2048 sc1
v_mfma_f32_16x16x32_bf16 v[44:47], v[112:115], v[212:215], v[44:47]
ds_read_b64_tr_b16 v[130:131], v9 offset:32416
v_mfma_f32_16x16x32_bf16 v[52:55], v[116:119], v[212:215], v[52:55]
ds_read_b64_tr_b16 v[132:133], v9 offset:27840
v_mfma_f32_16x16x32_bf16 v[48:51], v[116:119], v[208:211], v[48:51]
ds_read_b64_tr_b16 v[134:135], v9 offset:32448
s_waitcnt lgkmcnt(4)
v_mfma_f32_16x16x32_bf16 v[56:59], v[120:123], v[208:211], v[56:59]
ds_read_b64_tr_b16 v[104:105], v9 offset:27872
v_mfma_f32_16x16x32_bf16 v[60:63], v[120:123], v[212:215], v[60:63]
ds_read_b64_tr_b16 v[106:107], v9 offset:32480
v_mfma_f32_16x16x32_bf16 v[68:71], v[124:127], v[212:215], v[68:71]
ds_read_b64_tr_b16 v[108:109], v9 offset:27904
v_mfma_f32_16x16x32_bf16 v[64:67], v[124:127], v[208:211], v[64:67]
ds_read_b64_tr_b16 v[110:111], v9 offset:32512
s_waitcnt lgkmcnt(4)
v_mfma_f32_16x16x32_bf16 v[72:75], v[128:131], v[208:211], v[72:75]
ds_read_b64_tr_b16 v[112:113], v9 offset:36864
v_mfma_f32_16x16x32_bf16 v[76:79], v[128:131], v[212:215], v[76:79]
ds_read_b64_tr_b16 v[114:115], v9 offset:41472
v_mfma_f32_16x16x32_bf16 v[84:87], v[132:135], v[212:215], v[84:87]
ds_read_b64_tr_b16 v[116:117], v9 offset:36896
v_mfma_f32_16x16x32_bf16 v[80:83], v[132:135], v[208:211], v[80:83]
ds_read_b64_tr_b16 v[118:119], v9 offset:41504
s_waitcnt lgkmcnt(4)
v_mfma_f32_16x16x32_bf16 v[88:91], v[104:107], v[208:211], v[88:91]
ds_read_b64_tr_b16 v[120:121], v9 offset:36928
v_mfma_f32_16x16x32_bf16 v[92:95], v[104:107], v[212:215], v[92:95]
ds_read_b64_tr_b16 v[122:123], v9 offset:41536
v_mfma_f32_16x16x32_bf16 v[100:103], v[108:111], v[212:215], v[100:103]
ds_read_b64_tr_b16 v[124:125], v9 offset:36960
v_mfma_f32_16x16x32_bf16 v[96:99], v[108:111], v[208:211], v[96:99]
ds_read_b64_tr_b16 v[126:127], v9 offset:41568
s_barrier
s_waitcnt vmcnt(8)
s_waitcnt lgkmcnt(4)
v_mfma_f32_16x16x32_bf16 v[32:35], v[112:115], v[216:219], v[32:35]
ds_read_b64_tr_b16 v[128:129], v9 offset:36992
buffer_load_dwordx4 v[160:163], v6, s[16:19], s34 offen offset:3072 sc1
v_mfma_f32_16x16x32_bf16 v[36:39], v[112:115], v[220:223], v[36:39]
ds_read_b64_tr_b16 v[130:131], v9 offset:41600
buffer_load_dwordx4 v[164:167], v6, s[16:19], s35 offen offset:3072 sc1
v_mfma_f32_16x16x32_bf16 v[44:47], v[116:119], v[220:223], v[44:47]
ds_read_b64_tr_b16 v[132:133], v9 offset:37024
v_mfma_f32_16x16x32_bf16 v[40:43], v[116:119], v[216:219], v[40:43]
ds_read_b64_tr_b16 v[134:135], v9 offset:41632
s_waitcnt lgkmcnt(4)
v_mfma_f32_16x16x32_bf16 v[48:51], v[120:123], v[216:219], v[48:51]
ds_read_b64_tr_b16 v[104:105], v9 offset:37056
v_mfma_f32_16x16x32_bf16 v[52:55], v[120:123], v[220:223], v[52:55]
ds_read_b64_tr_b16 v[106:107], v9 offset:41664
v_mfma_f32_16x16x32_bf16 v[60:63], v[124:127], v[220:223], v[60:63]
ds_read_b64_tr_b16 v[108:109], v9 offset:37088
v_mfma_f32_16x16x32_bf16 v[56:59], v[124:127], v[216:219], v[56:59]
ds_read_b64_tr_b16 v[110:111], v9 offset:41696
s_waitcnt lgkmcnt(4)
v_mfma_f32_16x16x32_bf16 v[64:67], v[128:131], v[216:219], v[64:67]
ds_read_b64_tr_b16 v[112:113], v9 offset:37120
v_mfma_f32_16x16x32_bf16 v[68:71], v[128:131], v[220:223], v[68:71]
ds_read_b64_tr_b16 v[114:115], v9 offset:41728
v_mfma_f32_16x16x32_bf16 v[76:79], v[132:135], v[220:223], v[76:79]
ds_read_b64_tr_b16 v[116:117], v9 offset:46080
v_mfma_f32_16x16x32_bf16 v[72:75], v[132:135], v[216:219], v[72:75]
ds_read_b64_tr_b16 v[118:119], v9 offset:50688
s_waitcnt lgkmcnt(4)
v_mfma_f32_16x16x32_bf16 v[80:83], v[104:107], v[216:219], v[80:83]
ds_read_b64_tr_b16 v[120:121], v9 offset:46112
v_mfma_f32_16x16x32_bf16 v[84:87], v[104:107], v[220:223], v[84:87]
ds_read_b64_tr_b16 v[122:123], v9 offset:50720
v_mfma_f32_16x16x32_bf16 v[92:95], v[108:111], v[220:223], v[92:95]
ds_read_b64_tr_b16 v[124:125], v9 offset:46144
v_mfma_f32_16x16x32_bf16 v[88:91], v[108:111], v[216:219], v[88:91]
ds_read_b64_tr_b16 v[126:127], v9 offset:50752
s_waitcnt lgkmcnt(4)
v_mfma_f32_16x16x32_bf16 v[96:99], v[112:115], v[216:219], v[96:99]
ds_read_b64_tr_b16 v[128:129], v9 offset:46176
v_mfma_f32_16x16x32_bf16 v[100:103], v[112:115], v[220:223], v[100:103]
ds_read_b64_tr_b16 v[130:131], v9 offset:50784
s_barrier
s_waitcnt vmcnt(8)
v_mfma_f32_16x16x32_bf16 v[36:39], v[116:119], v[228:231], v[36:39]
ds_read_b64_tr_b16 v[132:133], v9 offset:46208
s_mov_b32 s39, 4423680
v_mfma_f32_16x16x32_bf16 v[32:35], v[116:119], v[224:227], v[32:35]
ds_read_b64_tr_b16 v[134:135], v9 offset:50816
s_waitcnt lgkmcnt(4)
v_mfma_f32_16x16x32_bf16 v[40:43], v[120:123], v[224:227], v[40:43]
ds_read_b64_tr_b16 v[104:105], v9 offset:46240
s_add_u32 m0, s37, 0
v_mfma_f32_16x16x32_bf16 v[44:47], v[120:123], v[228:231], v[44:47]
ds_read_b64_tr_b16 v[106:107], v9 offset:50848
buffer_load_dwordx4 v11, s[8:11], s39 offen lds
v_mfma_f32_16x16x32_bf16 v[52:55], v[124:127], v[228:231], v[52:55]
ds_read_b64_tr_b16 v[108:109], v9 offset:46272
s_add_u32 m0, s37, 4096
v_mfma_f32_16x16x32_bf16 v[48:51], v[124:127], v[224:227], v[48:51]
ds_read_b64_tr_b16 v[110:111], v9 offset:50880
s_waitcnt lgkmcnt(4)
v_mfma_f32_16x16x32_bf16 v[56:59], v[128:131], v[224:227], v[56:59]
ds_read_b64_tr_b16 v[112:113], v9 offset:46304
buffer_load_dwordx4 v12, s[8:11], s39 offen lds
v_mfma_f32_16x16x32_bf16 v[60:63], v[128:131], v[228:231], v[60:63]
ds_read_b64_tr_b16 v[114:115], v9 offset:50912
s_mov_b32 m0, 8192
v_mfma_f32_16x16x32_bf16 v[68:71], v[132:135], v[228:231], v[68:71]
ds_read_b64_tr_b16 v[116:117], v9 offset:46336
s_cmp_lg_u32 s29, 3
s_cbranch_scc1 Ld_20
buffer_load_dwordx4 v13, s[8:11], s39 offen lds
Ld_20:
v_mfma_f32_16x16x32_bf16 v[64:67], v[132:135], v[224:227], v[64:67]
ds_read_b64_tr_b16 v[118:119], v9 offset:50944
s_waitcnt lgkmcnt(4)
v_mfma_f32_16x16x32_bf16 v[72:75], v[104:107], v[224:227], v[72:75]
ds_read_b64_tr_b16 v[120:121], v10 offset:0
buffer_load_dwordx4 v[168:171], v7, s[16:19], s34 offen offset:0 sc1
v_mfma_f32_16x16x32_bf16 v[76:79], v[104:107], v[228:231], v[76:79]
ds_read_b64_tr_b16 v[122:123], v10 offset:4608
buffer_load_dwordx4 v[172:175], v7, s[16:19], s35 offen offset:0 sc1
v_mfma_f32_16x16x32_bf16 v[84:87], v[108:111], v[228:231], v[84:87]
ds_read_b64_tr_b16 v[124:125], v10 offset:32
v_mfma_f32_16x16x32_bf16 v[80:83], v[108:111], v[224:227], v[80:83]
ds_read_b64_tr_b16 v[126:127], v10 offset:4640
s_waitcnt lgkmcnt(4)
v_mfma_f32_16x16x32_bf16 v[88:91], v[112:115], v[224:227], v[88:91]
ds_read_b64_tr_b16 v[128:129], v10 offset:64
v_mfma_f32_16x16x32_bf16 v[92:95], v[112:115], v[228:231], v[92:95]
ds_read_b64_tr_b16 v[130:131], v10 offset:4672
v_mfma_f32_16x16x32_bf16 v[100:103], v[116:119], v[228:231], v[100:103]
ds_read_b64_tr_b16 v[132:133], v10 offset:96
v_mfma_f32_16x16x32_bf16 v[96:99], v[116:119], v[224:227], v[96:99]
ds_read_b64_tr_b16 v[134:135], v10 offset:4704
s_barrier
s_waitcnt vmcnt(10)
s_waitcnt lgkmcnt(4)
v_mfma_f32_16x16x32_bf16 v[32:35], v[120:123], v[136:139], v[32:35]
ds_read_b64_tr_b16 v[104:105], v10 offset:128
s_mov_b32 s39, 4718592
v_mfma_f32_16x16x32_bf16 v[36:39], v[120:123], v[140:143], v[36:39]
ds_read_b64_tr_b16 v[106:107], v10 offset:4736
s_add_u32 m0, s37, 9216
v_mfma_f32_16x16x32_bf16 v[44:47], v[124:127], v[140:143], v[44:47]
ds_read_b64_tr_b16 v[108:109], v10 offset:160
buffer_load_dwordx4 v11, s[8:11], s39 offen lds
v_mfma_f32_16x16x32_bf16 v[40:43], v[124:127], v[136:139], v[40:43]
ds_read_b64_tr_b16 v[110:111], v10 offset:4768
s_waitcnt lgkmcnt(4)
v_mfma_f32_16x16x32_bf16 v[48:51], v[128:131], v[136:139], v[48:51]
ds_read_b64_tr_b16 v[112:113], v10 offset:192
s_add_u32 m0, s37, 13312
v_mfma_f32_16x16x32_bf16 v[52:55], v[128:131], v[140:143], v[52:55]
ds_read_b64_tr_b16 v[114:115], v10 offset:4800
buffer_load_dwordx4 v12, s[8:11], s39 offen lds
v_mfma_f32_16x16x32_bf16 v[60:63], v[132:135], v[140:143], v[60:63]
ds_read_b64_tr_b16 v[116:117], v10 offset:224
s_mov_b32 m0, 17408
v_mfma_f32_16x16x32_bf16 v[56:59], v[132:135], v[136:139], v[56:59]
ds_read_b64_tr_b16 v[118:119], v10 offset:4832
s_waitcnt lgkmcnt(4)
v_mfma_f32_16x16x32_bf16 v[64:67], v[104:107], v[136:139], v[64:67]
ds_read_b64_tr_b16 v[120:121], v10 offset:256
s_cmp_lg_u32 s29, 0
s_cbranch_scc1 Ld_21
buffer_load_dwordx4 v13, s[8:11], s39 offen lds
Ld_21:
v_mfma_f32_16x16x32_bf16 v[68:71], v[104:107], v[140:143], v[68:71]
ds_read_b64_tr_b16 v[122:123], v10 offset:4864
buffer_load_dwordx4 v[176:179], v7, s[16:19], s34 offen offset:1024 sc1
v_mfma_f32_16x16x32_bf16 v[76:79], v[108:111], v[140:143], v[76:79]
ds_read_b64_tr_b16 v[124:125], v10 offset:9216
buffer_load_dwordx4 v[180:183], v7, s[16:19], s35 offen offset:1024 sc1
v_mfma_f32_16x16x32_bf16 v[72:75], v[108:111], v[136:139], v[72:75]
ds_read_b64_tr_b16 v[126:127], v10 offset:13824
s_waitcnt lgkmcnt(4)
v_mfma_f32_16x16x32_bf16 v[80:83], v[112:115], v[136:139], v[80:83]
ds_read_b64_tr_b16 v[128:129], v10 offset:9248
v_mfma_f32_16x16x32_bf16 v[84:87], v[112:115], v[140:143], v[84:87]
ds_read_b64_tr_b16 v[130:131], v10 offset:13856
v_mfma_f32_16x16x32_bf16 v[92:95], v[116:119], v[140:143], v[92:95]
ds_read_b64_tr_b16 v[132:133], v10 offset:9280
v_mfma_f32_16x16x32_bf16 v[88:91], v[116:119], v[136:139], v[88:91]
ds_read_b64_tr_b16 v[134:135], v10 offset:13888
s_waitcnt lgkmcnt(4)
v_mfma_f32_16x16x32_bf16 v[96:99], v[120:123], v[136:139], v[96:99]
ds_read_b64_tr_b16 v[104:105], v10 offset:9312
v_mfma_f32_16x16x32_bf16 v[100:103], v[120:123], v[140:143], v[100:103]
ds_read_b64_tr_b16 v[106:107], v10 offset:13920
s_barrier
s_waitcnt vmcnt(12)
v_mfma_f32_16x16x32_bf16 v[36:39], v[124:127], v[148:151], v[36:39]
ds_read_b64_tr_b16 v[108:109], v10 offset:9344
s_mov_b32 s39, 5013504
v_mfma_f32_16x16x32_bf16 v[32:35], v[124:127], v[144:147], v[32:35]
ds_read_b64_tr_b16 v[110:111], v10 offset:13952
s_waitcnt lgkmcnt(4)
v_mfma_f32_16x16x32_bf16 v[40:43], v[128:131], v[144:147], v[40:43]
ds_read_b64_tr_b16 v[112:113], v10 offset:9376
s_add_u32 m0, s37, 18432
v_mfma_f32_16x16x32_bf16 v[44:47], v[128:131], v[148:151], v[44:47]
ds_read_b64_tr_b16 v[114:115], v10 offset:13984
buffer_load_dwordx4 v11, s[8:11], s39 offen lds
v_mfma_f32_16x16x32_bf16 v[52:55], v[132:135], v[148:151], v[52:55]
ds_read_b64_tr_b16 v[116:117], v10 offset:9408
s_add_u32 m0, s37, 22528
v_mfma_f32_16x16x32_bf16 v[48:51], v[132:135], v[144:147], v[48:51]
ds_read_b64_tr_b16 v[118:119], v10 offset:14016
s_waitcnt lgkmcnt(4)
v_mfma_f32_16x16x32_bf16 v[56:59], v[104:107], v[144:147], v[56:59]
ds_read_b64_tr_b16 v[120:121], v10 offset:9440
buffer_load_dwordx4 v12, s[8:11], s39 offen lds
v_mfma_f32_16x16x32_bf16 v[60:63], v[104:107], v[148:151], v[60:63]
ds_read_b64_tr_b16 v[122:123], v10 offset:14048
s_mov_b32 m0, 26624
v_mfma_f32_16x16x32_bf16 v[68:71], v[108:111], v[148:151], v[68:71]
ds_read_b64_tr_b16 v[124:125], v10 offset:9472
s_cmp_lg_u32 s29, 1
s_cbranch_scc1 Ld_22
buffer_load_dwordx4 v13, s[8:11], s39 offen lds
Ld_22:
v_mfma_f32_16x16x32_bf16 v[64:67], v[108:111], v[144:147], v[64:67]
ds_read_b64_tr_b16 v[126:127], v10 offset:14080
s_waitcnt lgkmcnt(4)
v_mfma_f32_16x16x32_bf16 v[72:75], v[112:115], v[144:147], v[72:75]
ds_read_b64_tr_b16 v[128:129], v10 offset:18432
v_add_u32 v20, 50888704, v3
buffer_load_dwordx4 v[22:25], v20, s[16:19], 0 offen sc1
v_mfma_f32_16x16x32_bf16 v[76:79], v[112:115], v[148:151], v[76:79]
ds_read_b64_tr_b16 v[130:131], v10 offset:23040
v_mfma_f32_16x16x32_bf16 v[84:87], v[116:119], v[148:151], v[84:87]
ds_read_b64_tr_b16 v[132:133], v10 offset:18464
v_mfma_f32_16x16x32_bf16 v[80:83], v[116:119], v[144:147], v[80:83]
ds_read_b64_tr_b16 v[134:135], v10 offset:23072
s_waitcnt lgkmcnt(4)
v_mfma_f32_16x16x32_bf16 v[88:91], v[120:123], v[144:147], v[88:91]
ds_read_b64_tr_b16 v[104:105], v10 offset:18496
v_mfma_f32_16x16x32_bf16 v[92:95], v[120:123], v[148:151], v[92:95]
ds_read_b64_tr_b16 v[106:107], v10 offset:23104
v_mfma_f32_16x16x32_bf16 v[100:103], v[124:127], v[148:151], v[100:103]
ds_read_b64_tr_b16 v[108:109], v10 offset:18528
v_mfma_f32_16x16x32_bf16 v[96:99], v[124:127], v[144:147], v[96:99]
ds_read_b64_tr_b16 v[110:111], v10 offset:23136
s_waitcnt vmcnt(9)
s_barrier
s_waitcnt lgkmcnt(4)
v_mfma_f32_16x16x32_bf16 v[32:35], v[128:131], v[152:155], v[32:35]
ds_read_b64_tr_b16 v[112:113], v10 offset:18560
v_mfma_f32_16x16x32_bf16 v[36:39], v[128:131], v[156:159], v[36:39]
ds_read_b64_tr_b16 v[114:115], v10 offset:23168
v_mfma_f32_16x16x32_bf16 v[44:47], v[132:135], v[156:159], v[44:47]
ds_read_b64_tr_b16 v[116:117], v10 offset:18592
v_mfma_f32_16x16x32_bf16 v[40:43], v[132:135], v[152:155], v[40:43]
ds_read_b64_tr_b16 v[118:119], v10 offset:23200
s_waitcnt lgkmcnt(4)
v_mfma_f32_16x16x32_bf16 v[48:51], v[104:107], v[152:155], v[48:51]
ds_read_b64_tr_b16 v[120:121], v10 offset:18624
v_mfma_f32_16x16x32_bf16 v[52:55], v[104:107], v[156:159], v[52:55]
ds_read_b64_tr_b16 v[122:123], v10 offset:23232
v_mfma_f32_16x16x32_bf16 v[60:63], v[108:111], v[156:159], v[60:63]
ds_read_b64_tr_b16 v[124:125], v10 offset:18656
v_mfma_f32_16x16x32_bf16 v[56:59], v[108:111], v[152:155], v[56:59]
ds_read_b64_tr_b16 v[126:127], v10 offset:23264
s_waitcnt lgkmcnt(4)
v_mfma_f32_16x16x32_bf16 v[64:67], v[112:115], v[152:155], v[64:67]
ds_read_b64_tr_b16 v[128:129], v10 offset:18688
v_mfma_f32_16x16x32_bf16 v[68:71], v[112:115], v[156:159], v[68:71]
ds_read_b64_tr_b16 v[130:131], v10 offset:23296
v_mfma_f32_16x16x32_bf16 v[76:79], v[116:119], v[156:159], v[76:79]
ds_read_b64_tr_b16 v[132:133], v8 offset:0
v_mfma_f32_16x16x32_bf16 v[72:75], v[116:119], v[152:155], v[72:75]
ds_read_b64_tr_b16 v[134:135], v8 offset:4608
s_waitcnt lgkmcnt(4)
v_mfma_f32_16x16x32_bf16 v[80:83], v[120:123], v[152:155], v[80:83]
ds_read_b64_tr_b16 v[104:105], v8 offset:32
v_mfma_f32_16x16x32_bf16 v[84:87], v[120:123], v[156:159], v[84:87]
ds_read_b64_tr_b16 v[106:107], v8 offset:4640
v_mfma_f32_16x16x32_bf16 v[92:95], v[124:127], v[156:159], v[92:95]
ds_read_b64_tr_b16 v[108:109], v8 offset:64
v_mfma_f32_16x16x32_bf16 v[88:91], v[124:127], v[152:155], v[88:91]
ds_read_b64_tr_b16 v[110:111], v8 offset:4672
s_waitcnt lgkmcnt(4)
v_mfma_f32_16x16x32_bf16 v[96:99], v[128:131], v[152:155], v[96:99]
ds_read_b64_tr_b16 v[112:113], v8 offset:96
v_mfma_f32_16x16x32_bf16 v[100:103], v[128:131], v[156:159], v[100:103]
ds_read_b64_tr_b16 v[114:115], v8 offset:4704
s_waitcnt vmcnt(5)
s_barrier
v_mfma_f32_16x16x32_bf16 v[36:39], v[132:135], v[164:167], v[36:39]
ds_read_b64_tr_b16 v[116:117], v8 offset:128
v_mfma_f32_16x16x32_bf16 v[32:35], v[132:135], v[160:163], v[32:35]
ds_read_b64_tr_b16 v[118:119], v8 offset:4736
s_waitcnt lgkmcnt(4)
v_mfma_f32_16x16x32_bf16 v[40:43], v[104:107], v[160:163], v[40:43]
ds_read_b64_tr_b16 v[120:121], v8 offset:160
v_mfma_f32_16x16x32_bf16 v[44:47], v[104:107], v[164:167], v[44:47]
ds_read_b64_tr_b16 v[122:123], v8 offset:4768
v_mfma_f32_16x16x32_bf16 v[52:55], v[108:111], v[164:167], v[52:55]
ds_read_b64_tr_b16 v[124:125], v8 offset:192
v_mfma_f32_16x16x32_bf16 v[48:51], v[108:111], v[160:163], v[48:51]
ds_read_b64_tr_b16 v[126:127], v8 offset:4800
s_waitcnt lgkmcnt(4)
v_mfma_f32_16x16x32_bf16 v[56:59], v[112:115], v[160:163], v[56:59]
ds_read_b64_tr_b16 v[128:129], v8 offset:224
v_mfma_f32_16x16x32_bf16 v[60:63], v[112:115], v[164:167], v[60:63]
ds_read_b64_tr_b16 v[130:131], v8 offset:4832
v_mfma_f32_16x16x32_bf16 v[68:71], v[116:119], v[164:167], v[68:71]
ds_read_b64_tr_b16 v[132:133], v8 offset:256
v_mfma_f32_16x16x32_bf16 v[64:67], v[116:119], v[160:163], v[64:67]
ds_read_b64_tr_b16 v[134:135], v8 offset:4864
s_waitcnt lgkmcnt(4)
v_mfma_f32_16x16x32_bf16 v[72:75], v[120:123], v[160:163], v[72:75]
ds_read_b64_tr_b16 v[104:105], v8 offset:9216
v_mfma_f32_16x16x32_bf16 v[76:79], v[120:123], v[164:167], v[76:79]
ds_read_b64_tr_b16 v[106:107], v8 offset:13824
v_mfma_f32_16x16x32_bf16 v[84:87], v[124:127], v[164:167], v[84:87]
ds_read_b64_tr_b16 v[108:109], v8 offset:9248
v_mfma_f32_16x16x32_bf16 v[80:83], v[124:127], v[160:163], v[80:83]
ds_read_b64_tr_b16 v[110:111], v8 offset:13856
s_waitcnt lgkmcnt(4)
v_mfma_f32_16x16x32_bf16 v[88:91], v[128:131], v[160:163], v[88:91]
ds_read_b64_tr_b16 v[112:113], v8 offset:9280
v_mfma_f32_16x16x32_bf16 v[92:95], v[128:131], v[164:167], v[92:95]
ds_read_b64_tr_b16 v[114:115], v8 offset:13888
v_mfma_f32_16x16x32_bf16 v[100:103], v[132:135], v[164:167], v[100:103]
ds_read_b64_tr_b16 v[116:117], v8 offset:9312
v_mfma_f32_16x16x32_bf16 v[96:99], v[132:135], v[160:163], v[96:99]
ds_read_b64_tr_b16 v[118:119], v8 offset:13920
s_waitcnt vmcnt(1)
s_barrier
s_waitcnt vmcnt(0)
s_mov_b32 s58, 0x8000
LLp_23:
v_cmp_ne_u32 vcc, s68, v22
v_cmp_ne_u32 s[94:95], s68, v23
s_nop 1
s_or_b64 vcc, vcc, s[94:95]
v_cmp_ne_u32 s[94:95], s68, v24
s_nop 1
s_or_b64 vcc, vcc, s[94:95]
v_cmp_ne_u32 s[94:95], s68, v25
s_nop 1
s_or_b64 vcc, vcc, s[94:95]
s_nop 4
s_cbranch_vccz LBq_24
buffer_load_dwordx4 v[22:25], v20, s[16:19], 0 offen sc1
s_sub_u32 s58, s58, 1
s_waitcnt vmcnt(0)
s_cmp_gt_i32 s58, 0
s_cbranch_scc1 LLp_23
LBq_24:
s_waitcnt lgkmcnt(4)
v_mfma_f32_16x16x32_bf16 v[32:35], v[104:107], v[168:171], v[32:35]
ds_read_b64_tr_b16 v[120:121], v8 offset:9344
s_lshl_b32 s39, s52, 4
s_add_u32 s39, s39, 2621440
s_mul_i32 s38, s29, 3072
s_add_u32 m0, s38, 139680
s_nop 0
buffer_load_dwordx4 v232, s[16:19], s39 offen sc1 lds
s_add_u32 m0, s38, 140704
s_nop 0
buffer_load_dwordx4 v233, s[16:19], s39 offen sc1 lds
s_add_u32 m0, s38, 141728
s_nop 0
buffer_load_dwordx4 v234, s[16:19], s39 offen sc1 lds
v_mfma_f32_16x16x32_bf16 v[36:39], v[104:107], v[172:175], v[36:39]
ds_read_b64_tr_b16 v[122:123], v8 offset:13952
v_mfma_f32_16x16x32_bf16 v[44:47], v[108:111], v[172:175], v[44:47]
ds_read_b64_tr_b16 v[124:125], v8 offset:9376
v_mfma_f32_16x16x32_bf16 v[40:43], v[108:111], v[168:171], v[40:43]
ds_read_b64_tr_b16 v[126:127], v8 offset:13984
s_waitcnt lgkmcnt(4)
v_mfma_f32_16x16x32_bf16 v[48:51], v[112:115], v[168:171], v[48:51]
ds_read_b64_tr_b16 v[128:129], v8 offset:9408
v_mfma_f32_16x16x32_bf16 v[52:55], v[112:115], v[172:175], v[52:55]
ds_read_b64_tr_b16 v[130:131], v8 offset:14016
v_mfma_f32_16x16x32_bf16 v[60:63], v[116:119], v[172:175], v[60:63]
ds_read_b64_tr_b16 v[132:133], v8 offset:9440
v_mfma_f32_16x16x32_bf16 v[56:59], v[116:119], v[168:171], v[56:59]
ds_read_b64_tr_b16 v[134:135], v8 offset:14048
s_waitcnt lgkmcnt(4)
v_mfma_f32_16x16x32_bf16 v[64:67], v[120:123], v[168:171], v[64:67]
ds_read_b64_tr_b16 v[104:105], v8 offset:9472
v_mfma_f32_16x16x32_bf16 v[68:71], v[120:123], v[172:175], v[68:71]
ds_read_b64_tr_b16 v[106:107], v8 offset:14080
v_mfma_f32_16x16x32_bf16 v[76:79], v[124:127], v[172:175], v[76:79]
ds_read_b64_tr_b16 v[108:109], v8 offset:18432
v_mfma_f32_16x16x32_bf16 v[72:75], v[124:127], v[168:171], v[72:75]
ds_read_b64_tr_b16 v[110:111], v8 offset:23040
s_waitcnt lgkmcnt(4)
v_mfma_f32_16x16x32_bf16 v[80:83], v[128:131], v[168:171], v[80:83]
ds_read_b64_tr_b16 v[112:113], v8 offset:18464
v_mfma_f32_16x16x32_bf16 v[84:87], v[128:131], v[172:175], v[84:87]
ds_read_b64_tr_b16 v[114:115], v8 offset:23072
v_mfma_f32_16x16x32_bf16 v[92:95], v[132:135], v[172:175], v[92:95]
ds_read_b64_tr_b16 v[116:117], v8 offset:18496
v_mfma_f32_16x16x32_bf16 v[88:91], v[132:135], v[168:171], v[88:91]
ds_read_b64_tr_b16 v[118:119], v8 offset:23104
s_waitcnt lgkmcnt(4)
v_mfma_f32_16x16x32_bf16 v[96:99], v[104:107], v[168:171], v[96:99]
ds_read_b64_tr_b16 v[120:121], v8 offset:18528
v_mfma_f32_16x16x32_bf16 v[100:103], v[104:107], v[172:175], v[100:103]
ds_read_b64_tr_b16 v[122:123], v8 offset:23136
v_mfma_f32_16x16x32_bf16 v[36:39], v[108:111], v[180:183], v[36:39]
ds_read_b64_tr_b16 v[124:125], v8 offset:18560
v_mfma_f32_16x16x32_bf16 v[32:35], v[108:111], v[176:179], v[32:35]
ds_read_b64_tr_b16 v[126:127], v8 offset:23168
s_waitcnt lgkmcnt(4)
v_mfma_f32_16x16x32_bf16 v[40:43], v[112:115], v[176:179], v[40:43]
ds_read_b64_tr_b16 v[128:129], v8 offset:18592
v_mfma_f32_16x16x32_bf16 v[44:47], v[112:115], v[180:183], v[44:47]
ds_read_b64_tr_b16 v[130:131], v8 offset:23200
v_mfma_f32_16x16x32_bf16 v[52:55], v[116:119], v[180:183], v[52:55]
ds_read_b64_tr_b16 v[132:133], v8 offset:18624
v_mfma_f32_16x16x32_bf16 v[48:51], v[116:119], v[176:179], v[48:51]
ds_read_b64_tr_b16 v[134:135], v8 offset:23232
s_waitcnt lgkmcnt(4)
v_mfma_f32_16x16x32_bf16 v[56:59], v[120:123], v[176:179], v[56:59]
ds_read_b64_tr_b16 v[104:105], v8 offset:18656
v_mfma_f32_16x16x32_bf16 v[60:63], v[120:123], v[180:183], v[60:63]
ds_read_b64_tr_b16 v[106:107], v8 offset:23264
v_mfma_f32_16x16x32_bf16 v[68:71], v[124:127], v[180:183], v[68:71]
ds_read_b64_tr_b16 v[108:109], v8 offset:18688
v_mfma_f32_16x16x32_bf16 v[64:67], v[124:127], v[176:179], v[64:67]
ds_read_b64_tr_b16 v[110:111], v8 offset:23296
s_waitcnt lgkmcnt(4)
v_mfma_f32_16x16x32_bf16 v[72:75], v[128:131], v[176:179], v[72:75]
v_mfma_f32_16x16x32_bf16 v[76:79], v[128:131], v[180:183], v[76:79]
v_mfma_f32_16x16x32_bf16 v[84:87], v[132:135], v[180:183], v[84:87]
v_mfma_f32_16x16x32_bf16 v[80:83], v[132:135], v[176:179], v[80:83]
s_waitcnt lgkmcnt(0)
v_mfma_f32_16x16x32_bf16 v[88:91], v[104:107], v[176:179], v[88:91]
v_mfma_f32_16x16x32_bf16 v[92:95], v[104:107], v[180:183], v[92:95]
v_mfma_f32_16x16x32_bf16 v[100:103], v[108:111], v[180:183], v[100:103]
v_mfma_f32_16x16x32_bf16 v[96:99], v[108:111], v[176:179], v[96:99]
v_exp_f32 v20, -v32
v_exp_f32 v21, -v33
v_exp_f32 v22, -v34
v_exp_f32 v23, -v35
v_exp_f32 v24, -v36
v_exp_f32 v25, -v37
v_exp_f32 v26, -v38
v_exp_f32 v27, -v39
v_add_f32 v20, 1.0, v20
v_add_f32 v21, 1.0, v21
v_add_f32 v22, 1.0, v22
v_add_f32 v23, 1.0, v23
v_add_f32 v24, 1.0, v24
v_add_f32 v25, 1.0, v25
v_add_f32 v26, 1.0, v26
v_add_f32 v27, 1.0, v27
v_rcp_f32 v20, v20
v_rcp_f32 v21, v21
v_rcp_f32 v22, v22
v_rcp_f32 v23, v23
v_rcp_f32 v24, v24
v_rcp_f32 v25, v25
v_rcp_f32 v26, v26
v_rcp_f32 v27, v27
v_mul_f32 v20, v32, v20
v_mul_f32 v21, v33, v21
v_mul_f32 v22, v34, v22
v_mul_f32 v23, v35, v23
v_cvt_pk_bf16_f32 v136, v20, v21
v_cvt_pk_bf16_f32 v137, v22, v23
v_mul_f32 v24, v36, v24
v_mul_f32 v25, v37, v25
v_mul_f32 v26, v38, v26
v_mul_f32 v27, v39, v27
v_cvt_pk_bf16_f32 v140, v24, v25
v_cvt_pk_bf16_f32 v141, v26, v27
v_exp_f32 v20, -v40
v_exp_f32 v21, -v41
v_exp_f32 v22, -v42
v_exp_f32 v23, -v43
v_exp_f32 v24, -v44
v_exp_f32 v25, -v45
v_exp_f32 v26, -v46
v_exp_f32 v27, -v47
v_add_f32 v20, 1.0, v20
v_add_f32 v21, 1.0, v21
v_add_f32 v22, 1.0, v22
v_add_f32 v23, 1.0, v23
v_add_f32 v24, 1.0, v24
v_add_f32 v25, 1.0, v25
v_add_f32 v26, 1.0, v26
v_add_f32 v27, 1.0, v27
v_rcp_f32 v20, v20
v_rcp_f32 v21, v21
v_rcp_f32 v22, v22
v_rcp_f32 v23, v23
v_rcp_f32 v24, v24
v_rcp_f32 v25, v25
v_rcp_f32 v26, v26
v_rcp_f32 v27, v27
v_mul_f32 v20, v40, v20
v_mul_f32 v21, v41, v21
v_mul_f32 v22, v42, v22
v_mul_f32 v23, v43, v23
v_cvt_pk_bf16_f32 v138, v20, v21
v_cvt_pk_bf16_f32 v139, v22, v23
v_mul_f32 v24, v44, v24
v_mul_f32 v25, v45, v25
v_mul_f32 v26, v46, v26
v_mul_f32 v27, v47, v27
v_cvt_pk_bf16_f32 v142, v24, v25
v_cvt_pk_bf16_f32 v143, v26, v27
buffer_store_dwordx4 v[136:139], v3, s[16:19], s44 offen offset:0 sc1
buffer_store_dwordx4 v[140:143], v3, s[16:19], s44 offen offset:1024 sc1
v_exp_f32 v20, -v48
v_exp_f32 v21, -v49
v_exp_f32 v22, -v50
v_exp_f32 v23, -v51
v_exp_f32 v24, -v52
v_exp_f32 v25, -v53
v_exp_f32 v26, -v54
v_exp_f32 v27, -v55
v_add_f32 v20, 1.0, v20
v_add_f32 v21, 1.0, v21
v_add_f32 v22, 1.0, v22
v_add_f32 v23, 1.0, v23
v_add_f32 v24, 1.0, v24
v_add_f32 v25, 1.0, v25
v_add_f32 v26, 1.0, v26
v_add_f32 v27, 1.0, v27
v_rcp_f32 v20, v20
v_rcp_f32 v21, v21
v_rcp_f32 v22, v22
v_rcp_f32 v23, v23
v_rcp_f32 v24, v24
v_rcp_f32 v25, v25
v_rcp_f32 v26, v26
v_rcp_f32 v27, v27
v_mul_f32 v20, v48, v20
v_mul_f32 v21, v49, v21
v_mul_f32 v22, v50, v22
v_mul_f32 v23, v51, v23
v_cvt_pk_bf16_f32 v144, v20, v21
v_cvt_pk_bf16_f32 v145, v22, v23
v_mul_f32 v24, v52, v24
v_mul_f32 v25, v53, v25
v_mul_f32 v26, v54, v26
v_mul_f32 v27, v55, v27
v_cvt_pk_bf16_f32 v148, v24, v25
v_cvt_pk_bf16_f32 v149, v26, v27
v_exp_f32 v20, -v56
v_exp_f32 v21, -v57
v_exp_f32 v22, -v58
v_exp_f32 v23, -v59
v_exp_f32 v24, -v60
v_exp_f32 v25, -v61
v_exp_f32 v26, -v62
v_exp_f32 v27, -v63
v_add_f32 v20, 1.0, v20
v_add_f32 v21, 1.0, v21
v_add_f32 v22, 1.0, v22
v_add_f32 v23, 1.0, v23
v_add_f32 v24, 1.0, v24
v_add_f32 v25, 1.0, v25
v_add_f32 v26, 1.0, v26
v_add_f32 v27, 1.0, v27
v_rcp_f32 v20, v20
v_rcp_f32 v21, v21
v_rcp_f32 v22, v22
v_rcp_f32 v23, v23
v_rcp_f32 v24, v24
v_rcp_f32 v25, v25
v_rcp_f32 v26, v26
v_rcp_f32 v27, v27
v_mul_f32 v20, v56, v20
v_mul_f32 v21, v57, v21
v_mul_f32 v22, v58, v22
v_mul_f32 v23, v59, v23
v_cvt_pk_bf16_f32 v146, v20, v21
v_cvt_pk_bf16_f32 v147, v22, v23
v_mul_f32 v24, v60, v24
v_mul_f32 v25, v61, v25
v_mul_f32 v26, v62, v26
v_mul_f32 v27, v63, v27
v_cvt_pk_bf16_f32 v150, v24, v25
v_cvt_pk_bf16_f32 v151, v26, v27
buffer_store_dwordx4 v[144:147], v3, s[16:19], s44 offen offset:2048 sc1
buffer_store_dwordx4 v[148:151], v3, s[16:19], s44 offen offset:3072 sc1
s_mov_b32 s58, 0x100000
LLs_25:
ds_read_b32 v31, v0 offset:16
s_sub_u32 s58, s58, 1
s_waitcnt lgkmcnt(0)
v_cmp_gt_u32 vcc, 3, v31
s_nop 1
s_and_b32 s33, vcc_lo, 15
s_cbranch_scc0 LBs_26
s_sleep 2
s_cmp_gt_i32 s58, 0
s_cbranch_scc1 LLs_25
LBs_26:
s_add_u32 s39, s48, 0
s_add_u32 m0, s37, 36864
s_nop 0
buffer_load_dwordx4 v14, s[12:15], s39 offen lds
s_add_u32 m0, s37, 40960
s_nop 0
buffer_load_dwordx4 v15, s[12:15], s39 offen lds
s_mov_b32 m0, 45056
s_cmp_lg_u32 s29, 2
s_cbranch_scc1 Ld_27
buffer_load_dwordx4 v16, s[12:15], s39 offen lds
Ld_27:
v_exp_f32 v20, -v64
v_exp_f32 v21, -v65
v_exp_f32 v22, -v66
v_exp_f32 v23, -v67
v_exp_f32 v24, -v68
v_exp_f32 v25, -v69
v_exp_f32 v26, -v70
v_exp_f32 v27, -v71
v_add_f32 v20, 1.0, v20
v_add_f32 v21, 1.0, v21
v_add_f32 v22, 1.0, v22
v_add_f32 v23, 1.0, v23
v_add_f32 v24, 1.0, v24
v_add_f32 v25, 1.0, v25
v_add_f32 v26, 1.0, v26
v_add_f32 v27, 1.0, v27
v_rcp_f32 v20, v20
v_rcp_f32 v21, v21
v_rcp_f32 v22, v22
v_rcp_f32 v23, v23
v_rcp_f32 v24, v24
v_rcp_f32 v25, v25
v_rcp_f32 v26, v26
v_rcp_f32 v27, v27
v_mul_f32 v20, v64, v20
v_mul_f32 v21, v65, v21
v_mul_f32 v22, v66, v22
v_mul_f32 v23, v67, v23
v_cvt_pk_bf16_f32 v152, v20, v21
v_cvt_pk_bf16_f32 v153, v22, v23
v_mul_f32 v24, v68, v24
v_mul_f32 v25, v69, v25
v_mul_f32 v26, v70, v26
v_mul_f32 v27, v71, v27
v_cvt_pk_bf16_f32 v156, v24, v25
v_cvt_pk_bf16_f32 v157, v26, v27
s_add_u32 s39, s48, 36864
s_add_u32 m0, s37, 46080
s_nop 0
buffer_load_dwordx4 v14, s[12:15], s39 offen lds
s_add_u32 m0, s37, 50176
s_nop 0
buffer_load_dwordx4 v15, s[12:15], s39 offen lds
s_mov_b32 m0, 54272
s_cmp_lg_u32 s29, 3
s_cbranch_scc1 Ld_28
buffer_load_dwordx4 v16, s[12:15], s39 offen lds
Ld_28:
v_exp_f32 v20, -v72
v_exp_f32 v21, -v73
v_exp_f32 v22, -v74
v_exp_f32 v23, -v75
v_exp_f32 v24, -v76
v_exp_f32 v25, -v77
v_exp_f32 v26, -v78
v_exp_f32 v27, -v79
v_add_f32 v20, 1.0, v20
v_add_f32 v21, 1.0, v21
v_add_f32 v22, 1.0, v22
v_add_f32 v23, 1.0, v23
v_add_f32 v24, 1.0, v24
v_add_f32 v25, 1.0, v25
v_add_f32 v26, 1.0, v26
v_add_f32 v27, 1.0, v27
v_rcp_f32 v20, v20
v_rcp_f32 v21, v21
v_rcp_f32 v22, v22
v_rcp_f32 v23, v23
v_rcp_f32 v24, v24
v_rcp_f32 v25, v25
v_rcp_f32 v26, v26
v_rcp_f32 v27, v27
v_mul_f32 v20, v72, v20
v_mul_f32 v21, v73, v21
v_mul_f32 v22, v74, v22
v_mul_f32 v23, v75, v23
v_cvt_pk_bf16_f32 v154, v20, v21
v_cvt_pk_bf16_f32 v155, v22, v23
v_mul_f32 v24, v76, v24
v_mul_f32 v25, v77, v25
v_mul_f32 v26, v78, v26
v_mul_f32 v27, v79, v27
v_cvt_pk_bf16_f32 v158, v24, v25
v_cvt_pk_bf16_f32 v159, v26, v27
buffer_store_dwordx4 v[152:155], v4, s[16:19], s44 offen offset:0 sc1
buffer_store_dwordx4 v[156:159], v4, s[16:19], s44 offen offset:1024 sc1
s_add_u32 s39, s48, 73728
s_add_u32 m0, s37, 55296
s_nop 0
buffer_load_dwordx4 v14, s[12:15], s39 offen lds
s_add_u32 m0, s37, 59392
s_nop 0
buffer_load_dwordx4 v15, s[12:15], s39 offen lds
s_mov_b32 m0, 63488
s_cmp_lg_u32 s29, 0
s_cbranch_scc1 Ld_29
buffer_load_dwordx4 v16, s[12:15], s39 offen lds
Ld_29:
v_exp_f32 v20, -v80
v_exp_f32 v21, -v81
v_exp_f32 v22, -v82
v_exp_f32 v23, -v83
v_exp_f32 v24, -v84
v_exp_f32 v25, -v85
v_exp_f32 v26, -v86
v_exp_f32 v27, -v87
v_add_f32 v20, 1.0, v20
v_add_f32 v21, 1.0, v21
v_add_f32 v22, 1.0, v22
v_add_f32 v23, 1.0, v23
v_add_f32 v24, 1.0, v24
v_add_f32 v25, 1.0, v25
v_add_f32 v26, 1.0, v26
v_add_f32 v27, 1.0, v27
v_rcp_f32 v20, v20
v_rcp_f32 v21, v21
v_rcp_f32 v22, v22
v_rcp_f32 v23, v23
v_rcp_f32 v24, v24
v_rcp_f32 v25, v25
v_rcp_f32 v26, v26
v_rcp_f32 v27, v27
v_mul_f32 v20, v80, v20
v_mul_f32 v21, v81, v21
v_mul_f32 v22, v82, v22
v_mul_f32 v23, v83, v23
v_cvt_pk_bf16_f32 v160, v20, v21
v_cvt_pk_bf16_f32 v161, v22, v23
v_mul_f32 v24, v84, v24
v_mul_f32 v25, v85, v25
v_mul_f32 v26, v86, v26
v_mul_f32 v27, v87, v27
v_cvt_pk_bf16_f32 v164, v24, v25
v_cvt_pk_bf16_f32 v165, v26, v27
s_add_u32 s39, s48, 110592
s_add_u32 m0, s37, 64512
s_nop 0
buffer_load_dwordx4 v14, s[12:15], s39 offen lds
s_add_u32 m0, s37, 68608
s_nop 0
buffer_load_dwordx4 v15, s[12:15], s39 offen lds
s_mov_b32 m0, 72704
s_cmp_lg_u32 s29, 1
s_cbranch_scc1 Ld_30
buffer_load_dwordx4 v16, s[12:15], s39 offen lds
Ld_30:
s_mov_b32 s58, 0x100000
LLs_31:
ds_read_b32 v31, v0 offset:16
s_sub_u32 s58, s58, 1
s_waitcnt lgkmcnt(0)
v_cmp_gt_u32 vcc, 4, v31
s_nop 1
s_and_b32 s33, vcc_lo, 15
s_cbranch_scc0 LBs_32
s_sleep 2
s_cmp_gt_i32 s58, 0
s_cbranch_scc1 LLs_31
LBs_32:
v_mov_b32 v220, 0
v_mov_b32 v221, 0
v_mov_b32 v222, 0
v_mov_b32 v223, 0
s_cmp_eq_u32 s29, 3
s_cselect_b32 exec_lo, 0, 0xff
s_mov_b32 exec_hi, 0
ds_write_b128 v255, v[220:223]
s_mov_b64 exec, -1
ds_read_u16 v224, v240 offset:0
ds_read_u16 v225, v241 offset:0
ds_read_u16 v226, v242 offset:0
ds_read_u16 v227, v243 offset:0
ds_read_u16 v228, v244 offset:0
ds_read_u16 v229, v245 offset:0
ds_read_u16 v230, v246 offset:0
ds_read_u16 v231, v247 offset:0
ds_read_u16 v232, v248 offset:0
ds_read_u16 v233, v249 offset:0
ds_read_u16 v234, v250 offset:0
s_waitcnt lgkmcnt(0)
v_lshl_or_b32 v208, v225, 16, v224
v_lshl_or_b32 v209, v227, 16, v226
v_lshl_or_b32 v210, v229, 16, v228
v_lshl_or_b32 v211, v231, 16, v230
ds_write_b128 v251, v[208:211] offset:0
v_lshl_or_b32 v212, v226, 16, v225
v_lshl_or_b32 v213, v228, 16, v227
v_lshl_or_b32 v214, v230, 16, v229
v_lshl_or_b32 v215, v232, 16, v231
ds_write_b128 v251, v[212:215] offset:4160
v_lshl_or_b32 v216, v227, 16, v226
v_lshl_or_b32 v217, v229, 16, v228
v_lshl_or_b32 v218, v231, 16, v230
v_lshl_or_b32 v219, v233, 16, v232
ds_write_b128 v251, v[216:219] offset:8320
v_lshl_or_b32 v220, v228, 16, v227
v_lshl_or_b32 v221, v230, 16, v229
v_lshl_or_b32 v222, v232, 16, v231
v_lshl_or_b32 v223, v234, 16, v233
ds_write_b128 v251, v[220:223] offset:12480
s_waitcnt lgkmcnt(0)
s_waitcnt vmcnt(14)
v_mov_b32 v31, 1
s_mov_b64 exec, s[100:101]
ds_write_b32 v0, v31 offset:0
s_mov_b64 exec, -1
v_exp_f32 v20, -v88
v_exp_f32 v21, -v89
v_exp_f32 v22, -v90
v_exp_f32 v23, -v91
v_exp_f32 v24, -v92
v_exp_f32 v25, -v93
v_exp_f32 v26, -v94
v_exp_f32 v27, -v95
v_add_f32 v20, 1.0, v20
v_add_f32 v21, 1.0, v21
v_add_f32 v22, 1.0, v22
v_add_f32 v23, 1.0, v23
v_add_f32 v24, 1.0, v24
v_add_f32 v25, 1.0, v25
v_add_f32 v26, 1.0, v26
v_add_f32 v27, 1.0, v27
v_rcp_f32 v20, v20
v_rcp_f32 v21, v21
v_rcp_f32 v22, v22
v_rcp_f32 v23, v23
v_rcp_f32 v24, v24
v_rcp_f32 v25, v25
v_rcp_f32 v26, v26
v_rcp_f32 v27, v27
v_mul_f32 v20, v88, v20
v_mul_f32 v21, v89, v21
v_mul_f32 v22, v90, v22
v_mul_f32 v23, v91, v23
v_cvt_pk_bf16_f32 v162, v20, v21
v_cvt_pk_bf16_f32 v163, v22, v23
v_mul_f32 v24, v92, v24
v_mul_f32 v25, v93, v25
v_mul_f32 v26, v94, v26
v_mul_f32 v27, v95, v27
v_cvt_pk_bf16_f32 v166, v24, v25
v_cvt_pk_bf16_f32 v167, v26, v27
buffer_store_dwordx4 v[160:163], v4, s[16:19], s44 offen offset:2048 sc1
buffer_store_dwordx4 v[164:167], v4, s[16:19], s44 offen offset:3072 sc1
s_add_u32 s39, s49, 0
s_add_u32 m0, s37, 73728
s_nop 0
buffer_load_dwordx4 v14, s[12:15], s39 offen lds
s_add_u32 m0, s37, 77824
s_nop 0
buffer_load_dwordx4 v15, s[12:15], s39 offen lds
s_mov_b32 m0, 81920
s_cmp_lg_u32 s29, 2
s_cbranch_scc1 Ld_33
buffer_load_dwordx4 v16, s[12:15], s39 offen lds
Ld_33:
v_exp_f32 v20, -v96
v_exp_f32 v21, -v97
v_exp_f32 v22, -v98
v_exp_f32 v23, -v99
v_exp_f32 v24, -v100
v_exp_f32 v25, -v101
v_exp_f32 v26, -v102
v_exp_f32 v27, -v103
v_add_f32 v20, 1.0, v20
v_add_f32 v21, 1.0, v21
v_add_f32 v22, 1.0, v22
v_add_f32 v23, 1.0, v23
v_add_f32 v24, 1.0, v24
v_add_f32 v25, 1.0, v25
v_add_f32 v26, 1.0, v26
v_add_f32 v27, 1.0, v27
v_rcp_f32 v20, v20
v_rcp_f32 v21, v21
v_rcp_f32 v22, v22
v_rcp_f32 v23, v23
v_rcp_f32 v24, v24
v_rcp_f32 v25, v25
v_rcp_f32 v26, v26
v_rcp_f32 v27, v27
v_mul_f32 v20, v96, v20
v_mul_f32 v21, v97, v21
v_mul_f32 v22, v98, v22
v_mul_f32 v23, v99, v23
v_cvt_pk_bf16_f32 v200, v20, v21
v_cvt_pk_bf16_f32 v201, v22, v23
v_cvt_pk_bf16_f32 v28, v20, v21
v_cvt_pk_bf16_f32 v29, v22, v23
v_mul_f32 v24, v100, v24
v_mul_f32 v25, v101, v25
v_mul_f32 v26, v102, v26
v_mul_f32 v27, v103, v27
v_cvt_pk_bf16_f32 v204, v24, v25
v_cvt_pk_bf16_f32 v205, v26, v27
v_cvt_pk_bf16_f32 v30, v24, v25
v_cvt_pk_bf16_f32 v31, v26, v27
buffer_store_dwordx4 v[28:31], v5, s[16:19], s44 offen sc1
s_andn2_b32 s33, s96, 3
s_add_u32 s33, s33, 12582912
v_add_lshl_u32 v20, s33, v2, 2
s_mov_b32 s58, 0x100000
LLs_34:
ds_read_b32 v31, v0 offset:0
s_sub_u32 s58, s58, 1
s_waitcnt lgkmcnt(0)
v_cmp_gt_u32 vcc, 1, v31
s_nop 1
s_and_b32 s33, vcc_lo, 15
s_cbranch_scc0 LBs_35
s_sleep 2
s_cmp_gt_i32 s58, 0
s_cbranch_scc1 LLs_34
LBs_35:
s_setprio 1
s_mul_i32 s33, s31, 1536
v_subrev_u32 v22, s33, v253
s_sub_u32 s33, s33, 4608
v_add_u32 v23, s33, v253
v_add_u32 v24, 152064, v254
ds_read_b64 v[208:209], v252 offset:3840
ds_read_b64 v[210:211], v252 offset:3848
ds_read_b128 v[68:71], v253 offset:768
ds_read_b128 v[76:79], v253 offset:2304
ds_read_b128 v[84:87], v253 offset:3840
ds_read_b128 v[92:95], v253 offset:5376
ds_read_b128 v[100:103], v253 offset:6912
ds_read_b128 v[108:111], v253 offset:8448
ds_read_b128 v[116:119], v253 offset:9984
ds_read_b128 v[124:127], v253 offset:11520
ds_read_b64 v[212:213], v252 offset:3584
ds_read_b64 v[214:215], v252 offset:3592
s_waitcnt lgkmcnt(9)
v_mfma_f32_16x16x32_bf16 v[32:35], v[208:211], v[68:71], 0
ds_read_b128 v[64:67], v253 offset:0
s_waitcnt lgkmcnt(9)
v_mfma_f32_16x16x32_bf16 v[36:39], v[208:211], v[76:79], 0
ds_read_b128 v[72:75], v253 offset:1536
s_waitcnt lgkmcnt(9)
v_mfma_f32_16x16x32_bf16 v[40:43], v[208:211], v[84:87], 0
ds_read_b128 v[80:83], v253 offset:3072
s_waitcnt lgkmcnt(9)
v_mfma_f32_16x16x32_bf16 v[44:47], v[208:211], v[92:95], 0
ds_read_b128 v[88:91], v253 offset:4608
s_waitcnt lgkmcnt(9)
v_mfma_f32_16x16x32_bf16 v[48:51], v[208:211], v[100:103], 0
ds_read_b128 v[96:99], v253 offset:6144
s_waitcnt lgkmcnt(9)
v_mfma_f32_16x16x32_bf16 v[52:55], v[208:211], v[108:111], 0
ds_read_b128 v[104:107], v253 offset:7680
s_waitcnt lgkmcnt(9)
v_mfma_f32_16x16x32_bf16 v[56:59], v[208:211], v[116:119], 0
ds_read_b128 v[112:115], v253 offset:9216
s_waitcnt lgkmcnt(9)
v_mfma_f32_16x16x32_bf16 v[60:63], v[208:211], v[124:127], 0
ds_read_b128 v[120:123], v253 offset:10752
s_waitcnt lgkmcnt(7)
v_mfma_f32_16x16x32_bf16 v[32:35], v[212:215], v[64:67], v[32:35]
ds_read_b64 v[216:217], v252 offset:3328
ds_read_b64 v[218:219], v252 offset:3336
s_waitcnt lgkmcnt(8)
v_mfma_f32_16x16x32_bf16 v[36:39], v[212:215], v[72:75], v[36:39]
ds_read_b64 v[220:221], v252 offset:3072
ds_read_b64 v[222:223], v252 offset:3080
s_waitcnt lgkmcnt(9)
v_mfma_f32_16x16x32_bf16 v[40:43], v[212:215], v[80:83], v[40:43]
ds_read_b64 v[224:225], v252 offset:2816
ds_read_b64 v[226:227], v252 offset:2824
s_waitcnt lgkmcnt(10)
v_mfma_f32_16x16x32_bf16 v[44:47], v[212:215], v[88:91], v[44:47]
ds_read_b64 v[228:229], v252 offset:2560
ds_read_b64 v[230:231], v252 offset:2568
s_waitcnt lgkmcnt(11)
v_mfma_f32_16x16x32_bf16 v[48:51], v[212:215], v[96:99], v[48:51]
ds_read_b64 v[232:233], v252 offset:2304
ds_read_b64 v[234:235], v252 offset:2312
s_waitcnt lgkmcnt(12)
v_mfma_f32_16x16x32_bf16 v[52:55], v[212:215], v[104:107], v[52:55]
ds_read_b64 v[236:237], v252 offset:2048
ds_read_b64 v[238:239], v252 offset:2056
s_waitcnt lgkmcnt(13)
v_mfma_f32_16x16x32_bf16 v[56:59], v[212:215], v[112:115], v[56:59]
ds_read_b64 v[208:209], v252 offset:1792
ds_read_b64 v[210:211], v252 offset:1800
s_waitcnt lgkmcnt(14)
v_mfma_f32_16x16x32_bf16 v[60:63], v[212:215], v[120:123], v[60:63]
ds_read_b64 v[212:213], v252 offset:1536
ds_read_b64 v[214:215], v252 offset:1544
s_waitcnt lgkmcnt(14)
v_mfma_f32_16x16x32_bf16 v[36:39], v[216:219], v[68:71], v[36:39]
ds_read_b128 v[124:127], v253 offset:11536
v_mfma_f32_16x16x32_bf16 v[40:43], v[216:219], v[76:79], v[40:43]
ds_read_b128 v[120:123], v253 offset:10768
v_mfma_f32_16x16x32_bf16 v[44:47], v[216:219], v[84:87], v[44:47]
v_mfma_f32_16x16x32_bf16 v[48:51], v[216:219], v[92:95], v[48:51]
v_mfma_f32_16x16x32_bf16 v[52:55], v[216:219], v[100:103], v[52:55]
v_mfma_f32_16x16x32_bf16 v[56:59], v[216:219], v[108:111], v[56:59]
v_mfma_f32_16x16x32_bf16 v[60:63], v[216:219], v[116:119], v[60:63]
ds_read_b64 v[216:217], v252 offset:1280
ds_read_b64 v[218:219], v252 offset:1288
s_waitcnt lgkmcnt(15)
v_mfma_f32_16x16x32_bf16 v[36:39], v[220:223], v[64:67], v[36:39]
ds_read_b128 v[116:119], v253 offset:10000
v_mfma_f32_16x16x32_bf16 v[40:43], v[220:223], v[72:75], v[40:43]
v_mfma_f32_16x16x32_bf16 v[44:47], v[220:223], v[80:83], v[44:47]
v_mfma_f32_16x16x32_bf16 v[48:51], v[220:223], v[88:91], v[48:51]
v_mfma_f32_16x16x32_bf16 v[52:55], v[220:223], v[96:99], v[52:55]
v_mfma_f32_16x16x32_bf16 v[56:59], v[220:223], v[104:107], v[56:59]
v_mfma_f32_16x16x32_bf16 v[60:63], v[220:223], v[112:115], v[60:63]
ds_read_b64 v[220:221], v252 offset:1024
ds_read_b64 v[222:223], v252 offset:1032
s_waitcnt lgkmcnt(15)
v_mfma_f32_16x16x32_bf16 v[40:43], v[224:227], v[68:71], v[40:43]
ds_read_b128 v[112:115], v253 offset:9232
v_mfma_f32_16x16x32_bf16 v[44:47], v[224:227], v[76:79], v[44:47]
v_mfma_f32_16x16x32_bf16 v[48:51], v[224:227], v[84:87], v[48:51]
v_mfma_f32_16x16x32_bf16 v[52:55], v[224:227], v[92:95], v[52:55]
v_mfma_f32_16x16x32_bf16 v[56:59], v[224:227], v[100:103], v[56:59]
v_mfma_f32_16x16x32_bf16 v[60:63], v[224:227], v[108:111], v[60:63]
ds_read_b64 v[224:225], v252 offset:768
ds_read_b64 v[226:227], v252 offset:776
s_waitcnt lgkmcnt(15)
v_mfma_f32_16x16x32_bf16 v[40:43], v[228:231], v[64:67], v[40:43]
ds_read_b128 v[108:111], v253 offset:8464
v_mfma_f32_16x16x32_bf16 v[44:47], v[228:231], v[72:75], v[44:47]
v_mfma_f32_16x16x32_bf16 v[48:51], v[228:231], v[80:83], v[48:51]
v_mfma_f32_16x16x32_bf16 v[52:55], v[228:231], v[88:91], v[52:55]
v_mfma_f32_16x16x32_bf16 v[56:59], v[228:231], v[96:99], v[56:59]
v_mfma_f32_16x16x32_bf16 v[60:63], v[228:231], v[104:107], v[60:63]
ds_read_b64 v[228:229], v252 offset:512
ds_read_b64 v[230:231], v252 offset:520
s_waitcnt lgkmcnt(15)
v_mfma_f32_16x16x32_bf16 v[44:47], v[232:235], v[68:71], v[44:47]
ds_read_b128 v[104:107], v253 offset:7696
s_waitcnt vmcnt(0)
v_mfma_f32_16x16x32_bf16 v[48:51], v[232:235], v[76:79], v[48:51]
s_lshl_b32 s33, s96, 2
s_add_u32 s33, s33, 50331648
v_mov_b32 v30, 0
v_mov_b32 v31, s68
s_mov_b64 exec, 1
buffer_store_dword v31, v30, s[16:19], s33 offen sc1
s_mov_b64 exec, -1
v_mfma_f32_16x16x32_bf16 v[52:55], v[232:235], v[84:87], v[52:55]
v_mfma_f32_16x16x32_bf16 v[56:59], v[232:235], v[92:95], v[56:59]
v_mfma_f32_16x16x32_bf16 v[60:63], v[232:235], v[100:103], v[60:63]
ds_read_b32 v30, v0 offset:16
s_waitcnt lgkmcnt(15)
v_mfma_f32_16x16x32_bf16 v[44:47], v[236:239], v[64:67], v[44:47]
ds_read_b64 v[232:233], v252 offset:256
ds_read_b64 v[234:235], v252 offset:264
v_mfma_f32_16x16x32_bf16 v[48:51], v[236:239], v[72:75], v[48:51]
ds_read_b128 v[100:103], v253 offset:6928
v_mfma_f32_16x16x32_bf16 v[52:55], v[236:239], v[80:83], v[52:55]
v_mfma_f32_16x16x32_bf16 v[56:59], v[236:239], v[88:91], v[56:59]
v_mfma_f32_16x16x32_bf16 v[60:63], v[236:239], v[96:99], v[60:63]
ds_read_b64 v[236:237], v252 offset:0
ds_read_b64 v[238:239], v252 offset:8
s_waitcnt lgkmcnt(15)
v_mfma_f32_16x16x32_bf16 v[48:51], v[208:211], v[68:71], v[48:51]
ds_read_b128 v[96:99], v253 offset:6160
v_mfma_f32_16x16x32_bf16 v[52:55], v[208:211], v[76:79], v[52:55]
v_mfma_f32_16x16x32_bf16 v[56:59], v[208:211], v[84:87], v[56:59]
v_mfma_f32_16x16x32_bf16 v[60:63], v[208:211], v[92:95], v[60:63]
ds_read_b128 v[92:95], v253 offset:5392
s_waitcnt lgkmcnt(15)
v_mfma_f32_16x16x32_bf16 v[48:51], v[212:215], v[64:67], v[48:51]
v_mfma_f32_16x16x32_bf16 v[52:55], v[212:215], v[72:75], v[52:55]
v_mfma_f32_16x16x32_bf16 v[56:59], v[212:215], v[80:83], v[56:59]
v_mfma_f32_16x16x32_bf16 v[60:63], v[212:215], v[88:91], v[60:63]
ds_read_b128 v[88:91], v253 offset:4624
s_waitcnt lgkmcnt(8)
v_cmp_gt_u32 vcc, 5, v30
s_nop 1
s_and_b32 s33, vcc_lo, 15
s_cbranch_scc0 LBc_36
s_mov_b32 s58, 0x100000
LLs_37:
ds_read_b32 v31, v0 offset:16
s_sub_u32 s58, s58, 1
s_waitcnt lgkmcnt(0)
v_cmp_gt_u32 vcc, 5, v31
s_nop 1
s_and_b32 s33, vcc_lo, 15
s_cbranch_scc0 LBs_38
s_sleep 2
s_cmp_gt_i32 s58, 0
s_cbranch_scc1 LLs_37
LBs_38:
LBc_36:
v_mfma_f32_16x16x32_bf16 v[52:55], v[216:219], v[68:71], v[52:55]
ds_read_b64 v[208:209], v252 offset:22272
ds_read_b64 v[210:211], v252 offset:22280
v_mfma_f32_16x16x32_bf16 v[56:59], v[216:219], v[76:79], v[56:59]
ds_write_b128 v254, v[48:51] offset:16384
v_mfma_f32_16x16x32_bf16 v[60:63], v[216:219], v[84:87], v[60:63]
ds_read_b128 v[84:87], v253 offset:3856
v_mfma_f32_16x16x32_bf16 v[52:55], v[220:223], v[64:67], v[52:55]
ds_read_b64 v[212:213], v252 offset:22016
ds_read_b64 v[214:215], v252 offset:22024
v_mfma_f32_16x16x32_bf16 v[56:59], v[220:223], v[72:75], v[56:59]
ds_write_b128 v254, v[44:47] offset:12288
v_mfma_f32_16x16x32_bf16 v[60:63], v[220:223], v[80:83], v[60:63]
s_nop 2
ds_write_b128 v254, v[52:55] offset:20480
v_mfma_f32_16x16x32_bf16 v[56:59], v[224:227], v[68:71], v[56:59]
ds_write_b128 v254, v[40:43] offset:8192
v_mfma_f32_16x16x32_bf16 v[60:63], v[224:227], v[76:79], v[60:63]
ds_read_b128 v[76:79], v253 offset:2320
v_mfma_f32_16x16x32_bf16 v[56:59], v[228:231], v[64:67], v[56:59]
ds_read_b128 v[80:83], v253 offset:3088
v_mfma_f32_16x16x32_bf16 v[60:63], v[228:231], v[72:75], v[60:63]
ds_read_b128 v[72:75], v253 offset:1552
s_waitcnt lgkmcnt(15)
v_mfma_f32_16x16x32_bf16 v[60:63], v[232:235], v[68:71], v[60:63]
ds_read_b128 v[68:71], v253 offset:784
s_waitcnt lgkmcnt(15)
v_mfma_f32_16x16x32_bf16 v[60:63], v[236:239], v[64:67], v[60:63]
ds_read_b128 v[64:67], v253 offset:16
s_waitcnt lgkmcnt(12)
v_mfma_f32_16x16x32_bf16 v[52:55], v[208:211], v[108:111], 0
ds_write_b128 v254, v[56:59] offset:24576
s_mov_b64 exec, 0xf
buffer_load_dword v21, v20, s[16:19], 0 offen sc1
s_mov_b64 exec, -1
v_mfma_f32_16x16x32_bf16 v[48:51], v[208:211], v[100:103], 0
ds_write_b128 v254, v[36:39] offset:4096
v_mfma_f32_16x16x32_bf16 v[44:47], v[208:211], v[92:95], 0
ds_write_b128 v254, v[60:63] offset:28672
s_waitcnt lgkmcnt(13)
v_mfma_f32_16x16x32_bf16 v[40:43], v[208:211], v[84:87], 0
ds_write_b128 v254, v[32:35] offset:0
v_mfma_f32_16x16x32_bf16 v[56:59], v[208:211], v[116:119], 0
ds_read_b64 v[216:217], v252 offset:21760
ds_read_b64 v[218:219], v252 offset:21768
s_waitcnt lgkmcnt(10)
v_mfma_f32_16x16x32_bf16 v[36:39], v[208:211], v[76:79], 0
ds_read_b64 v[220:221], v252 offset:21504
ds_read_b64 v[222:223], v252 offset:21512
v_mfma_f32_16x16x32_bf16 v[60:63], v[208:211], v[124:127], 0
ds_read_b64 v[224:225], v252 offset:21248
ds_read_b64 v[226:227], v252 offset:21256
s_waitcnt lgkmcnt(11)
v_mfma_f32_16x16x32_bf16 v[32:35], v[208:211], v[68:71], 0
ds_read_b64 v[228:229], v252 offset:20992
ds_read_b64 v[230:231], v252 offset:21000
s_waitcnt lgkmcnt(12)
v_mfma_f32_16x16x32_bf16 v[32:35], v[212:215], v[64:67], v[32:35]
ds_read_b64 v[232:233], v252 offset:20736
ds_read_b64 v[234:235], v252 offset:20744
v_mfma_f32_16x16x32_bf16 v[36:39], v[212:215], v[72:75], v[36:39]
ds_read_b64 v[236:237], v252 offset:20480
ds_read_b64 v[238:239], v252 offset:20488
v_mfma_f32_16x16x32_bf16 v[40:43], v[212:215], v[80:83], v[40:43]
ds_read_b64 v[208:209], v252 offset:20224
ds_read_b64 v[210:211], v252 offset:20232
v_mfma_f32_16x16x32_bf16 v[44:47], v[212:215], v[88:91], v[44:47]
ds_read_b128 v[124:127], v22 offset:11552
s_waitcnt lgkmcnt(15)
v_mov_b32 v31, 2
s_mov_b64 exec, s[100:101]
ds_write_b32 v0, v31 offset:0
s_mov_b64 exec, -1
v_mfma_f32_16x16x32_bf16 v[48:51], v[212:215], v[96:99], v[48:51]
v_mfma_f32_16x16x32_bf16 v[52:55], v[212:215], v[104:107], v[52:55]
v_mfma_f32_16x16x32_bf16 v[56:59], v[212:215], v[112:115], v[56:59]
v_mfma_f32_16x16x32_bf16 v[60:63], v[212:215], v[120:123], v[60:63]
ds_read_b64 v[212:213], v252 offset:19968
ds_read_b64 v[214:215], v252 offset:19976
s_waitcnt lgkmcnt(15)
v_mfma_f32_16x16x32_bf16 v[36:39], v[216:219], v[68:71], v[36:39]
ds_read_b128 v[120:123], v22 offset:10784
v_mfma_f32_16x16x32_bf16 v[40:43], v[216:219], v[76:79], v[40:43]
v_mfma_f32_16x16x32_bf16 v[44:47], v[216:219], v[84:87], v[44:47]
v_mfma_f32_16x16x32_bf16 v[48:51], v[216:219], v[92:95], v[48:51]
v_mfma_f32_16x16x32_bf16 v[52:55], v[216:219], v[100:103], v[52:55]
v_mfma_f32_16x16x32_bf16 v[56:59], v[216:219], v[108:111], v[56:59]
v_mfma_f32_16x16x32_bf16 v[60:63], v[216:219], v[116:119], v[60:63]
ds_read_b64 v[216:217], v252 offset:19712
ds_read_b64 v[218:219], v252 offset:19720
s_waitcnt lgkmcnt(15)
v_mfma_f32_16x16x32_bf16 v[36:39], v[220:223], v[64:67], v[36:39]
ds_read_b128 v[116:119], v22 offset:10016
v_mfma_f32_16x16x32_bf16 v[40:43], v[220:223], v[72:75], v[40:43]
v_mfma_f32_16x16x32_bf16 v[44:47], v[220:223], v[80:83], v[44:47]
v_mfma_f32_16x16x32_bf16 v[48:51], v[220:223], v[88:91], v[48:51]
v_mfma_f32_16x16x32_bf16 v[52:55], v[220:223], v[96:99], v[52:55]
v_mfma_f32_16x16x32_bf16 v[56:59], v[220:223], v[104:107], v[56:59]
v_mfma_f32_16x16x32_bf16 v[60:63], v[220:223], v[112:115], v[60:63]
ds_read_b64 v[220:221], v252 offset:19456
ds_read_b64 v[222:223], v252 offset:19464
s_waitcnt lgkmcnt(15)
v_mfma_f32_16x16x32_bf16 v[40:43], v[224:227], v[68:71], v[40:43]
ds_read_b128 v[112:115], v22 offset:9248
s_waitcnt vmcnt(0)
s_mov_b64 exec, 0xf
s_mov_b32 s58, 0x8000
LLp_39:
v_cmp_ne_u32 vcc, s68, v21
s_nop 4
s_cbranch_vccz LBq_40
buffer_load_dword v21, v20, s[16:19], 0 offen sc1
s_sub_u32 s58, s58, 1
s_waitcnt vmcnt(0)
s_cmp_gt_i32 s58, 0
s_cbranch_scc1 LLp_39
LBq_40:
s_mov_b64 exec, -1
v_mfma_f32_16x16x32_bf16 v[44:47], v[224:227], v[76:79], v[44:47]
buffer_load_dwordx4 v[168:171], v3, s[16:19], s45 offen offset:0 sc1
v_mfma_f32_16x16x32_bf16 v[48:51], v[224:227], v[84:87], v[48:51]
buffer_load_dwordx4 v[172:175], v3, s[16:19], s45 offen offset:1024 sc1
v_mfma_f32_16x16x32_bf16 v[52:55], v[224:227], v[92:95], v[52:55]
v_mfma_f32_16x16x32_bf16 v[56:59], v[224:227], v[100:103], v[56:59]
v_mfma_f32_16x16x32_bf16 v[60:63], v[224:227], v[108:111], v[60:63]
ds_read_b64 v[224:225], v252 offset:19200
ds_read_b64 v[226:227], v252 offset:19208
s_waitcnt lgkmcnt(15)
v_mfma_f32_16x16x32_bf16 v[40:43], v[228:231], v[64:67], v[40:43]
ds_read_b128 v[108:111], v22 offset:8480
v_mfma_f32_16x16x32_bf16 v[44:47], v[228:231], v[72:75], v[44:47]
v_mfma_f32_16x16x32_bf16 v[48:51], v[228:231], v[80:83], v[48:51]
v_mfma_f32_16x16x32_bf16 v[52:55], v[228:231], v[88:91], v[52:55]
v_mfma_f32_16x16x32_bf16 v[56:59], v[228:231], v[96:99], v[56:59]
v_mfma_f32_16x16x32_bf16 v[60:63], v[228:231], v[104:107], v[60:63]
ds_read_b64 v[228:229], v252 offset:18944
ds_read_b64 v[230:231], v252 offset:18952
s_waitcnt lgkmcnt(15)
v_mfma_f32_16x16x32_bf16 v[44:47], v[232:235], v[68:71], v[44:47]
ds_read_b128 v[104:107], v22 offset:7712
buffer_load_dwordx4 v[176:179], v3, s[16:19], s45 offen offset:2048 sc1
v_mfma_f32_16x16x32_bf16 v[48:51], v[232:235], v[76:79], v[48:51]
buffer_load_dwordx4 v[180:183], v3, s[16:19], s45 offen offset:3072 sc1
v_mfma_f32_16x16x32_bf16 v[52:55], v[232:235], v[84:87], v[52:55]
v_mfma_f32_16x16x32_bf16 v[56:59], v[232:235], v[92:95], v[56:59]
v_mfma_f32_16x16x32_bf16 v[60:63], v[232:235], v[100:103], v[60:63]
ds_read_b32 v30, v0 offset:16
s_waitcnt lgkmcnt(15)
v_mfma_f32_16x16x32_bf16 v[44:47], v[236:239], v[64:67], v[44:47]
ds_read_b64 v[232:233], v252 offset:18688
ds_read_b64 v[234:235], v252 offset:18696
v_mfma_f32_16x16x32_bf16 v[48:51], v[236:239], v[72:75], v[48:51]
ds_read_b128 v[100:103], v22 offset:6944
v_mfma_f32_16x16x32_bf16 v[52:55], v[236:239], v[80:83], v[52:55]
v_mfma_f32_16x16x32_bf16 v[56:59], v[236:239], v[88:91], v[56:59]
v_mfma_f32_16x16x32_bf16 v[60:63], v[236:239], v[96:99], v[60:63]
ds_read_b64 v[236:237], v252 offset:18432
ds_read_b64 v[238:239], v252 offset:18440
s_waitcnt lgkmcnt(15)
v_mfma_f32_16x16x32_bf16 v[48:51], v[208:211], v[68:71], v[48:51]
ds_read_b128 v[96:99], v22 offset:6176
v_mfma_f32_16x16x32_bf16 v[52:55], v[208:211], v[76:79], v[52:55]
buffer_load_dwordx4 v[184:187], v4, s[16:19], s45 offen offset:0 sc1
v_mfma_f32_16x16x32_bf16 v[56:59], v[208:211], v[84:87], v[56:59]
buffer_load_dwordx4 v[188:191], v4, s[16:19], s45 offen offset:1024 sc1
v_mfma_f32_16x16x32_bf16 v[60:63], v[208:211], v[92:95], v[60:63]
ds_read_b128 v[92:95], v22 offset:5408
s_waitcnt lgkmcnt(15)
v_mfma_f32_16x16x32_bf16 v[48:51], v[212:215], v[64:67], v[48:51]
v_mfma_f32_16x16x32_bf16 v[52:55], v[212:215], v[72:75], v[52:55]
v_mfma_f32_16x16x32_bf16 v[56:59], v[212:215], v[80:83], v[56:59]
v_mfma_f32_16x16x32_bf16 v[60:63], v[212:215], v[88:91], v[60:63]
ds_read_b128 v[88:91], v22 offset:4640
s_waitcnt lgkmcnt(8)
v_cmp_gt_u32 vcc, 7, v30
s_nop 1
s_and_b32 s33, vcc_lo, 15
s_cbranch_scc0 LBc_41
s_mov_b32 s58, 0x100000
LLs_42:
ds_read_b32 v31, v0 offset:16
s_sub_u32 s58, s58, 1
s_waitcnt lgkmcnt(0)
v_cmp_gt_u32 vcc, 7, v31
s_nop 1
s_and_b32 s33, vcc_lo, 15
s_cbranch_scc0 LBs_43
s_sleep 2
s_cmp_gt_i32 s58, 0
s_cbranch_scc1 LLs_42
LBs_43:
LBc_41:
v_mfma_f32_16x16x32_bf16 v[52:55], v[216:219], v[68:71], v[52:55]
ds_write_b128 v254, v[32:35] offset:0
buffer_load_dwordx4 v[192:195], v4, s[16:19], s45 offen offset:2048 sc1
v_mfma_f32_16x16x32_bf16 v[56:59], v[216:219], v[76:79], v[56:59]
ds_write_b128 v254, v[36:39] offset:4096
v_mfma_f32_16x16x32_bf16 v[60:63], v[216:219], v[84:87], v[60:63]
ds_write_b128 v254, v[40:43] offset:8192
v_mfma_f32_16x16x32_bf16 v[52:55], v[220:223], v[64:67], v[52:55]
ds_write_b128 v254, v[44:47] offset:12288
buffer_load_dwordx4 v[196:199], v4, s[16:19], s45 offen offset:3072 sc1
v_mfma_f32_16x16x32_bf16 v[56:59], v[220:223], v[72:75], v[56:59]
ds_read_b64 v[208:209], v252 offset:40704
ds_read_b64 v[210:211], v252 offset:40712
v_mfma_f32_16x16x32_bf16 v[60:63], v[220:223], v[80:83], v[60:63]
ds_write_b128 v254, v[48:51] offset:16384
s_nop 0
ds_write_b128 v254, v[52:55] offset:20480
v_mfma_f32_16x16x32_bf16 v[56:59], v[224:227], v[68:71], v[56:59]
ds_read_b64 v[212:213], v252 offset:40448
ds_read_b64 v[214:215], v252 offset:40456
v_mfma_f32_16x16x32_bf16 v[60:63], v[224:227], v[76:79], v[60:63]
ds_read_b64 v[216:217], v252 offset:40192
ds_read_b64 v[218:219], v252 offset:40200
v_mfma_f32_16x16x32_bf16 v[56:59], v[228:231], v[64:67], v[56:59]
ds_read_b64 v[220:221], v252 offset:39936
ds_read_b64 v[222:223], v252 offset:39944
v_mfma_f32_16x16x32_bf16 v[60:63], v[228:231], v[72:75], v[60:63]
ds_read_b64 v[224:225], v252 offset:39680
ds_read_b64 v[226:227], v252 offset:39688
s_waitcnt lgkmcnt(15)
v_mfma_f32_16x16x32_bf16 v[60:63], v[232:235], v[68:71], v[60:63]
ds_read_b64 v[228:229], v252 offset:39424
ds_read_b64 v[230:231], v252 offset:39432
s_waitcnt lgkmcnt(15)
v_mfma_f32_16x16x32_bf16 v[60:63], v[236:239], v[64:67], v[60:63]
ds_read_b64 v[232:233], v252 offset:39168
ds_read_b64 v[234:235], v252 offset:39176
ds_read_b64 v[236:237], v252 offset:38912
ds_read_b64 v[238:239], v252 offset:38920
ds_read_b128 v[84:87], v22 offset:3872
ds_read_b128 v[80:83], v22 offset:3104
ds_read_b128 v[76:79], v22 offset:2336
ds_read_b128 v[72:75], v22 offset:1568
ds_read_b128 v[68:71], v22 offset:800
ds_read_b128 v[64:67], v22 offset:32
ds_write_b128 v254, v[56:59] offset:24576
ds_write_b128 v254, v[60:63] offset:28672
ds_read_b128 v[40:43], v23 offset:5408
ds_read_b128 v[44:47], v23 offset:4640
ds_read_b128 v[48:51], v23 offset:3872
ds_read_b128 v[52:55], v23 offset:3104
s_waitcnt lgkmcnt(15)
v_mfma_f32_16x16x32_bf16 v[36:39], v[208:211], v[124:127], 0
s_waitcnt lgkmcnt(15)
v_mfma_f32_16x16x32_bf16 v[36:39], v[212:215], v[120:123], v[36:39]
s_waitcnt lgkmcnt(2)
v_mfma_f32_16x16x32_bf16 v[32:35], v[208:211], v[40:43], 0
v_mfma_f32_16x16x32_bf16 v[32:35], v[212:215], v[44:47], v[32:35]
ds_read_b128 v[40:43], v23 offset:2336
ds_read_b128 v[44:47], v23 offset:1568
v_mov_b32 v31, 3
s_mov_b64 exec, s[100:101]
ds_write_b32 v0, v31 offset:0
s_mov_b64 exec, -1
ds_read_b64 v[208:209], v252 offset:38656
ds_read_b64 v[210:211], v252 offset:38664
ds_read_b64 v[212:213], v252 offset:38400
ds_read_b64 v[214:215], v252 offset:38408
v_mfma_f32_16x16x32_bf16 v[36:39], v[216:219], v[116:119], v[36:39]
v_mfma_f32_16x16x32_bf16 v[36:39], v[220:223], v[112:115], v[36:39]
s_waitcnt lgkmcnt(7)
s_cmp_lt_u32 s31, 1
s_cbranch_scc1 Lr_46
v_mfma_f32_16x16x32_bf16 v[32:35], v[216:219], v[48:51], v[32:35]
v_mfma_f32_16x16x32_bf16 v[32:35], v[220:223], v[52:55], v[32:35]
Lr_46:
ds_read_b128 v[48:51], v23 offset:800
ds_read_b128 v[52:55], v23 offset:32
ds_read_b64 v[216:217], v252 offset:38144
ds_read_b64 v[218:219], v252 offset:38152
ds_read_b64 v[220:221], v252 offset:37888
ds_read_b64 v[222:223], v252 offset:37896
buffer_load_dwordx2 v[202:203], v5, s[16:19], s45 offen offset:0 sc1
buffer_load_dwordx2 v[206:207], v5, s[16:19], s45 offen offset:8 sc1
v_mfma_f32_16x16x32_bf16 v[36:39], v[224:227], v[108:111], v[36:39]
v_mfma_f32_16x16x32_bf16 v[36:39], v[228:231], v[104:107], v[36:39]
s_waitcnt lgkmcnt(11)
s_cmp_lt_u32 s31, 2
s_cbranch_scc1 Lr_47
v_mfma_f32_16x16x32_bf16 v[32:35], v[224:227], v[40:43], v[32:35]
v_mfma_f32_16x16x32_bf16 v[32:35], v[228:231], v[44:47], v[32:35]
Lr_47:
ds_read_b64 v[224:225], v252 offset:37632
ds_read_b64 v[226:227], v252 offset:37640
ds_read_b64 v[228:229], v252 offset:37376
ds_read_b64 v[230:231], v252 offset:37384
v_mfma_f32_16x16x32_bf16 v[36:39], v[232:235], v[100:103], v[36:39]
v_mfma_f32_16x16x32_bf16 v[36:39], v[236:239], v[96:99], v[36:39]
s_waitcnt lgkmcnt(8)
s_cmp_lt_u32 s31, 3
s_cbranch_scc1 Lr_48
v_mfma_f32_16x16x32_bf16 v[32:35], v[232:235], v[48:51], v[32:35]
v_mfma_f32_16x16x32_bf16 v[32:35], v[236:239], v[52:55], v[32:35]
Lr_48:
ds_read_b64 v[232:233], v252 offset:37120
ds_read_b64 v[234:235], v252 offset:37128
ds_read_b64 v[236:237], v252 offset:36864
ds_read_b64 v[238:239], v252 offset:36872
v_mfma_f32_16x16x32_bf16 v[36:39], v[208:211], v[92:95], v[36:39]
v_mfma_f32_16x16x32_bf16 v[36:39], v[212:215], v[88:91], v[36:39]
s_cmp_gt_u32 s31, 2
s_cbranch_scc1 Lq_44
s_waitcnt lgkmcnt(10)
v_mfma_f32_16x16x32_bf16 v[36:39], v[216:219], v[84:87], v[36:39]
s_waitcnt lgkmcnt(8)
v_mfma_f32_16x16x32_bf16 v[36:39], v[220:223], v[80:83], v[36:39]
s_cmp_gt_u32 s31, 1
s_cbranch_scc1 Lq_44
s_waitcnt lgkmcnt(6)
v_mfma_f32_16x16x32_bf16 v[36:39], v[224:227], v[76:79], v[36:39]
s_waitcnt lgkmcnt(4)
v_mfma_f32_16x16x32_bf16 v[36:39], v[228:231], v[72:75], v[36:39]
s_cmp_gt_u32 s31, 0
s_cbranch_scc1 Lq_44
s_waitcnt lgkmcnt(2)
v_mfma_f32_16x16x32_bf16 v[36:39], v[232:235], v[68:71], v[36:39]
s_waitcnt lgkmcnt(0)
v_mfma_f32_16x16x32_bf16 v[36:39], v[236:239], v[64:67], v[36:39]
Lq_44:
s_nop 7
ds_write_b128 v24, v[32:35] offset:0
ds_write_b128 v24, v[36:39] offset:4096
s_waitcnt lgkmcnt(0)
v_mov_b32 v31, 4
s_mov_b64 exec, s[100:101]
ds_write_b32 v0, v31 offset:0
s_mov_b64 exec, -1
s_mov_b32 s58, 0x100000
LLs_49:
ds_read_b32 v31, v0 offset:0
s_sub_u32 s58, s58, 1
s_waitcnt lgkmcnt(0)
v_cmp_gt_u32 vcc, 4, v31
s_nop 1
s_and_b32 s33, vcc_lo, 15
s_cbranch_scc0 LBs_50
s_sleep 2
s_cmp_gt_i32 s58, 0
s_cbranch_scc1 LLs_49
LBs_50:
ds_read_b64_tr_b16 v[112:113], v8 offset:36864
ds_read_b64_tr_b16 v[114:115], v8 offset:41472
ds_read_b64_tr_b16 v[116:117], v8 offset:36896
ds_read_b64_tr_b16 v[118:119], v8 offset:41504
ds_read_b64_tr_b16 v[120:121], v8 offset:36928
ds_read_b64_tr_b16 v[122:123], v8 offset:41536
ds_read_b64_tr_b16 v[124:125], v8 offset:36960
ds_read_b64_tr_b16 v[126:127], v8 offset:41568
s_waitcnt lgkmcnt(4)
v_mfma_f32_16x16x32_bf16 v[32:35], v[112:115], v[136:139], 0
ds_read_b64_tr_b16 v[128:129], v8 offset:36992
v_mfma_f32_16x16x32_bf16 v[36:39], v[112:115], v[140:143], 0
ds_read_b64_tr_b16 v[130:131], v8 offset:41600
v_mfma_f32_16x16x32_bf16 v[44:47], v[116:119], v[140:143], 0
ds_read_b64_tr_b16 v[132:133], v8 offset:37024
v_mfma_f32_16x16x32_bf16 v[40:43], v[116:119], v[136:139], 0
ds_read_b64_tr_b16 v[134:135], v8 offset:41632
s_waitcnt lgkmcnt(4)
v_mfma_f32_16x16x32_bf16 v[48:51], v[120:123], v[136:139], 0
ds_read_b64_tr_b16 v[104:105], v8 offset:37056
v_mfma_f32_16x16x32_bf16 v[52:55], v[120:123], v[140:143], 0
ds_read_b64_tr_b16 v[106:107], v8 offset:41664
v_mfma_f32_16x16x32_bf16 v[60:63], v[124:127], v[140:143], 0
ds_read_b64_tr_b16 v[108:109], v8 offset:37088
v_mfma_f32_16x16x32_bf16 v[56:59], v[124:127], v[136:139], 0
ds_read_b64_tr_b16 v[110:111], v8 offset:41696
s_waitcnt lgkmcnt(4)
v_mfma_f32_16x16x32_bf16 v[64:67], v[128:131], v[136:139], 0
ds_read_b64_tr_b16 v[112:113], v8 offset:37120
v_mfma_f32_16x16x32_bf16 v[68:71], v[128:131], v[140:143], 0
ds_read_b64_tr_b16 v[114:115], v8 offset:41728
v_mfma_f32_16x16x32_bf16 v[76:79], v[132:135], v[140:143], 0
ds_read_b64_tr_b16 v[116:117], v8 offset:46080
v_mfma_f32_16x16x32_bf16 v[72:75], v[132:135], v[136:139], 0
ds_read_b64_tr_b16 v[118:119], v8 offset:50688
s_waitcnt lgkmcnt(4)
v_mfma_f32_16x16x32_bf16 v[80:83], v[104:107], v[136:139], 0
ds_read_b64_tr_b16 v[120:121], v8 offset:46112
v_mfma_f32_16x16x32_bf16 v[84:87], v[104:107], v[140:143], 0
ds_read_b64_tr_b16 v[122:123], v8 offset:50720
v_mfma_f32_16x16x32_bf16 v[92:95], v[108:111], v[140:143], 0
ds_read_b64_tr_b16 v[124:125], v8 offset:46144
v_mfma_f32_16x16x32_bf16 v[88:91], v[108:111], v[136:139], 0
ds_read_b64_tr_b16 v[126:127], v8 offset:50752
s_waitcnt lgkmcnt(4)
v_mfma_f32_16x16x32_bf16 v[96:99], v[112:115], v[136:139], 0
ds_read_b64_tr_b16 v[128:129], v8 offset:46176
v_mfma_f32_16x16x32_bf16 v[100:103], v[112:115], v[140:143], 0
ds_read_b64_tr_b16 v[130:131], v8 offset:50784
v_mfma_f32_16x16x32_bf16 v[36:39], v[116:119], v[148:151], v[36:39]
ds_read_b64_tr_b16 v[132:133], v8 offset:46208
buffer_load_dwordx4 v[208:211], v3, s[16:19], s46 offen offset:0 sc1
v_mfma_f32_16x16x32_bf16 v[32:35], v[116:119], v[144:147], v[32:35]
ds_read_b64_tr_b16 v[134:135], v8 offset:50816
s_waitcnt lgkmcnt(4)
v_mfma_f32_16x16x32_bf16 v[40:43], v[120:123], v[144:147], v[40:43]
ds_read_b64_tr_b16 v[104:105], v8 offset:46240
buffer_load_dwordx4 v[212:215], v3, s[16:19], s46 offen offset:1024 sc1
v_mfma_f32_16x16x32_bf16 v[44:47], v[120:123], v[148:151], v[44:47]
ds_read_b64_tr_b16 v[106:107], v8 offset:50848
v_mfma_f32_16x16x32_bf16 v[52:55], v[124:127], v[148:151], v[52:55]
ds_read_b64_tr_b16 v[108:109], v8 offset:46272
v_mfma_f32_16x16x32_bf16 v[48:51], v[124:127], v[144:147], v[48:51]
ds_read_b64_tr_b16 v[110:111], v8 offset:50880
s_waitcnt lgkmcnt(4)
v_mfma_f32_16x16x32_bf16 v[56:59], v[128:131], v[144:147], v[56:59]
ds_read_b64_tr_b16 v[112:113], v8 offset:46304
v_mfma_f32_16x16x32_bf16 v[60:63], v[128:131], v[148:151], v[60:63]
ds_read_b64_tr_b16 v[114:115], v8 offset:50912
v_mfma_f32_16x16x32_bf16 v[68:71], v[132:135], v[148:151], v[68:71]
ds_read_b64_tr_b16 v[116:117], v8 offset:46336
v_mfma_f32_16x16x32_bf16 v[64:67], v[132:135], v[144:147], v[64:67]
ds_read_b64_tr_b16 v[118:119], v8 offset:50944
s_waitcnt lgkmcnt(4)
v_mfma_f32_16x16x32_bf16 v[72:75], v[104:107], v[144:147], v[72:75]
ds_read_b64_tr_b16 v[120:121], v9 offset:0
v_mfma_f32_16x16x32_bf16 v[76:79], v[104:107], v[148:151], v[76:79]
ds_read_b64_tr_b16 v[122:123], v9 offset:4608
v_mfma_f32_16x16x32_bf16 v[84:87], v[108:111], v[148:151], v[84:87]
ds_read_b64_tr_b16 v[124:125], v9 offset:32
v_mfma_f32_16x16x32_bf16 v[80:83], v[108:111], v[144:147], v[80:83]
ds_read_b64_tr_b16 v[126:127], v9 offset:4640
s_waitcnt lgkmcnt(4)
v_mfma_f32_16x16x32_bf16 v[88:91], v[112:115], v[144:147], v[88:91]
ds_read_b64_tr_b16 v[128:129], v9 offset:64
v_mfma_f32_16x16x32_bf16 v[92:95], v[112:115], v[148:151], v[92:95]
ds_read_b64_tr_b16 v[130:131], v9 offset:4672
v_mfma_f32_16x16x32_bf16 v[100:103], v[116:119], v[148:151], v[100:103]
ds_read_b64_tr_b16 v[132:133], v9 offset:96
v_mfma_f32_16x16x32_bf16 v[96:99], v[116:119], v[144:147], v[96:99]
ds_read_b64_tr_b16 v[134:135], v9 offset:4704
s_waitcnt lgkmcnt(4)
v_mfma_f32_16x16x32_bf16 v[32:35], v[120:123], v[152:155], v[32:35]
ds_read_b64_tr_b16 v[104:105], v9 offset:128
buffer_load_dwordx4 v[216:219], v3, s[16:19], s46 offen offset:2048 sc1
v_mfma_f32_16x16x32_bf16 v[36:39], v[120:123], v[156:159], v[36:39]
ds_read_b64_tr_b16 v[106:107], v9 offset:4736
buffer_load_dwordx4 v[220:223], v3, s[16:19], s46 offen offset:3072 sc1
v_mfma_f32_16x16x32_bf16 v[44:47], v[124:127], v[156:159], v[44:47]
ds_read_b64_tr_b16 v[108:109], v9 offset:160
v_mfma_f32_16x16x32_bf16 v[40:43], v[124:127], v[152:155], v[40:43]
ds_read_b64_tr_b16 v[110:111], v9 offset:4768
s_waitcnt lgkmcnt(4)
v_mfma_f32_16x16x32_bf16 v[48:51], v[128:131], v[152:155], v[48:51]
ds_read_b64_tr_b16 v[112:113], v9 offset:192
v_mfma_f32_16x16x32_bf16 v[52:55], v[128:131], v[156:159], v[52:55]
ds_read_b64_tr_b16 v[114:115], v9 offset:4800
v_mfma_f32_16x16x32_bf16 v[60:63], v[132:135], v[156:159], v[60:63]
ds_read_b64_tr_b16 v[116:117], v9 offset:224
v_mfma_f32_16x16x32_bf16 v[56:59], v[132:135], v[152:155], v[56:59]
ds_read_b64_tr_b16 v[118:119], v9 offset:4832
s_waitcnt lgkmcnt(4)
v_mfma_f32_16x16x32_bf16 v[64:67], v[104:107], v[152:155], v[64:67]
ds_read_b64_tr_b16 v[120:121], v9 offset:256
v_mfma_f32_16x16x32_bf16 v[68:71], v[104:107], v[156:159], v[68:71]
ds_read_b64_tr_b16 v[122:123], v9 offset:4864
v_mfma_f32_16x16x32_bf16 v[76:79], v[108:111], v[156:159], v[76:79]
ds_read_b64_tr_b16 v[124:125], v9 offset:9216
v_mfma_f32_16x16x32_bf16 v[72:75], v[108:111], v[152:155], v[72:75]
ds_read_b64_tr_b16 v[126:127], v9 offset:13824
s_waitcnt lgkmcnt(4)
v_mfma_f32_16x16x32_bf16 v[80:83], v[112:115], v[152:155], v[80:83]
ds_read_b64_tr_b16 v[128:129], v9 offset:9248
v_mfma_f32_16x16x32_bf16 v[84:87], v[112:115], v[156:159], v[84:87]
ds_read_b64_tr_b16 v[130:131], v9 offset:13856
v_mfma_f32_16x16x32_bf16 v[92:95], v[116:119], v[156:159], v[92:95]
ds_read_b64_tr_b16 v[132:133], v9 offset:9280
v_mfma_f32_16x16x32_bf16 v[88:91], v[116:119], v[152:155], v[88:91]
ds_read_b64_tr_b16 v[134:135], v9 offset:13888
s_waitcnt lgkmcnt(4)
v_mfma_f32_16x16x32_bf16 v[96:99], v[120:123], v[152:155], v[96:99]
ds_read_b64_tr_b16 v[104:105], v9 offset:9312
v_mfma_f32_16x16x32_bf16 v[100:103], v[120:123], v[156:159], v[100:103]
ds_read_b64_tr_b16 v[106:107], v9 offset:13920
v_mfma_f32_16x16x32_bf16 v[36:39], v[124:127], v[164:167], v[36:39]
ds_read_b64_tr_b16 v[108:109], v9 offset:9344
buffer_load_dwordx4 v[224:227], v4, s[16:19], s46 offen offset:0 sc1
v_mfma_f32_16x16x32_bf16 v[32:35], v[124:127], v[160:163], v[32:35]
ds_read_b64_tr_b16 v[110:111], v9 offset:13952
s_waitcnt lgkmcnt(4)
v_mfma_f32_16x16x32_bf16 v[40:43], v[128:131], v[160:163], v[40:43]
ds_read_b64_tr_b16 v[112:113], v9 offset:9376
buffer_load_dwordx4 v[228:231], v4, s[16:19], s46 offen offset:1024 sc1
v_mfma_f32_16x16x32_bf16 v[44:47], v[128:131], v[164:167], v[44:47]
ds_read_b64_tr_b16 v[114:115], v9 offset:13984
v_mfma_f32_16x16x32_bf16 v[52:55], v[132:135], v[164:167], v[52:55]
ds_read_b64_tr_b16 v[116:117], v9 offset:9408
v_mfma_f32_16x16x32_bf16 v[48:51], v[132:135], v[160:163], v[48:51]
ds_read_b64_tr_b16 v[118:119], v9 offset:14016
s_waitcnt lgkmcnt(4)
v_mfma_f32_16x16x32_bf16 v[56:59], v[104:107], v[160:163], v[56:59]
ds_read_b64_tr_b16 v[120:121], v9 offset:9440
v_mfma_f32_16x16x32_bf16 v[60:63], v[104:107], v[164:167], v[60:63]
ds_read_b64_tr_b16 v[122:123], v9 offset:14048
v_mfma_f32_16x16x32_bf16 v[68:71], v[108:111], v[164:167], v[68:71]
ds_read_b64_tr_b16 v[124:125], v9 offset:9472
v_mfma_f32_16x16x32_bf16 v[64:67], v[108:111], v[160:163], v[64:67]
ds_read_b64_tr_b16 v[126:127], v9 offset:14080
s_waitcnt lgkmcnt(4)
v_mfma_f32_16x16x32_bf16 v[72:75], v[112:115], v[160:163], v[72:75]
ds_read_b64_tr_b16 v[128:129], v9 offset:18432
v_mfma_f32_16x16x32_bf16 v[76:79], v[112:115], v[164:167], v[76:79]
ds_read_b64_tr_b16 v[130:131], v9 offset:23040
v_mfma_f32_16x16x32_bf16 v[84:87], v[116:119], v[164:167], v[84:87]
ds_read_b64_tr_b16 v[132:133], v9 offset:18464
v_mfma_f32_16x16x32_bf16 v[80:83], v[116:119], v[160:163], v[80:83]
ds_read_b64_tr_b16 v[134:135], v9 offset:23072
s_waitcnt lgkmcnt(4)
v_mfma_f32_16x16x32_bf16 v[88:91], v[120:123], v[160:163], v[88:91]
ds_read_b64_tr_b16 v[104:105], v9 offset:18496
v_mfma_f32_16x16x32_bf16 v[92:95], v[120:123], v[164:167], v[92:95]
ds_read_b64_tr_b16 v[106:107], v9 offset:23104
v_mfma_f32_16x16x32_bf16 v[100:103], v[124:127], v[164:167], v[100:103]
ds_read_b64_tr_b16 v[108:109], v9 offset:18528
v_mfma_f32_16x16x32_bf16 v[96:99], v[124:127], v[160:163], v[96:99]
ds_read_b64_tr_b16 v[110:111], v9 offset:23136
s_mov_b32 s58, 0x100000
LLs_51:
ds_read_b32 v31, v0 offset:16
s_sub_u32 s58, s58, 1
s_waitcnt lgkmcnt(0)
v_cmp_gt_u32 vcc, 9, v31
s_nop 1
s_and_b32 s33, vcc_lo, 15
s_cbranch_scc0 LBs_52
s_sleep 2
s_cmp_gt_i32 s58, 0
s_cbranch_scc1 LLs_51
LBs_52:
s_waitcnt vmcnt(14)
s_waitcnt lgkmcnt(4)
v_mfma_f32_16x16x32_bf16 v[32:35], v[128:131], v[168:171], v[32:35]
ds_read_b64_tr_b16 v[112:113], v9 offset:18560
buffer_load_dwordx4 v[232:235], v4, s[16:19], s46 offen offset:2048 sc1
v_mfma_f32_16x16x32_bf16 v[36:39], v[128:131], v[172:175], v[36:39]
ds_read_b64_tr_b16 v[114:115], v9 offset:23168
buffer_load_dwordx4 v[236:239], v4, s[16:19], s46 offen offset:3072 sc1
v_mfma_f32_16x16x32_bf16 v[44:47], v[132:135], v[172:175], v[44:47]
ds_read_b64_tr_b16 v[116:117], v9 offset:18592
v_mfma_f32_16x16x32_bf16 v[40:43], v[132:135], v[168:171], v[40:43]
ds_read_b64_tr_b16 v[118:119], v9 offset:23200
s_waitcnt lgkmcnt(4)
v_mfma_f32_16x16x32_bf16 v[48:51], v[104:107], v[168:171], v[48:51]
ds_read_b64_tr_b16 v[120:121], v9 offset:18624
v_mfma_f32_16x16x32_bf16 v[52:55], v[104:107], v[172:175], v[52:55]
ds_read_b64_tr_b16 v[122:123], v9 offset:23232
v_mfma_f32_16x16x32_bf16 v[60:63], v[108:111], v[172:175], v[60:63]
ds_read_b64_tr_b16 v[124:125], v9 offset:18656
v_mfma_f32_16x16x32_bf16 v[56:59], v[108:111], v[168:171], v[56:59]
ds_read_b64_tr_b16 v[126:127], v9 offset:23264
s_waitcnt lgkmcnt(4)
v_mfma_f32_16x16x32_bf16 v[64:67], v[112:115], v[168:171], v[64:67]
ds_read_b64_tr_b16 v[128:129], v9 offset:18688
v_mfma_f32_16x16x32_bf16 v[68:71], v[112:115], v[172:175], v[68:71]
ds_read_b64_tr_b16 v[130:131], v9 offset:23296
v_mfma_f32_16x16x32_bf16 v[76:79], v[116:119], v[172:175], v[76:79]
ds_read_b64_tr_b16 v[132:133], v9 offset:27648
v_mfma_f32_16x16x32_bf16 v[72:75], v[116:119], v[168:171], v[72:75]
ds_read_b64_tr_b16 v[134:135], v9 offset:32256
s_waitcnt lgkmcnt(4)
v_mfma_f32_16x16x32_bf16 v[80:83], v[120:123], v[168:171], v[80:83]
ds_read_b64_tr_b16 v[104:105], v9 offset:27680
v_mfma_f32_16x16x32_bf16 v[84:87], v[120:123], v[172:175], v[84:87]
ds_read_b64_tr_b16 v[106:107], v9 offset:32288
v_mfma_f32_16x16x32_bf16 v[92:95], v[124:127], v[172:175], v[92:95]
ds_read_b64_tr_b16 v[108:109], v9 offset:27712
v_mfma_f32_16x16x32_bf16 v[88:91], v[124:127], v[168:171], v[88:91]
ds_read_b64_tr_b16 v[110:111], v9 offset:32320
s_waitcnt lgkmcnt(4)
v_mfma_f32_16x16x32_bf16 v[96:99], v[128:131], v[168:171], v[96:99]
ds_read_b64_tr_b16 v[112:113], v9 offset:27744
v_mfma_f32_16x16x32_bf16 v[100:103], v[128:131], v[172:175], v[100:103]
ds_read_b64_tr_b16 v[114:115], v9 offset:32352
s_waitcnt vmcnt(14)
v_mfma_f32_16x16x32_bf16 v[36:39], v[132:135], v[180:183], v[36:39]
ds_read_b64_tr_b16 v[116:117], v9 offset:27776
buffer_load_dwordx4 v[240:243], v3, s[16:19], s47 offen offset:0 sc1
v_mfma_f32_16x16x32_bf16 v[32:35], v[132:135], v[176:179], v[32:35]
ds_read_b64_tr_b16 v[118:119], v9 offset:32384
s_waitcnt lgkmcnt(4)
v_mfma_f32_16x16x32_bf16 v[40:43], v[104:107], v[176:179], v[40:43]
ds_read_b64_tr_b16 v[120:121], v9 offset:27808
buffer_load_dwordx4 v[244:247], v3, s[16:19], s47 offen offset:1024 sc1
v_mfma_f32_16x16x32_bf16 v[44:47], v[104:107], v[180:183], v[44:47]
ds_read_b64_tr_b16 v[122:123], v9 offset:32416
v_mfma_f32_16x16x32_bf16 v[52:55], v[108:111], v[180:183], v[52:55]
ds_read_b64_tr_b16 v[124:125], v9 offset:27840
v_mfma_f32_16x16x32_bf16 v[48:51], v[108:111], v[176:179], v[48:51]
ds_read_b64_tr_b16 v[126:127], v9 offset:32448
s_waitcnt lgkmcnt(4)
v_mfma_f32_16x16x32_bf16 v[56:59], v[112:115], v[176:179], v[56:59]
ds_read_b64_tr_b16 v[128:129], v9 offset:27872
v_mfma_f32_16x16x32_bf16 v[60:63], v[112:115], v[180:183], v[60:63]
ds_read_b64_tr_b16 v[130:131], v9 offset:32480
v_mfma_f32_16x16x32_bf16 v[68:71], v[116:119], v[180:183], v[68:71]
ds_read_b64_tr_b16 v[132:133], v9 offset:27904
v_mfma_f32_16x16x32_bf16 v[64:67], v[116:119], v[176:179], v[64:67]
ds_read_b64_tr_b16 v[134:135], v9 offset:32512
s_waitcnt lgkmcnt(4)
v_mfma_f32_16x16x32_bf16 v[72:75], v[120:123], v[176:179], v[72:75]
ds_read_b64_tr_b16 v[104:105], v9 offset:36864
v_mfma_f32_16x16x32_bf16 v[76:79], v[120:123], v[180:183], v[76:79]
ds_read_b64_tr_b16 v[106:107], v9 offset:41472
v_mfma_f32_16x16x32_bf16 v[84:87], v[124:127], v[180:183], v[84:87]
ds_read_b64_tr_b16 v[108:109], v9 offset:36896
v_mfma_f32_16x16x32_bf16 v[80:83], v[124:127], v[176:179], v[80:83]
ds_read_b64_tr_b16 v[110:111], v9 offset:41504
s_waitcnt lgkmcnt(4)
v_mfma_f32_16x16x32_bf16 v[88:91], v[128:131], v[176:179], v[88:91]
ds_read_b64_tr_b16 v[112:113], v9 offset:36928
v_mfma_f32_16x16x32_bf16 v[92:95], v[128:131], v[180:183], v[92:95]
ds_read_b64_tr_b16 v[114:115], v9 offset:41536
v_mfma_f32_16x16x32_bf16 v[100:103], v[132:135], v[180:183], v[100:103]
ds_read_b64_tr_b16 v[116:117], v9 offset:36960
v_mfma_f32_16x16x32_bf16 v[96:99], v[132:135], v[176:179], v[96:99]
ds_read_b64_tr_b16 v[118:119], v9 offset:41568
s_waitcnt vmcnt(14)
s_waitcnt lgkmcnt(4)
v_mfma_f32_16x16x32_bf16 v[32:35], v[104:107], v[184:187], v[32:35]
ds_read_b64_tr_b16 v[120:121], v9 offset:36992
buffer_load_dwordx4 v[248:251], v3, s[16:19], s47 offen offset:2048 sc1
v_mfma_f32_16x16x32_bf16 v[36:39], v[104:107], v[188:191], v[36:39]
ds_read_b64_tr_b16 v[122:123], v9 offset:41600
buffer_load_dwordx4 v[252:255], v3, s[16:19], s47 offen offset:3072 sc1
v_mfma_f32_16x16x32_bf16 v[44:47], v[108:111], v[188:191], v[44:47]
ds_read_b64_tr_b16 v[124:125], v9 offset:37024
v_mfma_f32_16x16x32_bf16 v[40:43], v[108:111], v[184:187], v[40:43]
ds_read_b64_tr_b16 v[126:127], v9 offset:41632
s_waitcnt lgkmcnt(4)
v_mfma_f32_16x16x32_bf16 v[48:51], v[112:115], v[184:187], v[48:51]
ds_read_b64_tr_b16 v[128:129], v9 offset:37056
v_mfma_f32_16x16x32_bf16 v[52:55], v[112:115], v[188:191], v[52:55]
ds_read_b64_tr_b16 v[130:131], v9 offset:41664
v_mfma_f32_16x16x32_bf16 v[60:63], v[116:119], v[188:191], v[60:63]
ds_read_b64_tr_b16 v[132:133], v9 offset:37088
v_mfma_f32_16x16x32_bf16 v[56:59], v[116:119], v[184:187], v[56:59]
ds_read_b64_tr_b16 v[134:135], v9 offset:41696
s_waitcnt lgkmcnt(4)
v_mfma_f32_16x16x32_bf16 v[64:67], v[120:123], v[184:187], v[64:67]
ds_read_b64_tr_b16 v[104:105], v9 offset:37120
v_mfma_f32_16x16x32_bf16 v[68:71], v[120:123], v[188:191], v[68:71]
ds_read_b64_tr_b16 v[106:107], v9 offset:41728
v_mfma_f32_16x16x32_bf16 v[76:79], v[124:127], v[188:191], v[76:79]
ds_read_b64_tr_b16 v[108:109], v9 offset:46080
v_mfma_f32_16x16x32_bf16 v[72:75], v[124:127], v[184:187], v[72:75]
ds_read_b64_tr_b16 v[110:111], v9 offset:50688
s_waitcnt lgkmcnt(4)
v_mfma_f32_16x16x32_bf16 v[80:83], v[128:131], v[184:187], v[80:83]
ds_read_b64_tr_b16 v[112:113], v9 offset:46112
v_mfma_f32_16x16x32_bf16 v[84:87], v[128:131], v[188:191], v[84:87]
ds_read_b64_tr_b16 v[114:115], v9 offset:50720
v_mfma_f32_16x16x32_bf16 v[92:95], v[132:135], v[188:191], v[92:95]
ds_read_b64_tr_b16 v[116:117], v9 offset:46144
v_mfma_f32_16x16x32_bf16 v[88:91], v[132:135], v[184:187], v[88:91]
ds_read_b64_tr_b16 v[118:119], v9 offset:50752
s_waitcnt lgkmcnt(4)
v_mfma_f32_16x16x32_bf16 v[96:99], v[104:107], v[184:187], v[96:99]
ds_read_b64_tr_b16 v[120:121], v9 offset:46176
v_mfma_f32_16x16x32_bf16 v[100:103], v[104:107], v[188:191], v[100:103]
ds_read_b64_tr_b16 v[122:123], v9 offset:50784
s_waitcnt vmcnt(14)
v_mfma_f32_16x16x32_bf16 v[36:39], v[108:111], v[196:199], v[36:39]
ds_read_b64_tr_b16 v[124:125], v9 offset:46208
buffer_load_dwordx4 v[136:139], v4, s[16:19], s47 offen offset:0 sc1
v_mfma_f32_16x16x32_bf16 v[32:35], v[108:111], v[192:195], v[32:35]
ds_read_b64_tr_b16 v[126:127], v9 offset:50816
s_waitcnt lgkmcnt(4)
v_mfma_f32_16x16x32_bf16 v[40:43], v[112:115], v[192:195], v[40:43]
ds_read_b64_tr_b16 v[128:129], v9 offset:46240
buffer_load_dwordx4 v[140:143], v4, s[16:19], s47 offen offset:1024 sc1
v_mfma_f32_16x16x32_bf16 v[44:47], v[112:115], v[196:199], v[44:47]
ds_read_b64_tr_b16 v[130:131], v9 offset:50848
v_mfma_f32_16x16x32_bf16 v[52:55], v[116:119], v[196:199], v[52:55]
ds_read_b64_tr_b16 v[132:133], v9 offset:46272
v_mfma_f32_16x16x32_bf16 v[48:51], v[116:119], v[192:195], v[48:51]
ds_read_b64_tr_b16 v[134:135], v9 offset:50880
s_waitcnt lgkmcnt(4)
v_mfma_f32_16x16x32_bf16 v[56:59], v[120:123], v[192:195], v[56:59]
ds_read_b64_tr_b16 v[104:105], v9 offset:46304
v_mfma_f32_16x16x32_bf16 v[60:63], v[120:123], v[196:199], v[60:63]
ds_read_b64_tr_b16 v[106:107], v9 offset:50912
v_mfma_f32_16x16x32_bf16 v[68:71], v[124:127], v[196:199], v[68:71]
ds_read_b64_tr_b16 v[108:109], v9 offset:46336
v_mfma_f32_16x16x32_bf16 v[64:67], v[124:127], v[192:195], v[64:67]
ds_read_b64_tr_b16 v[110:111], v9 offset:50944
s_waitcnt lgkmcnt(4)
v_mfma_f32_16x16x32_bf16 v[72:75], v[128:131], v[192:195], v[72:75]
ds_read_b64_tr_b16 v[112:113], v10 offset:0
v_mfma_f32_16x16x32_bf16 v[76:79], v[128:131], v[196:199], v[76:79]
ds_read_b64_tr_b16 v[114:115], v10 offset:4608
v_mfma_f32_16x16x32_bf16 v[84:87], v[132:135], v[196:199], v[84:87]
ds_read_b64_tr_b16 v[116:117], v10 offset:32
v_mfma_f32_16x16x32_bf16 v[80:83], v[132:135], v[192:195], v[80:83]
ds_read_b64_tr_b16 v[118:119], v10 offset:4640
s_waitcnt lgkmcnt(4)
v_mfma_f32_16x16x32_bf16 v[88:91], v[104:107], v[192:195], v[88:91]
ds_read_b64_tr_b16 v[120:121], v10 offset:64
v_mfma_f32_16x16x32_bf16 v[92:95], v[104:107], v[196:199], v[92:95]
ds_read_b64_tr_b16 v[122:123], v10 offset:4672
v_mfma_f32_16x16x32_bf16 v[100:103], v[108:111], v[196:199], v[100:103]
ds_read_b64_tr_b16 v[124:125], v10 offset:96
v_mfma_f32_16x16x32_bf16 v[96:99], v[108:111], v[192:195], v[96:99]
ds_read_b64_tr_b16 v[126:127], v10 offset:4704
s_mov_b32 s58, 0x100000
LLs_53:
ds_read_b32 v31, v0 offset:16
s_sub_u32 s58, s58, 1
s_waitcnt lgkmcnt(0)
v_cmp_gt_u32 vcc, 10, v31
s_nop 1
s_and_b32 s33, vcc_lo, 15
s_cbranch_scc0 LBs_54
s_sleep 2
s_cmp_gt_i32 s58, 0
s_cbranch_scc1 LLs_53
LBs_54:
s_waitcnt vmcnt(14)
s_waitcnt lgkmcnt(4)
v_mfma_f32_16x16x32_bf16 v[32:35], v[112:115], v[200:203], v[32:35]
ds_read_b64_tr_b16 v[128:129], v10 offset:128
buffer_load_dwordx4 v[144:147], v4, s[16:19], s47 offen offset:2048 sc1
v_mfma_f32_16x16x32_bf16 v[36:39], v[112:115], v[204:207], v[36:39]
ds_read_b64_tr_b16 v[130:131], v10 offset:4736
buffer_load_dwordx4 v[148:151], v4, s[16:19], s47 offen offset:3072 sc1
v_mfma_f32_16x16x32_bf16 v[44:47], v[116:119], v[204:207], v[44:47]
ds_read_b64_tr_b16 v[132:133], v10 offset:160
v_mfma_f32_16x16x32_bf16 v[40:43], v[116:119], v[200:203], v[40:43]
ds_read_b64_tr_b16 v[134:135], v10 offset:4768
s_waitcnt lgkmcnt(4)
v_mfma_f32_16x16x32_bf16 v[48:51], v[120:123], v[200:203], v[48:51]
ds_read_b64_tr_b16 v[104:105], v10 offset:192
v_mfma_f32_16x16x32_bf16 v[52:55], v[120:123], v[204:207], v[52:55]
ds_read_b64_tr_b16 v[106:107], v10 offset:4800
v_mfma_f32_16x16x32_bf16 v[60:63], v[124:127], v[204:207], v[60:63]
ds_read_b64_tr_b16 v[108:109], v10 offset:224
v_mfma_f32_16x16x32_bf16 v[56:59], v[124:127], v[200:203], v[56:59]
ds_read_b64_tr_b16 v[110:111], v10 offset:4832
s_waitcnt lgkmcnt(4)
v_mfma_f32_16x16x32_bf16 v[64:67], v[128:131], v[200:203], v[64:67]
ds_read_b64_tr_b16 v[112:113], v10 offset:256
v_mfma_f32_16x16x32_bf16 v[68:71], v[128:131], v[204:207], v[68:71]
ds_read_b64_tr_b16 v[114:115], v10 offset:4864
v_mfma_f32_16x16x32_bf16 v[76:79], v[132:135], v[204:207], v[76:79]
ds_read_b64_tr_b16 v[116:117], v10 offset:9216
v_mfma_f32_16x16x32_bf16 v[72:75], v[132:135], v[200:203], v[72:75]
ds_read_b64_tr_b16 v[118:119], v10 offset:13824
s_waitcnt lgkmcnt(4)
v_mfma_f32_16x16x32_bf16 v[80:83], v[104:107], v[200:203], v[80:83]
ds_read_b64_tr_b16 v[120:121], v10 offset:9248
v_mfma_f32_16x16x32_bf16 v[84:87], v[104:107], v[204:207], v[84:87]
ds_read_b64_tr_b16 v[122:123], v10 offset:13856
v_mfma_f32_16x16x32_bf16 v[92:95], v[108:111], v[204:207], v[92:95]
ds_read_b64_tr_b16 v[124:125], v10 offset:9280
v_mfma_f32_16x16x32_bf16 v[88:91], v[108:111], v[200:203], v[88:91]
ds_read_b64_tr_b16 v[126:127], v10 offset:13888
s_waitcnt lgkmcnt(4)
v_mfma_f32_16x16x32_bf16 v[96:99], v[112:115], v[200:203], v[96:99]
ds_read_b64_tr_b16 v[128:129], v10 offset:9312
v_mfma_f32_16x16x32_bf16 v[100:103], v[112:115], v[204:207], v[100:103]
ds_read_b64_tr_b16 v[130:131], v10 offset:13920
s_waitcnt vmcnt(14)
v_mfma_f32_16x16x32_bf16 v[36:39], v[116:119], v[212:215], v[36:39]
ds_read_b64_tr_b16 v[132:133], v10 offset:9344
buffer_load_dwordx2 v[152:153], v5, s[16:19], s46 offen offset:0 sc1
v_mfma_f32_16x16x32_bf16 v[32:35], v[116:119], v[208:211], v[32:35]
ds_read_b64_tr_b16 v[134:135], v10 offset:13952
s_waitcnt lgkmcnt(4)
v_mfma_f32_16x16x32_bf16 v[40:43], v[120:123], v[208:211], v[40:43]
ds_read_b64_tr_b16 v[104:105], v10 offset:9376
buffer_load_dwordx2 v[154:155], v5, s[16:19], s47 offen offset:0 sc1
v_mfma_f32_16x16x32_bf16 v[44:47], v[120:123], v[212:215], v[44:47]
ds_read_b64_tr_b16 v[106:107], v10 offset:13984
buffer_load_dwordx2 v[156:157], v5, s[16:19], s46 offen offset:8 sc1
v_mfma_f32_16x16x32_bf16 v[52:55], v[124:127], v[212:215], v[52:55]
ds_read_b64_tr_b16 v[108:109], v10 offset:9408
buffer_load_dwordx2 v[158:159], v5, s[16:19], s47 offen offset:8 sc1
v_mfma_f32_16x16x32_bf16 v[48:51], v[124:127], v[208:211], v[48:51]
ds_read_b64_tr_b16 v[110:111], v10 offset:14016
s_waitcnt lgkmcnt(4)
v_mfma_f32_16x16x32_bf16 v[56:59], v[128:131], v[208:211], v[56:59]
ds_read_b64_tr_b16 v[112:113], v10 offset:9440
v_mfma_f32_16x16x32_bf16 v[60:63], v[128:131], v[212:215], v[60:63]
ds_read_b64_tr_b16 v[114:115], v10 offset:14048
v_mfma_f32_16x16x32_bf16 v[68:71], v[132:135], v[212:215], v[68:71]
ds_read_b64_tr_b16 v[116:117], v10 offset:9472
v_mfma_f32_16x16x32_bf16 v[64:67], v[132:135], v[208:211], v[64:67]
ds_read_b64_tr_b16 v[118:119], v10 offset:14080
s_waitcnt lgkmcnt(4)
v_mfma_f32_16x16x32_bf16 v[72:75], v[104:107], v[208:211], v[72:75]
ds_read_b64_tr_b16 v[120:121], v10 offset:18432
v_mfma_f32_16x16x32_bf16 v[76:79], v[104:107], v[212:215], v[76:79]
ds_read_b64_tr_b16 v[122:123], v10 offset:23040
v_mfma_f32_16x16x32_bf16 v[84:87], v[108:111], v[212:215], v[84:87]
ds_read_b64_tr_b16 v[124:125], v10 offset:18464
v_mfma_f32_16x16x32_bf16 v[80:83], v[108:111], v[208:211], v[80:83]
ds_read_b64_tr_b16 v[126:127], v10 offset:23072
s_waitcnt lgkmcnt(4)
v_mfma_f32_16x16x32_bf16 v[88:91], v[112:115], v[208:211], v[88:91]
ds_read_b64_tr_b16 v[128:129], v10 offset:18496
v_mfma_f32_16x16x32_bf16 v[92:95], v[112:115], v[212:215], v[92:95]
ds_read_b64_tr_b16 v[130:131], v10 offset:23104
v_mfma_f32_16x16x32_bf16 v[100:103], v[116:119], v[212:215], v[100:103]
ds_read_b64_tr_b16 v[132:133], v10 offset:18528
v_mfma_f32_16x16x32_bf16 v[96:99], v[116:119], v[208:211], v[96:99]
ds_read_b64_tr_b16 v[134:135], v10 offset:23136
s_setprio 0
s_barrier
s_waitcnt vmcnt(16)
s_waitcnt lgkmcnt(4)
v_mfma_f32_16x16x32_bf16 v[32:35], v[120:123], v[216:219], v[32:35]
ds_read_b64_tr_b16 v[104:105], v10 offset:18560
v_mfma_f32_16x16x32_bf16 v[36:39], v[120:123], v[220:223], v[36:39]
ds_read_b64_tr_b16 v[106:107], v10 offset:23168
v_mfma_f32_16x16x32_bf16 v[44:47], v[124:127], v[220:223], v[44:47]
ds_read_b64_tr_b16 v[108:109], v10 offset:18592
v_mfma_f32_16x16x32_bf16 v[40:43], v[124:127], v[216:219], v[40:43]
ds_read_b64_tr_b16 v[110:111], v10 offset:23200
s_waitcnt lgkmcnt(4)
v_mfma_f32_16x16x32_bf16 v[48:51], v[128:131], v[216:219], v[48:51]
ds_read_b64_tr_b16 v[112:113], v10 offset:18624
v_mfma_f32_16x16x32_bf16 v[52:55], v[128:131], v[220:223], v[52:55]
ds_read_b64_tr_b16 v[114:115], v10 offset:23232
v_mfma_f32_16x16x32_bf16 v[60:63], v[132:135], v[220:223], v[60:63]
ds_read_b64_tr_b16 v[116:117], v10 offset:18656
v_mfma_f32_16x16x32_bf16 v[56:59], v[132:135], v[216:219], v[56:59]
ds_read_b64_tr_b16 v[118:119], v10 offset:23264
s_waitcnt lgkmcnt(4)
v_mfma_f32_16x16x32_bf16 v[64:67], v[104:107], v[216:219], v[64:67]
ds_read_b64_tr_b16 v[120:121], v10 offset:18688
v_mfma_f32_16x16x32_bf16 v[68:71], v[104:107], v[220:223], v[68:71]
ds_read_b64_tr_b16 v[122:123], v10 offset:23296
v_mfma_f32_16x16x32_bf16 v[76:79], v[108:111], v[220:223], v[76:79]
ds_read_b64_tr_b16 v[124:125], v8 offset:0
v_mfma_f32_16x16x32_bf16 v[72:75], v[108:111], v[216:219], v[72:75]
ds_read_b64_tr_b16 v[126:127], v8 offset:4608
s_waitcnt lgkmcnt(4)
v_mfma_f32_16x16x32_bf16 v[80:83], v[112:115], v[216:219], v[80:83]
ds_read_b64_tr_b16 v[128:129], v8 offset:32
v_mfma_f32_16x16x32_bf16 v[84:87], v[112:115], v[220:223], v[84:87]
ds_read_b64_tr_b16 v[130:131], v8 offset:4640
v_mfma_f32_16x16x32_bf16 v[92:95], v[116:119], v[220:223], v[92:95]
ds_read_b64_tr_b16 v[132:133], v8 offset:64
v_mfma_f32_16x16x32_bf16 v[88:91], v[116:119], v[216:219], v[88:91]
ds_read_b64_tr_b16 v[134:135], v8 offset:4672
s_waitcnt lgkmcnt(4)
v_mfma_f32_16x16x32_bf16 v[96:99], v[120:123], v[216:219], v[96:99]
ds_read_b64_tr_b16 v[104:105], v8 offset:96
v_mfma_f32_16x16x32_bf16 v[100:103], v[120:123], v[220:223], v[100:103]
ds_read_b64_tr_b16 v[106:107], v8 offset:4704
s_barrier
s_waitcnt vmcnt(14)
v_mfma_f32_16x16x32_bf16 v[36:39], v[124:127], v[228:231], v[36:39]
ds_read_b64_tr_b16 v[108:109], v8 offset:128
s_add_u32 s39, s51, 73728
v_mfma_f32_16x16x32_bf16 v[32:35], v[124:127], v[224:227], v[32:35]
ds_read_b64_tr_b16 v[110:111], v8 offset:4736
s_waitcnt lgkmcnt(4)
v_mfma_f32_16x16x32_bf16 v[40:43], v[128:131], v[224:227], v[40:43]
ds_read_b64_tr_b16 v[112:113], v8 offset:160
s_add_u32 m0, s37, 36864
v_mfma_f32_16x16x32_bf16 v[44:47], v[128:131], v[228:231], v[44:47]
ds_read_b64_tr_b16 v[114:115], v8 offset:4768
buffer_load_dwordx4 v14, s[12:15], s39 offen lds
v_mfma_f32_16x16x32_bf16 v[52:55], v[132:135], v[228:231], v[52:55]
ds_read_b64_tr_b16 v[116:117], v8 offset:192
s_add_u32 m0, s37, 40960
v_mfma_f32_16x16x32_bf16 v[48:51], v[132:135], v[224:227], v[48:51]
ds_read_b64_tr_b16 v[118:119], v8 offset:4800
s_waitcnt lgkmcnt(4)
v_mfma_f32_16x16x32_bf16 v[56:59], v[104:107], v[224:227], v[56:59]
ds_read_b64_tr_b16 v[120:121], v8 offset:224
buffer_load_dwordx4 v15, s[12:15], s39 offen lds
v_mfma_f32_16x16x32_bf16 v[60:63], v[104:107], v[228:231], v[60:63]
ds_read_b64_tr_b16 v[122:123], v8 offset:4832
s_mov_b32 m0, 45056
v_mfma_f32_16x16x32_bf16 v[68:71], v[108:111], v[228:231], v[68:71]
ds_read_b64_tr_b16 v[124:125], v8 offset:256
s_cmp_lg_u32 s29, 1
s_cbranch_scc1 Ld_55
buffer_load_dwordx4 v16, s[12:15], s39 offen lds
Ld_55:
v_mfma_f32_16x16x32_bf16 v[64:67], v[108:111], v[224:227], v[64:67]
ds_read_b64_tr_b16 v[126:127], v8 offset:4864
s_waitcnt lgkmcnt(4)
v_mfma_f32_16x16x32_bf16 v[72:75], v[112:115], v[224:227], v[72:75]
ds_read_b64_tr_b16 v[128:129], v8 offset:9216
v_mfma_f32_16x16x32_bf16 v[76:79], v[112:115], v[228:231], v[76:79]
ds_read_b64_tr_b16 v[130:131], v8 offset:13824
v_mfma_f32_16x16x32_bf16 v[84:87], v[116:119], v[228:231], v[84:87]
ds_read_b64_tr_b16 v[132:133], v8 offset:9248
v_mfma_f32_16x16x32_bf16 v[80:83], v[116:119], v[224:227], v[80:83]
ds_read_b64_tr_b16 v[134:135], v8 offset:13856
s_waitcnt lgkmcnt(4)
v_mfma_f32_16x16x32_bf16 v[88:91], v[120:123], v[224:227], v[88:91]
ds_read_b64_tr_b16 v[104:105], v8 offset:9280
v_mfma_f32_16x16x32_bf16 v[92:95], v[120:123], v[228:231], v[92:95]
ds_read_b64_tr_b16 v[106:107], v8 offset:13888
v_mfma_f32_16x16x32_bf16 v[100:103], v[124:127], v[228:231], v[100:103]
ds_read_b64_tr_b16 v[108:109], v8 offset:9312
v_mfma_f32_16x16x32_bf16 v[96:99], v[124:127], v[224:227], v[96:99]
ds_read_b64_tr_b16 v[110:111], v8 offset:13920
s_barrier
s_waitcnt vmcnt(14)
s_waitcnt lgkmcnt(4)
v_mfma_f32_16x16x32_bf16 v[32:35], v[128:131], v[232:235], v[32:35]
ds_read_b64_tr_b16 v[112:113], v8 offset:9344
s_add_u32 s39, s51, 110592
v_mfma_f32_16x16x32_bf16 v[36:39], v[128:131], v[236:239], v[36:39]
ds_read_b64_tr_b16 v[114:115], v8 offset:13952
s_add_u32 m0, s37, 46080
v_mfma_f32_16x16x32_bf16 v[44:47], v[132:135], v[236:239], v[44:47]
ds_read_b64_tr_b16 v[116:117], v8 offset:9376
buffer_load_dwordx4 v14, s[12:15], s39 offen lds
v_mfma_f32_16x16x32_bf16 v[40:43], v[132:135], v[232:235], v[40:43]
ds_read_b64_tr_b16 v[118:119], v8 offset:13984
s_waitcnt lgkmcnt(4)
v_mfma_f32_16x16x32_bf16 v[48:51], v[104:107], v[232:235], v[48:51]
ds_read_b64_tr_b16 v[120:121], v8 offset:9408
s_add_u32 m0, s37, 50176
v_mfma_f32_16x16x32_bf16 v[52:55], v[104:107], v[236:239], v[52:55]
ds_read_b64_tr_b16 v[122:123], v8 offset:14016
buffer_load_dwordx4 v15, s[12:15], s39 offen lds
v_mfma_f32_16x16x32_bf16 v[60:63], v[108:111], v[236:239], v[60:63]
ds_read_b64_tr_b16 v[124:125], v8 offset:9440
s_mov_b32 m0, 54272
v_mfma_f32_16x16x32_bf16 v[56:59], v[108:111], v[232:235], v[56:59]
ds_read_b64_tr_b16 v[126:127], v8 offset:14048
s_waitcnt lgkmcnt(4)
v_mfma_f32_16x16x32_bf16 v[64:67], v[112:115], v[232:235], v[64:67]
ds_read_b64_tr_b16 v[128:129], v8 offset:9472
s_cmp_lg_u32 s29, 2
s_cbranch_scc1 Ld_56
buffer_load_dwordx4 v16, s[12:15], s39 offen lds
Ld_56:
v_mfma_f32_16x16x32_bf16 v[68:71], v[112:115], v[236:239], v[68:71]
ds_read_b64_tr_b16 v[130:131], v8 offset:14080
v_mfma_f32_16x16x32_bf16 v[76:79], v[116:119], v[236:239], v[76:79]
ds_read_b64_tr_b16 v[132:133], v8 offset:18432
v_mfma_f32_16x16x32_bf16 v[72:75], v[116:119], v[232:235], v[72:75]
ds_read_b64_tr_b16 v[134:135], v8 offset:23040
s_waitcnt lgkmcnt(4)
v_mfma_f32_16x16x32_bf16 v[80:83], v[120:123], v[232:235], v[80:83]
ds_read_b64_tr_b16 v[104:105], v8 offset:18464
v_mfma_f32_16x16x32_bf16 v[84:87], v[120:123], v[236:239], v[84:87]
ds_read_b64_tr_b16 v[106:107], v8 offset:23072
v_mfma_f32_16x16x32_bf16 v[92:95], v[124:127], v[236:239], v[92:95]
ds_read_b64_tr_b16 v[108:109], v8 offset:18496
v_mfma_f32_16x16x32_bf16 v[88:91], v[124:127], v[232:235], v[88:91]
ds_read_b64_tr_b16 v[110:111], v8 offset:23104
s_waitcnt lgkmcnt(4)
v_mfma_f32_16x16x32_bf16 v[96:99], v[128:131], v[232:235], v[96:99]
ds_read_b64_tr_b16 v[112:113], v8 offset:18528
v_mfma_f32_16x16x32_bf16 v[100:103], v[128:131], v[236:239], v[100:103]
ds_read_b64_tr_b16 v[114:115], v8 offset:23136
s_barrier
s_waitcnt vmcnt(14)
v_mfma_f32_16x16x32_bf16 v[36:39], v[132:135], v[244:247], v[36:39]
ds_read_b64_tr_b16 v[116:117], v8 offset:18560
s_mov_b32 s39, 147456
v_mfma_f32_16x16x32_bf16 v[32:35], v[132:135], v[240:243], v[32:35]
ds_read_b64_tr_b16 v[118:119], v8 offset:23168
s_waitcnt lgkmcnt(4)
v_mfma_f32_16x16x32_bf16 v[40:43], v[104:107], v[240:243], v[40:43]
ds_read_b64_tr_b16 v[120:121], v8 offset:18592
s_add_u32 m0, s37, 55296
v_mfma_f32_16x16x32_bf16 v[44:47], v[104:107], v[244:247], v[44:47]
ds_read_b64_tr_b16 v[122:123], v8 offset:23200
buffer_load_dwordx4 v17, s[12:15], s39 offen lds
v_mfma_f32_16x16x32_bf16 v[52:55], v[108:111], v[244:247], v[52:55]
ds_read_b64_tr_b16 v[124:125], v8 offset:18624
s_add_u32 m0, s37, 59392
v_mfma_f32_16x16x32_bf16 v[48:51], v[108:111], v[240:243], v[48:51]
ds_read_b64_tr_b16 v[126:127], v8 offset:23232
s_waitcnt lgkmcnt(4)
v_mfma_f32_16x16x32_bf16 v[56:59], v[112:115], v[240:243], v[56:59]
ds_read_b64_tr_b16 v[128:129], v8 offset:18656
buffer_load_dwordx4 v18, s[12:15], s39 offen lds
v_mfma_f32_16x16x32_bf16 v[60:63], v[112:115], v[244:247], v[60:63]
ds_read_b64_tr_b16 v[130:131], v8 offset:23264
s_mov_b32 m0, 63488
v_mfma_f32_16x16x32_bf16 v[68:71], v[116:119], v[244:247], v[68:71]
ds_read_b64_tr_b16 v[132:133], v8 offset:18688
s_cmp_lg_u32 s29, 3
s_cbranch_scc1 Ld_57
buffer_load_dwordx4 v19, s[12:15], s39 offen lds
Ld_57:
v_mfma_f32_16x16x32_bf16 v[64:67], v[116:119], v[240:243], v[64:67]
ds_read_b64_tr_b16 v[134:135], v8 offset:23296
s_waitcnt lgkmcnt(4)
v_mfma_f32_16x16x32_bf16 v[72:75], v[120:123], v[240:243], v[72:75]
ds_read_b64_tr_b16 v[104:105], v8 offset:27648
v_mfma_f32_16x16x32_bf16 v[76:79], v[120:123], v[244:247], v[76:79]
ds_read_b64_tr_b16 v[106:107], v8 offset:32256
v_mfma_f32_16x16x32_bf16 v[84:87], v[124:127], v[244:247], v[84:87]
ds_read_b64_tr_b16 v[108:109], v8 offset:27680
v_mfma_f32_16x16x32_bf16 v[80:83], v[124:127], v[240:243], v[80:83]
ds_read_b64_tr_b16 v[110:111], v8 offset:32288
s_waitcnt lgkmcnt(4)
v_mfma_f32_16x16x32_bf16 v[88:91], v[128:131], v[240:243], v[88:91]
ds_read_b64_tr_b16 v[112:113], v8 offset:27712
v_mfma_f32_16x16x32_bf16 v[92:95], v[128:131], v[244:247], v[92:95]
ds_read_b64_tr_b16 v[114:115], v8 offset:32320
v_mfma_f32_16x16x32_bf16 v[100:103], v[132:135], v[244:247], v[100:103]
ds_read_b64_tr_b16 v[116:117], v8 offset:27744
v_mfma_f32_16x16x32_bf16 v[96:99], v[132:135], v[240:243], v[96:99]
ds_read_b64_tr_b16 v[118:119], v8 offset:32352
s_waitcnt vmcnt(4)
s_barrier
s_waitcnt lgkmcnt(4)
v_mfma_f32_16x16x32_bf16 v[32:35], v[104:107], v[248:251], v[32:35]
ds_read_b64_tr_b16 v[120:121], v8 offset:27776
v_mfma_f32_16x16x32_bf16 v[36:39], v[104:107], v[252:255], v[36:39]
ds_read_b64_tr_b16 v[122:123], v8 offset:32384
v_mfma_f32_16x16x32_bf16 v[44:47], v[108:111], v[252:255], v[44:47]
ds_read_b64_tr_b16 v[124:125], v8 offset:27808
v_mfma_f32_16x16x32_bf16 v[40:43], v[108:111], v[248:251], v[40:43]
ds_read_b64_tr_b16 v[126:127], v8 offset:32416
s_waitcnt lgkmcnt(4)
v_mfma_f32_16x16x32_bf16 v[48:51], v[112:115], v[248:251], v[48:51]
ds_read_b64_tr_b16 v[128:129], v8 offset:27840
v_mfma_f32_16x16x32_bf16 v[52:55], v[112:115], v[252:255], v[52:55]
ds_read_b64_tr_b16 v[130:131], v8 offset:32448
v_mfma_f32_16x16x32_bf16 v[60:63], v[116:119], v[252:255], v[60:63]
ds_read_b64_tr_b16 v[132:133], v8 offset:27872
v_mfma_f32_16x16x32_bf16 v[56:59], v[116:119], v[248:251], v[56:59]
ds_read_b64_tr_b16 v[134:135], v8 offset:32480
s_waitcnt lgkmcnt(4)
v_mfma_f32_16x16x32_bf16 v[64:67], v[120:123], v[248:251], v[64:67]
ds_read_b64_tr_b16 v[104:105], v8 offset:27904
v_mfma_f32_16x16x32_bf16 v[68:71], v[120:123], v[252:255], v[68:71]
ds_read_b64_tr_b16 v[106:107], v8 offset:32512
v_mfma_f32_16x16x32_bf16 v[76:79], v[124:127], v[252:255], v[76:79]
ds_read_b64_tr_b16 v[108:109], v8 offset:36864
v_mfma_f32_16x16x32_bf16 v[72:75], v[124:127], v[248:251], v[72:75]
ds_read_b64_tr_b16 v[110:111], v8 offset:41472
s_waitcnt lgkmcnt(4)
v_mfma_f32_16x16x32_bf16 v[80:83], v[128:131], v[248:251], v[80:83]
ds_read_b64_tr_b16 v[112:113], v8 offset:36896
v_mfma_f32_16x16x32_bf16 v[84:87], v[128:131], v[252:255], v[84:87]
ds_read_b64_tr_b16 v[114:115], v8 offset:41504
v_mfma_f32_16x16x32_bf16 v[92:95], v[132:135], v[252:255], v[92:95]
ds_read_b64_tr_b16 v[116:117], v8 offset:36928
v_mfma_f32_16x16x32_bf16 v[88:91], v[132:135], v[248:251], v[88:91]
ds_read_b64_tr_b16 v[118:119], v8 offset:41536
s_waitcnt lgkmcnt(4)
v_mfma_f32_16x16x32_bf16 v[96:99], v[104:107], v[248:251], v[96:99]
ds_read_b64_tr_b16 v[120:121], v8 offset:36960
v_mfma_f32_16x16x32_bf16 v[100:103], v[104:107], v[252:255], v[100:103]
ds_read_b64_tr_b16 v[122:123], v8 offset:41568
s_waitcnt vmcnt(2)
s_barrier
v_mfma_f32_16x16x32_bf16 v[36:39], v[108:111], v[140:143], v[36:39]
ds_read_b64_tr_b16 v[124:125], v8 offset:36992
v_mfma_f32_16x16x32_bf16 v[32:35], v[108:111], v[136:139], v[32:35]
ds_read_b64_tr_b16 v[126:127], v8 offset:41600
s_waitcnt lgkmcnt(4)
v_mfma_f32_16x16x32_bf16 v[40:43], v[112:115], v[136:139], v[40:43]
ds_read_b64_tr_b16 v[128:129], v8 offset:37024
v_mfma_f32_16x16x32_bf16 v[44:47], v[112:115], v[140:143], v[44:47]
ds_read_b64_tr_b16 v[130:131], v8 offset:41632
v_mfma_f32_16x16x32_bf16 v[52:55], v[116:119], v[140:143], v[52:55]
ds_read_b64_tr_b16 v[132:133], v8 offset:37056
v_mfma_f32_16x16x32_bf16 v[48:51], v[116:119], v[136:139], v[48:51]
ds_read_b64_tr_b16 v[134:135], v8 offset:41664
s_waitcnt lgkmcnt(4)
v_mfma_f32_16x16x32_bf16 v[56:59], v[120:123], v[136:139], v[56:59]
ds_read_b64_tr_b16 v[104:105], v8 offset:37088
v_mfma_f32_16x16x32_bf16 v[60:63], v[120:123], v[140:143], v[60:63]
ds_read_b64_tr_b16 v[106:107], v8 offset:41696
v_mfma_f32_16x16x32_bf16 v[68:71], v[124:127], v[140:143], v[68:71]
ds_read_b64_tr_b16 v[108:109], v8 offset:37120
v_mfma_f32_16x16x32_bf16 v[64:67], v[124:127], v[136:139], v[64:67]
ds_read_b64_tr_b16 v[110:111], v8 offset:41728
s_waitcnt lgkmcnt(4)
v_mfma_f32_16x16x32_bf16 v[72:75], v[128:131], v[136:139], v[72:75]
ds_read_b64_tr_b16 v[112:113], v8 offset:46080
v_mfma_f32_16x16x32_bf16 v[76:79], v[128:131], v[140:143], v[76:79]
ds_read_b64_tr_b16 v[114:115], v8 offset:50688
v_mfma_f32_16x16x32_bf16 v[84:87], v[132:135], v[140:143], v[84:87]
ds_read_b64_tr_b16 v[116:117], v8 offset:46112
v_mfma_f32_16x16x32_bf16 v[80:83], v[132:135], v[136:139], v[80:83]
ds_read_b64_tr_b16 v[118:119], v8 offset:50720
s_waitcnt lgkmcnt(4)
v_mfma_f32_16x16x32_bf16 v[88:91], v[104:107], v[136:139], v[88:91]
ds_read_b64_tr_b16 v[120:121], v8 offset:46144
v_mfma_f32_16x16x32_bf16 v[92:95], v[104:107], v[140:143], v[92:95]
ds_read_b64_tr_b16 v[122:123], v8 offset:50752
v_mfma_f32_16x16x32_bf16 v[100:103], v[108:111], v[140:143], v[100:103]
ds_read_b64_tr_b16 v[124:125], v8 offset:46176
v_mfma_f32_16x16x32_bf16 v[96:99], v[108:111], v[136:139], v[96:99]
ds_read_b64_tr_b16 v[126:127], v8 offset:50784
s_waitcnt vmcnt(0)
s_barrier
s_waitcnt lgkmcnt(4)
v_mfma_f32_16x16x32_bf16 v[32:35], v[112:115], v[144:147], v[32:35]
ds_read_b64_tr_b16 v[128:129], v8 offset:46208
v_mfma_f32_16x16x32_bf16 v[36:39], v[112:115], v[148:151], v[36:39]
ds_read_b64_tr_b16 v[130:131], v8 offset:50816
v_mfma_f32_16x16x32_bf16 v[44:47], v[116:119], v[148:151], v[44:47]
ds_read_b64_tr_b16 v[132:133], v8 offset:46240
v_mfma_f32_16x16x32_bf16 v[40:43], v[116:119], v[144:147], v[40:43]
ds_read_b64_tr_b16 v[134:135], v8 offset:50848
s_waitcnt lgkmcnt(4)
v_mfma_f32_16x16x32_bf16 v[48:51], v[120:123], v[144:147], v[48:51]
ds_read_b64_tr_b16 v[104:105], v8 offset:46272
v_mfma_f32_16x16x32_bf16 v[52:55], v[120:123], v[148:151], v[52:55]
ds_read_b64_tr_b16 v[106:107], v8 offset:50880
v_mfma_f32_16x16x32_bf16 v[60:63], v[124:127], v[148:151], v[60:63]
ds_read_b64_tr_b16 v[108:109], v8 offset:46304
v_mfma_f32_16x16x32_bf16 v[56:59], v[124:127], v[144:147], v[56:59]
ds_read_b64_tr_b16 v[110:111], v8 offset:50912
s_waitcnt lgkmcnt(4)
v_mfma_f32_16x16x32_bf16 v[64:67], v[128:131], v[144:147], v[64:67]
ds_read_b64_tr_b16 v[112:113], v8 offset:46336
v_mfma_f32_16x16x32_bf16 v[68:71], v[128:131], v[148:151], v[68:71]
ds_read_b64_tr_b16 v[114:115], v8 offset:50944
v_mfma_f32_16x16x32_bf16 v[76:79], v[132:135], v[148:151], v[76:79]
ds_read_b64_tr_b16 v[116:117], v9 offset:0
v_mfma_f32_16x16x32_bf16 v[72:75], v[132:135], v[144:147], v[72:75]
ds_read_b64_tr_b16 v[118:119], v9 offset:4608
s_waitcnt lgkmcnt(4)
v_mfma_f32_16x16x32_bf16 v[80:83], v[104:107], v[144:147], v[80:83]
ds_read_b64_tr_b16 v[120:121], v9 offset:32
v_mfma_f32_16x16x32_bf16 v[84:87], v[104:107], v[148:151], v[84:87]
ds_read_b64_tr_b16 v[122:123], v9 offset:4640
v_mfma_f32_16x16x32_bf16 v[92:95], v[108:111], v[148:151], v[92:95]
ds_read_b64_tr_b16 v[124:125], v9 offset:64
v_mfma_f32_16x16x32_bf16 v[88:91], v[108:111], v[144:147], v[88:91]
ds_read_b64_tr_b16 v[126:127], v9 offset:4672
s_waitcnt lgkmcnt(4)
v_mfma_f32_16x16x32_bf16 v[96:99], v[112:115], v[144:147], v[96:99]
ds_read_b64_tr_b16 v[128:129], v9 offset:96
v_mfma_f32_16x16x32_bf16 v[100:103], v[112:115], v[148:151], v[100:103]
ds_read_b64_tr_b16 v[130:131], v9 offset:4704
v_mfma_f32_16x16x32_bf16 v[36:39], v[116:119], v[156:159], v[36:39]
ds_read_b64_tr_b16 v[132:133], v9 offset:128
v_mfma_f32_16x16x32_bf16 v[32:35], v[116:119], v[152:155], v[32:35]
ds_read_b64_tr_b16 v[134:135], v9 offset:4736
s_waitcnt lgkmcnt(4)
v_mfma_f32_16x16x32_bf16 v[40:43], v[120:123], v[152:155], v[40:43]
ds_read_b64_tr_b16 v[104:105], v9 offset:160
v_mfma_f32_16x16x32_bf16 v[44:47], v[120:123], v[156:159], v[44:47]
ds_read_b64_tr_b16 v[106:107], v9 offset:4768
v_mfma_f32_16x16x32_bf16 v[52:55], v[124:127], v[156:159], v[52:55]
ds_read_b64_tr_b16 v[108:109], v9 offset:192
v_mfma_f32_16x16x32_bf16 v[48:51], v[124:127], v[152:155], v[48:51]
ds_read_b64_tr_b16 v[110:111], v9 offset:4800
s_waitcnt lgkmcnt(4)
v_mfma_f32_16x16x32_bf16 v[56:59], v[128:131], v[152:155], v[56:59]
ds_read_b64_tr_b16 v[112:113], v9 offset:224
v_mfma_f32_16x16x32_bf16 v[60:63], v[128:131], v[156:159], v[60:63]
ds_read_b64_tr_b16 v[114:115], v9 offset:4832
v_mfma_f32_16x16x32_bf16 v[68:71], v[132:135], v[156:159], v[68:71]
ds_read_b64_tr_b16 v[116:117], v9 offset:256
v_mfma_f32_16x16x32_bf16 v[64:67], v[132:135], v[152:155], v[64:67]
ds_read_b64_tr_b16 v[118:119], v9 offset:4864
s_waitcnt lgkmcnt(4)
v_mfma_f32_16x16x32_bf16 v[72:75], v[104:107], v[152:155], v[72:75]
v_mfma_f32_16x16x32_bf16 v[76:79], v[104:107], v[156:159], v[76:79]
v_mfma_f32_16x16x32_bf16 v[84:87], v[108:111], v[156:159], v[84:87]
v_mfma_f32_16x16x32_bf16 v[80:83], v[108:111], v[152:155], v[80:83]
s_waitcnt lgkmcnt(0)
v_mfma_f32_16x16x32_bf16 v[88:91], v[112:115], v[152:155], v[88:91]
v_mfma_f32_16x16x32_bf16 v[92:95], v[112:115], v[156:159], v[92:95]
v_mfma_f32_16x16x32_bf16 v[100:103], v[116:119], v[156:159], v[100:103]
v_mfma_f32_16x16x32_bf16 v[96:99], v[116:119], v[152:155], v[96:99]
s_mul_i32 s59, s3, 9216
s_add_u32 s59, s59, 29360128
s_mul_i32 s33, s30, 4352
s_add_u32 s59, s59, s33
s_lshl_b32 s33, s29, 1
s_cmp_eq_u32 s33, s30
s_cselect_b32 s56, 0x7f000000, s59
s_add_u32 s33, s33, 1
s_cmp_eq_u32 s33, s30
s_cselect_b32 s57, 0x7f000000, s59
v_add_u32 v30, 64512, v3
v_cvt_pk_bf16_f32 v136, v32, v33
v_cvt_pk_bf16_f32 v137, v34, v35
v_cvt_pk_bf16_f32 v138, v40, v41
v_cvt_pk_bf16_f32 v139, v42, v43
buffer_store_dwordx4 v[136:139], v3, s[16:19], s56 offen offset:0 sc1
v_cvt_pk_bf16_f32 v140, v48, v49
v_cvt_pk_bf16_f32 v141, v50, v51
v_cvt_pk_bf16_f32 v142, v56, v57
v_cvt_pk_bf16_f32 v143, v58, v59
buffer_store_dwordx4 v[140:143], v3, s[16:19], s56 offen offset:1024 sc1
v_cvt_pk_bf16_f32 v144, v64, v65
v_cvt_pk_bf16_f32 v145, v66, v67
v_cvt_pk_bf16_f32 v146, v72, v73
v_cvt_pk_bf16_f32 v147, v74, v75
buffer_store_dwordx4 v[144:147], v3, s[16:19], s56 offen offset:2048 sc1
v_cvt_pk_bf16_f32 v148, v80, v81
v_cvt_pk_bf16_f32 v149, v82, v83
v_cvt_pk_bf16_f32 v150, v88, v89
v_cvt_pk_bf16_f32 v151, v90, v91
buffer_store_dwordx4 v[148:151], v3, s[16:19], s56 offen offset:3072 sc1
v_cvt_pk_bf16_f32 v168, v96, v97
v_cvt_pk_bf16_f32 v169, v98, v99
v_cvt_pk_bf16_f32 v152, v36, v37
v_cvt_pk_bf16_f32 v153, v38, v39
v_cvt_pk_bf16_f32 v154, v44, v45
v_cvt_pk_bf16_f32 v155, v46, v47
buffer_store_dwordx4 v[152:155], v4, s[16:19], s57 offen offset:0 sc1
v_cvt_pk_bf16_f32 v156, v52, v53
v_cvt_pk_bf16_f32 v157, v54, v55
v_cvt_pk_bf16_f32 v158, v60, v61
v_cvt_pk_bf16_f32 v159, v62, v63
buffer_store_dwordx4 v[156:159], v4, s[16:19], s57 offen offset:1024 sc1
v_cvt_pk_bf16_f32 v160, v68, v69
v_cvt_pk_bf16_f32 v161, v70, v71
v_cvt_pk_bf16_f32 v162, v76, v77
v_cvt_pk_bf16_f32 v163, v78, v79
buffer_store_dwordx4 v[160:163], v4, s[16:19], s57 offen offset:2048 sc1
v_cvt_pk_bf16_f32 v164, v84, v85
v_cvt_pk_bf16_f32 v165, v86, v87
v_cvt_pk_bf16_f32 v166, v92, v93
v_cvt_pk_bf16_f32 v167, v94, v95
buffer_store_dwordx4 v[164:167], v4, s[16:19], s57 offen offset:3072 sc1
v_cvt_pk_bf16_f32 v170, v100, v101
v_cvt_pk_bf16_f32 v171, v102, v103
s_nop 0
v_permlane32_swap_b32 v168, v170
v_permlane32_swap_b32 v169, v171
buffer_store_dwordx4 v[168:171], v5, s[16:19], s59 offen sc1
s_cmp_lg_u32 s56, 0x7f000000
s_cbranch_scc1 Lo_58
ds_write_b128 v30, v[136:139] offset:0
ds_write_b128 v30, v[140:143] offset:1024
ds_write_b128 v30, v[144:147] offset:2048
ds_write_b128 v30, v[148:151] offset:3072
Lo_58:
s_cmp_lg_u32 s57, 0x7f000000
s_cbranch_scc1 Lo_59
ds_write_b128 v30, v[152:155] offset:0
ds_write_b128 v30, v[156:159] offset:1024
ds_write_b128 v30, v[160:163] offset:2048
ds_write_b128 v30, v[164:167] offset:3072
Lo_59:
s_waitcnt lgkmcnt(0)
s_lshl_b32 s33, s31, 6
s_add_u32 s33, s33, 12713984
v_add_lshl_u32 v28, s33, v2, 2
buffer_load_dword v29, v28, s[16:19], 0 offen sc1
s_lshl_b32 s69, s32, 4
s_add_u32 s69, s69, s30
s_add_u32 s69, s69, 0
s_lshl_b32 s33, s69, 4
v_and_b32 v20, 15, v2
v_add_u32 v20, s33, v20
v_mul_u32_u24 v20, 1152, v20
v_lshrrev_b32 v21, 4, v2
v_lshl_add_u32 v20, v21, 3, v20
s_mul_i32 s33, s31, 288
v_add_u32 v20, s33, v20
s_lshl_b32 s61, s29, 6
buffer_load_dwordx2 v[22:23], v20, s[20:23], s61 offen
buffer_load_dwordx2 v[24:25], v20, s[20:23], s61 offen offset:32
buffer_load_dwordx2 v[26:27], v20, s[20:23], 0 offen offset:256
s_lshl_b32 s33, s32, 2
s_add_u32 s33, s33, s31
s_lshl_b32 s33, s33, 3
s_lshr_b32 s59, s30, 1
s_add_u32 s33, s33, s59
s_add_u32 s38, s33, 0
s_waitcnt vmcnt(4)
s_lshl_b32 s33, s97, 2
s_add_u32 s33, s33, 51052544
v_mov_b32 v30, 0
v_mov_b32 v31, s68
s_mov_b64 exec, 1
buffer_store_dword v31, v30, s[16:19], s33 offen sc1
s_mov_b64 exec, -1
s_andn2_b32 s33, s2, 7
s_lshr_b32 s59, s30, 1
s_add_u32 s33, s33, s59
s_add_u32 s33, s33, 0
s_lshl_b32 s33, s33, 5
s_add_u32 s33, s33, 12763136
v_lshlrev_b32 v32, 0, v2
v_add_lshl_u32 v32, s33, v32, 2
s_mul_i32 s59, s38, 9216
s_add_u32 s59, s59, 29360128
s_and_b32 s33, s30, 1
s_lshl_b32 s38, s33, 12
s_add_u32 s60, s59, s38
s_lshl_b32 s33, s33, 9
s_add_u32 s59, s59, s33
v_and_b32 v37, 31, v2
v_lshlrev_b32 v37, 4, v37
v_lshrrev_b32 v38, 5, v2
v_lshl_add_u32 v37, v38, 3, v37
v_add_u32 v37, 8192, v37
s_waitcnt vmcnt(4)
s_mov_b32 s58, 0x8000
LLp_60:
v_cmp_ne_u32 vcc, s68, v29
s_nop 4
s_cbranch_vccz LBq_61
buffer_load_dword v29, v28, s[16:19], 0 offen sc1
s_sub_u32 s58, s58, 1
s_waitcnt vmcnt(0)
s_cmp_gt_i32 s58, 0
s_cbranch_scc1 LLp_60
LBq_61:
v_lshrrev_b32 v38, 1, v2
v_lshlrev_b32 v38, 6, v38
v_and_b32 v39, 1, v2
v_lshl_add_u32 v38, v39, 4, v38
s_lshr_b32 s39, s69, 1
s_mul_i32 s39, s39, 36864
s_and_b32 s33, s69, 1
s_lshl_b32 s33, s33, 5
s_add_u32 s39, s39, s33
s_mul_i32 s33, s31, 9216
s_add_u32 s39, s39, s33
s_add_u32 s39, s39, 6815744
s_lshl_b32 s33, s29, 11
s_add_u32 s33, s33, s39
s_add_u32 m0, s37, 138240
s_nop 0
buffer_load_dwordx4 v38, s[16:19], s33 offen sc1 lds
s_cmp_lg_u32 s29, 0
s_cbranch_scc1 Lu_62
s_add_u32 s39, s39, 8192
s_mov_b32 m0, 142336
s_mov_b32 exec_hi, 0
buffer_load_dwordx4 v38, s[16:19], s39 offen sc1 lds
s_mov_b64 exec, -1
Lu_62:
s_add_u32 s69, s69, 8
v_lshrrev_b32 v38, 1, v2
v_lshlrev_b32 v38, 6, v38
v_and_b32 v39, 1, v2
v_lshl_add_u32 v38, v39, 4, v38
s_lshr_b32 s39, s69, 1
s_mul_i32 s39, s39, 36864
s_and_b32 s33, s69, 1
s_lshl_b32 s33, s33, 5
s_add_u32 s39, s39, s33
s_mul_i32 s33, s31, 9216
s_add_u32 s39, s39, s33
s_add_u32 s39, s39, 6815744
s_lshl_b32 s33, s29, 11
s_add_u32 s33, s33, s39
s_add_u32 m0, s37, 143360
s_nop 0
buffer_load_dwordx4 v38, s[16:19], s33 offen sc1 lds
s_cmp_lg_u32 s29, 0
s_cbranch_scc1 Lu_63
s_add_u32 s39, s39, 8192
s_mov_b32 m0, 147456
s_mov_b32 exec_hi, 0
buffer_load_dwordx4 v38, s[16:19], s39 offen sc1 lds
s_mov_b64 exec, -1
Lu_63:
s_mov_b64 exec, 0xff
buffer_load_dword v33, v32, s[16:19], 0 offen sc1
s_mov_b64 exec, -1
s_waitcnt vmcnt(0)
s_mov_b64 exec, 0xff
s_mov_b32 s58, 0x8000
LLp_64:
v_cmp_ne_u32 vcc, s68, v33
s_nop 4
s_cbranch_vccz LBq_65
buffer_load_dword v33, v32, s[16:19], 0 offen sc1
s_sub_u32 s58, s58, 1
s_waitcnt vmcnt(0)
s_cmp_gt_i32 s58, 0
s_cbranch_scc1 LLp_64
LBq_65:
s_mov_b64 exec, -1
s_barrier
s_add_u32 s39, s60, s37
s_add_u32 s33, s37, 64512
v_add_u32 v36, s33, v3
s_cmp_eq_u32 s30, 0
s_cbranch_scc1 Lo_66
buffer_load_dwordx4 v[136:139], v3, s[16:19], s39 offen sc1
Lo_66:
s_cbranch_scc0 Lo_67
ds_read_b128 v[136:139], v36
Lo_67:
s_add_u32 s39, s39, 2363648
s_cmp_eq_u32 s30, 1
s_cbranch_scc1 Lo_68
buffer_load_dwordx4 v[140:143], v3, s[16:19], s39 offen sc1
Lo_68:
s_cbranch_scc0 Lo_69
ds_read_b128 v[140:143], v36
Lo_69:
s_add_u32 s39, s39, 2363648
s_cmp_eq_u32 s30, 2
s_cbranch_scc1 Lo_70
buffer_load_dwordx4 v[144:147], v3, s[16:19], s39 offen sc1
Lo_70:
s_cbranch_scc0 Lo_71
ds_read_b128 v[144:147], v36
Lo_71:
s_add_u32 s39, s39, 2363648
s_cmp_eq_u32 s30, 3
s_cbranch_scc1 Lo_72
buffer_load_dwordx4 v[148:151], v3, s[16:19], s39 offen sc1
Lo_72:
s_cbranch_scc0 Lo_73
ds_read_b128 v[148:151], v36
Lo_73:
s_add_u32 s39, s39, 2363648
s_cmp_eq_u32 s30, 4
s_cbranch_scc1 Lo_74
buffer_load_dwordx4 v[152:155], v3, s[16:19], s39 offen sc1
Lo_74:
s_cbranch_scc0 Lo_75
ds_read_b128 v[152:155], v36
Lo_75:
s_add_u32 s39, s39, 2363648
s_cmp_eq_u32 s30, 5
s_cbranch_scc1 Lo_76
buffer_load_dwordx4 v[156:159], v3, s[16:19], s39 offen sc1
Lo_76:
s_cbranch_scc0 Lo_77
ds_read_b128 v[156:159], v36
Lo_77:
s_add_u32 s39, s39, 2363648
s_cmp_eq_u32 s30, 6
s_cbranch_scc1 Lo_78
buffer_load_dwordx4 v[160:163], v3, s[16:19], s39 offen sc1
Lo_78:
s_cbranch_scc0 Lo_79
ds_read_b128 v[160:163], v36
Lo_79:
s_add_u32 s39, s39, 2363648
s_cmp_eq_u32 s30, 7
s_cbranch_scc1 Lo_80
buffer_load_dwordx4 v[164:167], v3, s[16:19], s39 offen sc1
Lo_80:
s_cbranch_scc0 Lo_81
ds_read_b128 v[164:167], v36
Lo_81:
s_cmp_lg_u32 s29, 0
s_cbranch_scc1 Lv_82
buffer_load_dwordx2 v[168:169], v37, s[16:19], s59 offen sc1
s_add_u32 s59, s59, 2363648
buffer_load_dwordx2 v[170:171], v37, s[16:19], s59 offen sc1
s_add_u32 s59, s59, 2363648
buffer_load_dwordx2 v[172:173], v37, s[16:19], s59 offen sc1
s_add_u32 s59, s59, 2363648
buffer_load_dwordx2 v[174:175], v37, s[16:19], s59 offen sc1
s_add_u32 s59, s59, 2363648
buffer_load_dwordx2 v[176:177], v37, s[16:19], s59 offen sc1
s_add_u32 s59, s59, 2363648
buffer_load_dwordx2 v[178:179], v37, s[16:19], s59 offen sc1
s_add_u32 s59, s59, 2363648
buffer_load_dwordx2 v[180:181], v37, s[16:19], s59 offen sc1
s_add_u32 s59, s59, 2363648
buffer_load_dwordx2 v[182:183], v37, s[16:19], s59 offen sc1
Lv_82:
v_lshlrev_b32 v34, 3, v2
s_add_u32 s33, s37, 138240
v_add_u32 v34, s33, v34
s_mov_b32 s62, 0x00003f80
s_mov_b32 s63, 0x3f800000
s_mov_b32 s56, 0xbfb8aa3b
s_mov_b32 s57, 0x3f317218
ds_read_b64_tr_b16 v[40:41], v34
ds_read_b64_tr_b16 v[42:43], v34 offset:512
s_waitcnt vmcnt(0) lgkmcnt(0)
v_dot2_f32_bf16 v48, v136, s62, 0
v_dot2_f32_bf16 v49, v136, s63, 0
v_dot2_f32_bf16 v50, v137, s62, 0
v_dot2_f32_bf16 v51, v137, s63, 0
v_dot2_f32_bf16 v52, v138, s62, 0
v_dot2_f32_bf16 v53, v138, s63, 0
v_dot2_f32_bf16 v54, v139, s62, 0
v_dot2_f32_bf16 v55, v139, s63, 0
v_dot2_f32_bf16 v48, v140, s62, v48
v_dot2_f32_bf16 v49, v140, s63, v49
v_dot2_f32_bf16 v50, v141, s62, v50
v_dot2_f32_bf16 v51, v141, s63, v51
v_dot2_f32_bf16 v52, v142, s62, v52
v_dot2_f32_bf16 v53, v142, s63, v53
v_dot2_f32_bf16 v54, v143, s62, v54
v_dot2_f32_bf16 v55, v143, s63, v55
v_dot2_f32_bf16 v48, v144, s62, v48
v_dot2_f32_bf16 v49, v144, s63, v49
v_dot2_f32_bf16 v50, v145, s62, v50
v_dot2_f32_bf16 v51, v145, s63, v51
v_dot2_f32_bf16 v52, v146, s62, v52
v_dot2_f32_bf16 v53, v146, s63, v53
v_dot2_f32_bf16 v54, v147, s62, v54
v_dot2_f32_bf16 v55, v147, s63, v55
v_dot2_f32_bf16 v48, v148, s62, v48
v_dot2_f32_bf16 v49, v148, s63, v49
v_dot2_f32_bf16 v50, v149, s62, v50
v_dot2_f32_bf16 v51, v149, s63, v51
v_dot2_f32_bf16 v52, v150, s62, v52
v_dot2_f32_bf16 v53, v150, s63, v53
v_dot2_f32_bf16 v54, v151, s62, v54
v_dot2_f32_bf16 v55, v151, s63, v55
v_dot2_f32_bf16 v48, v152, s62, v48
v_dot2_f32_bf16 v49, v152, s63, v49
v_dot2_f32_bf16 v50, v153, s62, v50
v_dot2_f32_bf16 v51, v153, s63, v51
v_dot2_f32_bf16 v52, v154, s62, v52
v_dot2_f32_bf16 v53, v154, s63, v53
v_dot2_f32_bf16 v54, v155, s62, v54
v_dot2_f32_bf16 v55, v155, s63, v55
v_dot2_f32_bf16 v48, v156, s62, v48
v_dot2_f32_bf16 v49, v156, s63, v49
v_dot2_f32_bf16 v50, v157, s62, v50
v_dot2_f32_bf16 v51, v157, s63, v51
v_dot2_f32_bf16 v52, v158, s62, v52
v_dot2_f32_bf16 v53, v158, s63, v53
v_dot2_f32_bf16 v54, v159, s62, v54
v_dot2_f32_bf16 v55, v159, s63, v55
v_dot2_f32_bf16 v48, v160, s62, v48
v_dot2_f32_bf16 v49, v160, s63, v49
v_dot2_f32_bf16 v50, v161, s62, v50
v_dot2_f32_bf16 v51, v161, s63, v51
v_dot2_f32_bf16 v52, v162, s62, v52
v_dot2_f32_bf16 v53, v162, s63, v53
v_dot2_f32_bf16 v54, v163, s62, v54
v_dot2_f32_bf16 v55, v163, s63, v55
v_dot2_f32_bf16 v48, v164, s62, v48
v_dot2_f32_bf16 v49, v164, s63, v49
v_dot2_f32_bf16 v50, v165, s62, v50
v_dot2_f32_bf16 v51, v165, s63, v51
v_dot2_f32_bf16 v52, v166, s62, v52
v_dot2_f32_bf16 v53, v166, s63, v53
v_dot2_f32_bf16 v54, v167, s62, v54
v_dot2_f32_bf16 v55, v167, s63, v55
s_waitcnt lgkmcnt(0)
v_mul_f32 v48, s57, v48
v_mul_f32 v49, s57, v49
v_mul_f32 v50, s57, v50
v_mul_f32 v51, s57, v51
v_mul_f32 v52, s57, v52
v_mul_f32 v53, s57, v53
v_mul_f32 v54, s57, v54
v_mul_f32 v55, s57, v55
v_cvt_pk_bf16_f32 v64, v48, v49
v_cvt_pk_bf16_f32 v65, v50, v51
v_cvt_pk_bf16_f32 v66, v52, v53
v_cvt_pk_bf16_f32 v67, v54, v55
v_lshlrev_b32 v48, 16, v64
v_and_b32 v49, 0xffff0000, v64
v_lshlrev_b32 v50, 16, v65
v_and_b32 v51, 0xffff0000, v65
v_lshlrev_b32 v52, 16, v66
v_and_b32 v53, 0xffff0000, v66
v_lshlrev_b32 v54, 16, v67
v_and_b32 v55, 0xffff0000, v67
v_mul_f32 v80, s56, v48
v_mul_f32 v81, s56, v49
v_mul_f32 v82, s56, v50
v_mul_f32 v83, s56, v51
v_mul_f32 v84, s56, v52
v_mul_f32 v85, s56, v53
v_mul_f32 v86, s56, v54
v_mul_f32 v87, s56, v55
v_exp_f32 v80, v80
v_exp_f32 v81, v81
v_exp_f32 v82, v82
v_exp_f32 v83, v83
v_exp_f32 v84, v84
v_exp_f32 v85, v85
v_exp_f32 v86, v86
v_exp_f32 v87, v87
v_add_f32 v80, 1.0, v80
v_add_f32 v81, 1.0, v81
v_add_f32 v82, 1.0, v82
v_add_f32 v83, 1.0, v83
v_add_f32 v84, 1.0, v84
v_add_f32 v85, 1.0, v85
v_add_f32 v86, 1.0, v86
v_add_f32 v87, 1.0, v87
v_rcp_f32 v80, v80
v_rcp_f32 v81, v81
v_rcp_f32 v82, v82
v_rcp_f32 v83, v83
v_rcp_f32 v84, v84
v_rcp_f32 v85, v85
v_rcp_f32 v86, v86
v_rcp_f32 v87, v87
v_mul_f32 v48, v48, v80
v_mul_f32 v49, v49, v81
v_mul_f32 v50, v50, v82
v_mul_f32 v51, v51, v83
v_mul_f32 v52, v52, v84
v_mul_f32 v53, v53, v85
v_mul_f32 v54, v54, v86
v_mul_f32 v55, v55, v87
v_cvt_pk_bf16_f32 v64, v48, v49
v_cvt_pk_bf16_f32 v65, v50, v51
v_cvt_pk_bf16_f32 v66, v52, v53
v_cvt_pk_bf16_f32 v67, v54, v55
v_lshlrev_b32 v48, 16, v64
v_and_b32 v49, 0xffff0000, v64
v_lshlrev_b32 v80, 16, v40
v_and_b32 v81, 0xffff0000, v40
v_lshlrev_b32 v50, 16, v65
v_and_b32 v51, 0xffff0000, v65
v_lshlrev_b32 v82, 16, v41
v_and_b32 v83, 0xffff0000, v41
v_lshlrev_b32 v52, 16, v66
v_and_b32 v53, 0xffff0000, v66
v_lshlrev_b32 v84, 16, v42
v_and_b32 v85, 0xffff0000, v42
v_lshlrev_b32 v54, 16, v67
v_and_b32 v55, 0xffff0000, v67
v_lshlrev_b32 v86, 16, v43
v_and_b32 v87, 0xffff0000, v43
v_mul_f32 v48, v48, v80
v_mul_f32 v49, v49, v81
v_mul_f32 v50, v50, v82
v_mul_f32 v51, v51, v83
v_mul_f32 v52, v52, v84
v_mul_f32 v53, v53, v85
v_mul_f32 v54, v54, v86
v_mul_f32 v55, v55, v87
v_cvt_pk_bf16_f32 v64, v48, v49
v_cvt_pk_bf16_f32 v65, v50, v51
v_cvt_pk_bf16_f32 v66, v52, v53
v_cvt_pk_bf16_f32 v67, v54, v55
v_lshlrev_b32 v48, 16, v64
v_and_b32 v49, 0xffff0000, v64
v_lshlrev_b32 v80, 16, v22
v_and_b32 v81, 0xffff0000, v22
v_lshlrev_b32 v50, 16, v65
v_and_b32 v51, 0xffff0000, v65
v_lshlrev_b32 v82, 16, v23
v_and_b32 v83, 0xffff0000, v23
v_lshlrev_b32 v52, 16, v66
v_and_b32 v53, 0xffff0000, v66
v_lshlrev_b32 v84, 16, v24
v_and_b32 v85, 0xffff0000, v24
v_lshlrev_b32 v54, 16, v67
v_and_b32 v55, 0xffff0000, v67
v_lshlrev_b32 v86, 16, v25
v_and_b32 v87, 0xffff0000, v25
v_add_f32 v48, v48, v80
v_add_f32 v49, v49, v81
v_add_f32 v50, v50, v82
v_add_f32 v51, v51, v83
v_add_f32 v52, v52, v84
v_add_f32 v53, v53, v85
v_add_f32 v54, v54, v86
v_add_f32 v55, v55, v87
v_cvt_pk_bf16_f32 v96, v48, v49
v_cvt_pk_bf16_f32 v97, v50, v51
v_cvt_pk_bf16_f32 v98, v52, v53
v_cvt_pk_bf16_f32 v99, v54, v55
buffer_store_dwordx2 v[96:97], v20, s[24:27], s61 offen
buffer_store_dwordx2 v[98:99], v20, s[24:27], s61 offen offset:32
s_cmp_lg_u32 s29, 0
s_cbranch_scc1 LBw_83
ds_read_b64_tr_b16 v[44:45], v34 offset:4096
v_dot2_f32_bf16 v48, v168, s62, 0
v_dot2_f32_bf16 v49, v168, s63, 0
v_dot2_f32_bf16 v50, v169, s62, 0
v_dot2_f32_bf16 v51, v169, s63, 0
v_dot2_f32_bf16 v48, v170, s62, v48
v_dot2_f32_bf16 v49, v170, s63, v49
v_dot2_f32_bf16 v50, v171, s62, v50
v_dot2_f32_bf16 v51, v171, s63, v51
v_dot2_f32_bf16 v48, v172, s62, v48
v_dot2_f32_bf16 v49, v172, s63, v49
v_dot2_f32_bf16 v50, v173, s62, v50
v_dot2_f32_bf16 v51, v173, s63, v51
v_dot2_f32_bf16 v48, v174, s62, v48
v_dot2_f32_bf16 v49, v174, s63, v49
v_dot2_f32_bf16 v50, v175, s62, v50
v_dot2_f32_bf16 v51, v175, s63, v51
v_dot2_f32_bf16 v48, v176, s62, v48
v_dot2_f32_bf16 v49, v176, s63, v49
v_dot2_f32_bf16 v50, v177, s62, v50
v_dot2_f32_bf16 v51, v177, s63, v51
v_dot2_f32_bf16 v48, v178, s62, v48
v_dot2_f32_bf16 v49, v178, s63, v49
v_dot2_f32_bf16 v50, v179, s62, v50
v_dot2_f32_bf16 v51, v179, s63, v51
v_dot2_f32_bf16 v48, v180, s62, v48
v_dot2_f32_bf16 v49, v180, s63, v49
v_dot2_f32_bf16 v50, v181, s62, v50
v_dot2_f32_bf16 v51, v181, s63, v51
v_dot2_f32_bf16 v48, v182, s62, v48
v_dot2_f32_bf16 v49, v182, s63, v49
v_dot2_f32_bf16 v50, v183, s62, v50
v_dot2_f32_bf16 v51, v183, s63, v51
s_waitcnt lgkmcnt(0)
v_mul_f32 v48, s57, v48
v_mul_f32 v49, s57, v49
v_mul_f32 v50, s57, v50
v_mul_f32 v51, s57, v51
v_cvt_pk_bf16_f32 v64, v48, v49
v_cvt_pk_bf16_f32 v65, v50, v51
v_lshlrev_b32 v48, 16, v64
v_and_b32 v49, 0xffff0000, v64
v_lshlrev_b32 v50, 16, v65
v_and_b32 v51, 0xffff0000, v65
v_mul_f32 v80, s56, v48
v_mul_f32 v81, s56, v49
v_mul_f32 v82, s56, v50
v_mul_f32 v83, s56, v51
v_exp_f32 v80, v80
v_exp_f32 v81, v81
v_exp_f32 v82, v82
v_exp_f32 v83, v83
v_add_f32 v80, 1.0, v80
v_add_f32 v81, 1.0, v81
v_add_f32 v82, 1.0, v82
v_add_f32 v83, 1.0, v83
v_rcp_f32 v80, v80
v_rcp_f32 v81, v81
v_rcp_f32 v82, v82
v_rcp_f32 v83, v83
v_mul_f32 v48, v48, v80
v_mul_f32 v49, v49, v81
v_mul_f32 v50, v50, v82
v_mul_f32 v51, v51, v83
v_cvt_pk_bf16_f32 v64, v48, v49
v_cvt_pk_bf16_f32 v65, v50, v51
v_lshlrev_b32 v48, 16, v64
v_and_b32 v49, 0xffff0000, v64
v_lshlrev_b32 v80, 16, v44
v_and_b32 v81, 0xffff0000, v44
v_lshlrev_b32 v50, 16, v65
v_and_b32 v51, 0xffff0000, v65
v_lshlrev_b32 v82, 16, v45
v_and_b32 v83, 0xffff0000, v45
v_mul_f32 v48, v48, v80
v_mul_f32 v49, v49, v81
v_mul_f32 v50, v50, v82
v_mul_f32 v51, v51, v83
v_cvt_pk_bf16_f32 v64, v48, v49
v_cvt_pk_bf16_f32 v65, v50, v51
v_lshlrev_b32 v48, 16, v64
v_and_b32 v49, 0xffff0000, v64
v_lshlrev_b32 v80, 16, v26
v_and_b32 v81, 0xffff0000, v26
v_lshlrev_b32 v50, 16, v65
v_and_b32 v51, 0xffff0000, v65
v_lshlrev_b32 v82, 16, v27
v_and_b32 v83, 0xffff0000, v27
v_add_f32 v48, v48, v80
v_add_f32 v49, v49, v81
v_add_f32 v50, v50, v82
v_add_f32 v51, v51, v83
v_cvt_pk_bf16_f32 v100, v48, v49
v_cvt_pk_bf16_f32 v101, v50, v51
buffer_store_dwordx2 v[100:101], v20, s[24:27], 0 offen offset:256
LBw_83:
s_branch LB_end
LB_B:
s_setprio 1
s_mul_i32 s53, s30, 72
s_mul_i32 s52, s32, 9
s_add_u32 s53, s53, s52
s_lshl_b32 s52, s31, 1
s_add_u32 s52, s52, s53
s_add_u32 s53, s53, 8
s_waitcnt lgkmcnt(0)
s_mul_i32 s33, s30, 1152
s_mul_i32 s38, s31, 288
s_add_u32 s33, s33, s38
s_add_u32 s8, s4, s33
s_addc_u32 s9, s5, 0
s_sub_u32 s10, 5308416, s33
s_mul_i32 s33, s30, 663552
s_add_u32 s33, s33, s38
s_add_u32 s12, s6, s33
s_addc_u32 s13, s7, 0
s_sub_u32 s14, 5308416, s33
s_mov_b32 s92, s26
s_mov_b32 s93, s27
s_mov_b32 s26, 2359296
s_mov_b32 s27, 0x20000
s_add_u32 s59, s52, s29
s_cmp_ge_u32 s29, 2
s_cselect_b32 s59, s53, s59
s_mul_i32 s54, s29, 9216
s_add_u32 s54, s54, 110592
v_mov_b32 v29, 0
s_or_b32 s70, s70, 1
v_mov_b32 v30, s70
v_mov_b32 v31, 0
s_lshl_b32 s33, s2, 3
s_add_u32 s33, s33, s29
s_cmp_lg_u32 s33, 3
s_cbranch_scc1 Lm_86
s_mov_b64 exec, 1
global_atomic_cmpswap v29, v[30:31], s[92:93] sc1
s_mov_b64 exec, -1
Lm_86:
s_lshl_b32 s60, s59, 8
v_lshl_add_u32 v38, v2, 2, s60
global_load_dword v32, v38, s[72:73]
global_load_dword v33, v38, s[74:75]
global_load_dword v34, v38, s[76:77]
global_load_dword v35, v38, s[78:79]
global_load_dword v36, v38, s[80:81]
global_load_dword v37, v38, s[82:83]
s_lshl_b32 s60, s59, 1
v_mov_b32 v40, s60
global_load_ushort v39, v40, s[84:85]
v_lshlrev_b32 v88, 3, v2
v_add_u32 v88, s54, v88
v_and_b32 v40, 15, v2
v_mul_u32_u24 v40, 544, v40
v_lshrrev_b32 v41, 4, v2
v_lshl_add_u32 v89, v41, 4, v40
v_add_u32 v89, s54, v89
s_mov_b32 s33, 0x55555556
v_mul_hi_u32 v251, v2, s33
v_mul_u32_u24 v250, 3, v251
v_sub_u32 v250, v2, v250
v_mul_u32_u24 v251, 9216, v251
v_lshl_add_u32 v250, v250, 7, v251
s_lshl_b32 s33, s32, 2
s_add_u32 s33, s33, s29
s_mul_i32 s39, s33, 165888
s_add_u32 s39, s39, 0
s_bfm_b64 exec, 54, 0
buffer_load_dword v251, v250, s[8:11], s39 offen
s_mov_b64 exec, -1
s_lshl_b32 s33, s29, 6
s_add_u32 s33, s33, 0
v_add_u32 v20, s33, v2
s_mov_b32 s33, 0xe38e38f
v_mul_hi_u32 v21, v20, s33
v_mul_u32_u24 v22, 18, v21
v_sub_u32 v22, v20, v22
v_lshlrev_b32 v22, 4, v22
v_mul_u32_u24 v23, 1152, v21
v_add_u32 v14, v23, v22
v_and_b32 v23, 3, v21
v_bfe_u32 v24, v21, 2, 2
v_lshl_add_u32 v23, v24, 3, v23
v_lshrrev_b32 v24, 4, v21
v_lshl_add_u32 v23, v24, 2, v23
v_mul_u32_u24 v23, 9216, v23
v_add_u32 v11, v23, v22
s_lshl_b32 s33, s29, 6
s_add_u32 s33, s33, 256
v_add_u32 v20, s33, v2
s_mov_b32 s33, 0xe38e38f
v_mul_hi_u32 v21, v20, s33
v_mul_u32_u24 v22, 18, v21
v_sub_u32 v22, v20, v22
v_lshlrev_b32 v22, 4, v22
v_mul_u32_u24 v23, 1152, v21
v_add_u32 v15, v23, v22
v_and_b32 v23, 3, v21
v_bfe_u32 v24, v21, 2, 2
v_lshl_add_u32 v23, v24, 3, v23
v_lshrrev_b32 v24, 4, v21
v_lshl_add_u32 v23, v24, 2, v23
v_mul_u32_u24 v23, 9216, v23
v_add_u32 v12, v23, v22
s_mov_b32 s33, 512
v_add_u32 v20, s33, v2
s_mov_b32 s33, 0xe38e38f
v_mul_hi_u32 v21, v20, s33
v_mul_u32_u24 v22, 18, v21
v_sub_u32 v22, v20, v22
v_lshlrev_b32 v22, 4, v22
v_mul_u32_u24 v23, 1152, v21
v_add_u32 v16, v23, v22
v_and_b32 v23, 3, v21
v_bfe_u32 v24, v21, 2, 2
v_lshl_add_u32 v23, v24, 3, v23
v_lshrrev_b32 v24, 4, v21
v_lshl_add_u32 v23, v24, 2, v23
v_mul_u32_u24 v23, 9216, v23
v_add_u32 v13, v23, v22
v_add_u32 v4, 4096, v3
v_add_u32 v5, 8192, v3
v_add_u32 v6, 12288, v3
v_add_u32 v7, 16384, v3
s_lshl_b32 s33, s32, 4
s_lshl_b32 s34, s28, 1
s_add_u32 s33, s33, s34
s_mul_i32 s34, s33, 18432
s_add_u32 s35, s34, 18432
v_lshrrev_b32 v20, 2, v2
v_mul_u32_u24 v20, 288, v20
v_and_b32 v21, 3, v2
v_lshl_add_u32 v8, v21, 3, v20
v_add_u32 v9, 55296, v8
v_add_u32 v10, 110592, v8
s_add_u32 s40, s31, 0
s_and_b32 s40, s40, 3
s_sub_u32 s33, s40, s31
s_lshl_b32 s33, s33, 3
s_add_u32 s33, s33, s3
s_mul_i32 s44, s33, 9216
s_add_u32 s44, s44, 9437184
s_mul_i32 s33, s30, 4352
s_add_u32 s44, s44, s33
s_mul_i32 s48, s40, 165888
s_add_u32 s41, s31, 1
s_and_b32 s41, s41, 3
s_sub_u32 s33, s41, s31
s_lshl_b32 s33, s33, 3
s_add_u32 s33, s33, s3
s_mul_i32 s45, s33, 9216
s_add_u32 s45, s45, 9437184
s_mul_i32 s33, s30, 4352
s_add_u32 s45, s45, s33
s_mul_i32 s49, s41, 165888
s_add_u32 s42, s31, 2
s_and_b32 s42, s42, 3
s_sub_u32 s33, s42, s31
s_lshl_b32 s33, s33, 3
s_add_u32 s33, s33, s3
s_mul_i32 s46, s33, 9216
s_add_u32 s46, s46, 9437184
s_mul_i32 s33, s30, 4352
s_add_u32 s46, s46, s33
s_mul_i32 s50, s42, 165888
s_add_u32 s43, s31, 3
s_and_b32 s43, s43, 3
s_sub_u32 s33, s43, s31
s_lshl_b32 s33, s33, 3
s_add_u32 s33, s33, s3
s_mul_i32 s47, s33, 9216
s_add_u32 s47, s47, 9437184
s_mul_i32 s33, s30, 4352
s_add_u32 s47, s47, s33
s_mul_i32 s51, s43, 165888
s_lshl_b32 s96, s32, 3
s_add_u32 s96, s96, s30
s_lshl_b32 s96, s96, 3
s_add_u32 s96, s96, s28
s_lshl_b32 s96, s96, 2
s_add_u32 s96, s96, s31
s_andn2_b32 s97, s2, 7
s_add_u32 s97, s97, s28
s_lshl_b32 s97, s97, 5
s_lshl_b32 s33, s30, 0
s_add_u32 s97, s97, s33
s_lshr_b32 s98, s30, 1
s_lshl_b32 s98, s98, 6
s_lshr_b32 s33, s2, 3
s_lshl_b32 s33, s33, 1
s_add_u32 s98, s98, s33
s_and_b32 s33, s30, 1
s_add_u32 s98, s98, s33
s_lshl_b32 s100, 1, s29
s_mov_b32 s101, 0
v_lshlrev_b32 v0, 2, v2
v_add_u32 v0, 163584, v0
s_barrier
s_cmp_ge_u32 s29, 3
s_cbranch_scc1 LBk_85
s_waitcnt vmcnt(1)
v_lshlrev_b32 v39, 16, v39
s_mov_b32 s60, 0x3fb8aa3b
s_mov_b32 s61, 0x32a57060
s_mov_b32 s62, 0x3f317218
s_mov_b32 s63, 0x3e22f983
v_mul_f32 v40, s60, v39
v_fma_f32 v41, v39, s60, -v40
v_fma_f32 v41, v39, s61, v41
v_exp_f32 v40, v40
v_mul_f32 v41, s62, v41
v_fma_f32 v40, v40, v41, v40
v_cvt_pk_bf16_f32 v39, v40, v40
v_lshlrev_b32 v39, 16, v39
v_lshlrev_b32 v40, 16, v32
v_lshlrev_b32 v41, 16, v33
v_mul_f32 v40, v39, v40
v_mul_f32 v41, v39, v41
v_mul_f32 v48, s60, v40
v_mul_f32 v49, s63, v41
v_lshlrev_b32 v40, 16, v34
v_lshlrev_b32 v41, 16, v35
v_lshlrev_b32 v42, 16, v36
v_lshlrev_b32 v43, 16, v37
v_mul_f32 v40, v39, v40
v_mul_f32 v41, v39, v41
v_pk_mul_f32 v[50:51], v[42:43], v[40:41] op_sel_hi:[1,0]
v_pk_fma_f32 v[50:51], v[42:43], v[40:41], v[50:51] op_sel:[1,1,0] op_sel_hi:[0,1,1] neg_lo:[1,0,0]
v_and_b32 v40, 0xffff0000, v32
v_and_b32 v41, 0xffff0000, v33
v_mul_f32 v40, v39, v40
v_mul_f32 v41, v39, v41
v_mul_f32 v68, s60, v40
v_mul_f32 v69, s63, v41
v_and_b32 v40, 0xffff0000, v34
v_and_b32 v41, 0xffff0000, v35
v_and_b32 v42, 0xffff0000, v36
v_and_b32 v43, 0xffff0000, v37
v_mul_f32 v40, v39, v40
v_mul_f32 v41, v39, v41
v_pk_mul_f32 v[70:71], v[42:43], v[40:41] op_sel_hi:[1,0]
v_pk_fma_f32 v[70:71], v[42:43], v[40:41], v[70:71] op_sel:[1,1,0] op_sel_hi:[0,1,1] neg_lo:[1,0,0]
v_exp_f32 v40, v48
v_fract_f32 v41, v49
v_cos_f32 v42, v41
v_sin_f32 v43, v41
v_exp_f32 v44, v68
v_fract_f32 v45, v69
v_cos_f32 v46, v45
v_sin_f32 v47, v45
v_pk_mul_f32 v[52:53], v[42:43], v[40:41] op_sel_hi:[1,0]
v_pk_mul_f32 v[72:73], v[46:47], v[44:45] op_sel_hi:[1,0]
v_mul_f32 v40, 0x41000000, v48
v_mul_f32 v41, 0x41000000, v49
v_exp_f32 v40, v40
v_fract_f32 v41, v41
v_cos_f32 v42, v41
v_sin_f32 v43, v41
v_mul_f32 v44, 0x41000000, v68
v_mul_f32 v45, 0x41000000, v69
v_exp_f32 v44, v44
v_fract_f32 v45, v45
v_cos_f32 v46, v45
v_sin_f32 v47, v45
v_pk_mul_f32 v[54:55], v[42:43], v[40:41] op_sel_hi:[1,0]
v_pk_mul_f32 v[74:75], v[46:47], v[44:45] op_sel_hi:[1,0]
v_mul_f32 v40, 0x43800000, v48
v_mul_f32 v41, 0x43800000, v49
v_exp_f32 v40, v40
v_fract_f32 v41, v41
v_cos_f32 v42, v41
v_sin_f32 v43, v41
v_mul_f32 v44, 0x43800000, v68
v_mul_f32 v45, 0x43800000, v69
v_exp_f32 v44, v44
v_fract_f32 v45, v45
v_cos_f32 v46, v45
v_sin_f32 v47, v45
v_pk_mul_f32 v[56:57], v[42:43], v[40:41] op_sel_hi:[1,0]
v_pk_mul_f32 v[76:77], v[46:47], v[44:45] op_sel_hi:[1,0]
v_pk_mul_f32 v[58:59], v[52:53], v[52:53] op_sel_hi:[1,0]
v_pk_fma_f32 v[58:59], v[52:53], v[52:53], v[58:59] op_sel:[1,1,0] op_sel_hi:[0,1,1] neg_lo:[1,0,0]
v_pk_mul_f32 v[78:79], v[72:73], v[72:73] op_sel_hi:[1,0]
v_pk_fma_f32 v[78:79], v[72:73], v[72:73], v[78:79] op_sel:[1,1,0] op_sel_hi:[0,1,1] neg_lo:[1,0,0]
v_pk_mul_f32 v[60:61], v[58:59], v[58:59] op_sel_hi:[1,0]
v_pk_fma_f32 v[60:61], v[58:59], v[58:59], v[60:61] op_sel:[1,1,0] op_sel_hi:[0,1,1] neg_lo:[1,0,0]
v_pk_mul_f32 v[80:81], v[78:79], v[78:79] op_sel_hi:[1,0]
v_pk_fma_f32 v[80:81], v[78:79], v[78:79], v[80:81] op_sel:[1,1,0] op_sel_hi:[0,1,1] neg_lo:[1,0,0]
v_mov_b32 v208, 1.0
v_mov_b32 v209, 0
v_mov_b32 v228, 1.0
v_mov_b32 v229, 0
v_pk_mul_f32 v[212:213], v[54:55], v[54:55] op_sel_hi:[1,0]
v_pk_mul_f32 v[232:233], v[74:75], v[74:75] op_sel_hi:[1,0]
v_pk_mul_f32 v[64:65], v[56:57], v[56:57] op_sel_hi:[1,0]
v_pk_mul_f32 v[84:85], v[76:77], v[76:77] op_sel_hi:[1,0]
v_pk_fma_f32 v[212:213], v[54:55], v[54:55], v[212:213] op_sel:[1,1,0] op_sel_hi:[0,1,1] neg_lo:[1,0,0]
v_pk_fma_f32 v[232:233], v[74:75], v[74:75], v[232:233] op_sel:[1,1,0] op_sel_hi:[0,1,1] neg_lo:[1,0,0]
v_pk_fma_f32 v[64:65], v[56:57], v[56:57], v[64:65] op_sel:[1,1,0] op_sel_hi:[0,1,1] neg_lo:[1,0,0]
v_pk_fma_f32 v[84:85], v[76:77], v[76:77], v[84:85] op_sel:[1,1,0] op_sel_hi:[0,1,1] neg_lo:[1,0,0]
v_pk_mul_f32 v[214:215], v[212:213], v[54:55] op_sel_hi:[1,0]
v_pk_mul_f32 v[234:235], v[232:233], v[74:75] op_sel_hi:[1,0]
v_pk_mul_f32 v[62:63], v[212:213], v[212:213] op_sel_hi:[1,0]
v_pk_mul_f32 v[82:83], v[232:233], v[232:233] op_sel_hi:[1,0]
v_pk_fma_f32 v[214:215], v[212:213], v[54:55], v[214:215] op_sel:[1,1,0] op_sel_hi:[0,1,1] neg_lo:[1,0,0]
v_pk_fma_f32 v[234:235], v[232:233], v[74:75], v[234:235] op_sel:[1,1,0] op_sel_hi:[0,1,1] neg_lo:[1,0,0]
v_pk_fma_f32 v[62:63], v[212:213], v[212:213], v[62:63] op_sel:[1,1,0] op_sel_hi:[0,1,1] neg_lo:[1,0,0]
v_pk_fma_f32 v[82:83], v[232:233], v[232:233], v[82:83] op_sel:[1,1,0] op_sel_hi:[0,1,1] neg_lo:[1,0,0]
v_pk_mul_f32 v[216:217], v[208:209], v[62:63] op_sel_hi:[1,0]
v_pk_mul_f32 v[236:237], v[228:229], v[82:83] op_sel_hi:[1,0]
v_pk_mul_f32 v[218:219], v[54:55], v[62:63] op_sel_hi:[1,0]
v_pk_mul_f32 v[238:239], v[74:75], v[82:83] op_sel_hi:[1,0]
v_pk_mul_f32 v[220:221], v[212:213], v[62:63] op_sel_hi:[1,0]
v_pk_mul_f32 v[240:241], v[232:233], v[82:83] op_sel_hi:[1,0]
v_pk_mul_f32 v[222:223], v[214:215], v[62:63] op_sel_hi:[1,0]
v_pk_mul_f32 v[242:243], v[234:235], v[82:83] op_sel_hi:[1,0]
v_pk_fma_f32 v[216:217], v[208:209], v[62:63], v[216:217] op_sel:[1,1,0] op_sel_hi:[0,1,1] neg_lo:[1,0,0]
v_pk_fma_f32 v[236:237], v[228:229], v[82:83], v[236:237] op_sel:[1,1,0] op_sel_hi:[0,1,1] neg_lo:[1,0,0]
v_pk_fma_f32 v[218:219], v[54:55], v[62:63], v[218:219] op_sel:[1,1,0] op_sel_hi:[0,1,1] neg_lo:[1,0,0]
v_pk_fma_f32 v[238:239], v[74:75], v[82:83], v[238:239] op_sel:[1,1,0] op_sel_hi:[0,1,1] neg_lo:[1,0,0]
v_pk_fma_f32 v[220:221], v[212:213], v[62:63], v[220:221] op_sel:[1,1,0] op_sel_hi:[0,1,1] neg_lo:[1,0,0]
v_pk_fma_f32 v[240:241], v[232:233], v[82:83], v[240:241] op_sel:[1,1,0] op_sel_hi:[0,1,1] neg_lo:[1,0,0]
v_pk_fma_f32 v[222:223], v[214:215], v[62:63], v[222:223] op_sel:[1,1,0] op_sel_hi:[0,1,1] neg_lo:[1,0,0]
v_pk_fma_f32 v[242:243], v[234:235], v[82:83], v[242:243] op_sel:[1,1,0] op_sel_hi:[0,1,1] neg_lo:[1,0,0]
v_cvt_pk_bf16_f32 v90, v208, v209
v_cvt_pk_bf16_f32 v91, v228, v229
ds_write_b64 v88, v[90:91] offset:0
v_cvt_pk_bf16_f32 v92, v54, v55
v_cvt_pk_bf16_f32 v93, v74, v75
ds_write_b64 v88, v[92:93] offset:544
v_cvt_pk_bf16_f32 v94, v212, v213
v_cvt_pk_bf16_f32 v95, v232, v233
ds_write_b64 v88, v[94:95] offset:1088
v_cvt_pk_bf16_f32 v90, v214, v215
v_cvt_pk_bf16_f32 v91, v234, v235
ds_write_b64 v88, v[90:91] offset:1632
v_pk_mul_f32 v[208:209], v[216:217], v[62:63] op_sel_hi:[1,0]
v_pk_mul_f32 v[228:229], v[236:237], v[82:83] op_sel_hi:[1,0]
v_pk_mul_f32 v[210:211], v[218:219], v[62:63] op_sel_hi:[1,0]
v_pk_mul_f32 v[230:231], v[238:239], v[82:83] op_sel_hi:[1,0]
v_pk_mul_f32 v[212:213], v[220:221], v[62:63] op_sel_hi:[1,0]
v_pk_mul_f32 v[232:233], v[240:241], v[82:83] op_sel_hi:[1,0]
v_pk_mul_f32 v[214:215], v[222:223], v[62:63] op_sel_hi:[1,0]
v_pk_mul_f32 v[234:235], v[242:243], v[82:83] op_sel_hi:[1,0]
v_pk_fma_f32 v[208:209], v[216:217], v[62:63], v[208:209] op_sel:[1,1,0] op_sel_hi:[0,1,1] neg_lo:[1,0,0]
v_pk_fma_f32 v[228:229], v[236:237], v[82:83], v[228:229] op_sel:[1,1,0] op_sel_hi:[0,1,1] neg_lo:[1,0,0]
v_pk_fma_f32 v[210:211], v[218:219], v[62:63], v[210:211] op_sel:[1,1,0] op_sel_hi:[0,1,1] neg_lo:[1,0,0]
v_pk_fma_f32 v[230:231], v[238:239], v[82:83], v[230:231] op_sel:[1,1,0] op_sel_hi:[0,1,1] neg_lo:[1,0,0]
v_pk_fma_f32 v[212:213], v[220:221], v[62:63], v[212:213] op_sel:[1,1,0] op_sel_hi:[0,1,1] neg_lo:[1,0,0]
v_pk_fma_f32 v[232:233], v[240:241], v[82:83], v[232:233] op_sel:[1,1,0] op_sel_hi:[0,1,1] neg_lo:[1,0,0]
v_pk_fma_f32 v[214:215], v[222:223], v[62:63], v[214:215] op_sel:[1,1,0] op_sel_hi:[0,1,1] neg_lo:[1,0,0]
v_pk_fma_f32 v[234:235], v[242:243], v[82:83], v[234:235] op_sel:[1,1,0] op_sel_hi:[0,1,1] neg_lo:[1,0,0]
v_cvt_pk_bf16_f32 v92, v216, v217
v_cvt_pk_bf16_f32 v93, v236, v237
ds_write_b64 v88, v[92:93] offset:2176
v_cvt_pk_bf16_f32 v94, v218, v219
v_cvt_pk_bf16_f32 v95, v238, v239
ds_write_b64 v88, v[94:95] offset:2720
v_cvt_pk_bf16_f32 v90, v220, v221
v_cvt_pk_bf16_f32 v91, v240, v241
ds_write_b64 v88, v[90:91] offset:3264
v_cvt_pk_bf16_f32 v92, v222, v223
v_cvt_pk_bf16_f32 v93, v242, v243
ds_write_b64 v88, v[92:93] offset:3808
v_pk_mul_f32 v[216:217], v[208:209], v[62:63] op_sel_hi:[1,0]
v_pk_mul_f32 v[236:237], v[228:229], v[82:83] op_sel_hi:[1,0]
v_pk_mul_f32 v[218:219], v[210:211], v[62:63] op_sel_hi:[1,0]
v_pk_mul_f32 v[238:239], v[230:231], v[82:83] op_sel_hi:[1,0]
v_pk_mul_f32 v[220:221], v[212:213], v[62:63] op_sel_hi:[1,0]
v_pk_mul_f32 v[240:241], v[232:233], v[82:83] op_sel_hi:[1,0]
v_pk_mul_f32 v[222:223], v[214:215], v[62:63] op_sel_hi:[1,0]
v_pk_mul_f32 v[242:243], v[234:235], v[82:83] op_sel_hi:[1,0]
v_pk_fma_f32 v[216:217], v[208:209], v[62:63], v[216:217] op_sel:[1,1,0] op_sel_hi:[0,1,1] neg_lo:[1,0,0]
v_pk_fma_f32 v[236:237], v[228:229], v[82:83], v[236:237] op_sel:[1,1,0] op_sel_hi:[0,1,1] neg_lo:[1,0,0]
v_pk_fma_f32 v[218:219], v[210:211], v[62:63], v[218:219] op_sel:[1,1,0] op_sel_hi:[0,1,1] neg_lo:[1,0,0]
v_pk_fma_f32 v[238:239], v[230:231], v[82:83], v[238:239] op_sel:[1,1,0] op_sel_hi:[0,1,1] neg_lo:[1,0,0]
v_pk_fma_f32 v[220:221], v[212:213], v[62:63], v[220:221] op_sel:[1,1,0] op_sel_hi:[0,1,1] neg_lo:[1,0,0]
v_pk_fma_f32 v[240:241], v[232:233], v[82:83], v[240:241] op_sel:[1,1,0] op_sel_hi:[0,1,1] neg_lo:[1,0,0]
v_pk_fma_f32 v[222:223], v[214:215], v[62:63], v[222:223] op_sel:[1,1,0] op_sel_hi:[0,1,1] neg_lo:[1,0,0]
v_pk_fma_f32 v[242:243], v[234:235], v[82:83], v[242:243] op_sel:[1,1,0] op_sel_hi:[0,1,1] neg_lo:[1,0,0]
v_cvt_pk_bf16_f32 v94, v208, v209
v_cvt_pk_bf16_f32 v95, v228, v229
ds_write_b64 v88, v[94:95] offset:4352
v_cvt_pk_bf16_f32 v90, v210, v211
v_cvt_pk_bf16_f32 v91, v230, v231
ds_write_b64 v88, v[90:91] offset:4896
v_cvt_pk_bf16_f32 v92, v212, v213
v_cvt_pk_bf16_f32 v93, v232, v233
ds_write_b64 v88, v[92:93] offset:5440
v_cvt_pk_bf16_f32 v94, v214, v215
v_cvt_pk_bf16_f32 v95, v234, v235
ds_write_b64 v88, v[94:95] offset:5984
v_pk_mul_f32 v[208:209], v[216:217], v[62:63] op_sel_hi:[1,0]
v_pk_mul_f32 v[228:229], v[236:237], v[82:83] op_sel_hi:[1,0]
v_pk_mul_f32 v[210:211], v[218:219], v[62:63] op_sel_hi:[1,0]
v_pk_mul_f32 v[230:231], v[238:239], v[82:83] op_sel_hi:[1,0]
v_pk_mul_f32 v[212:213], v[220:221], v[62:63] op_sel_hi:[1,0]
v_pk_mul_f32 v[232:233], v[240:241], v[82:83] op_sel_hi:[1,0]
v_pk_mul_f32 v[214:215], v[222:223], v[62:63] op_sel_hi:[1,0]
v_pk_mul_f32 v[234:235], v[242:243], v[82:83] op_sel_hi:[1,0]
v_pk_fma_f32 v[208:209], v[216:217], v[62:63], v[208:209] op_sel:[1,1,0] op_sel_hi:[0,1,1] neg_lo:[1,0,0]
v_pk_fma_f32 v[228:229], v[236:237], v[82:83], v[228:229] op_sel:[1,1,0] op_sel_hi:[0,1,1] neg_lo:[1,0,0]
v_pk_fma_f32 v[210:211], v[218:219], v[62:63], v[210:211] op_sel:[1,1,0] op_sel_hi:[0,1,1] neg_lo:[1,0,0]
v_pk_fma_f32 v[230:231], v[238:239], v[82:83], v[230:231] op_sel:[1,1,0] op_sel_hi:[0,1,1] neg_lo:[1,0,0]
v_pk_fma_f32 v[212:213], v[220:221], v[62:63], v[212:213] op_sel:[1,1,0] op_sel_hi:[0,1,1] neg_lo:[1,0,0]
v_pk_fma_f32 v[232:233], v[240:241], v[82:83], v[232:233] op_sel:[1,1,0] op_sel_hi:[0,1,1] neg_lo:[1,0,0]
v_pk_fma_f32 v[214:215], v[222:223], v[62:63], v[214:215] op_sel:[1,1,0] op_sel_hi:[0,1,1] neg_lo:[1,0,0]
v_pk_fma_f32 v[234:235], v[242:243], v[82:83], v[234:235] op_sel:[1,1,0] op_sel_hi:[0,1,1] neg_lo:[1,0,0]
v_cvt_pk_bf16_f32 v90, v216, v217
v_cvt_pk_bf16_f32 v91, v236, v237
ds_write_b64 v88, v[90:91] offset:6528
v_cvt_pk_bf16_f32 v92, v218, v219
v_cvt_pk_bf16_f32 v93, v238, v239
ds_write_b64 v88, v[92:93] offset:7072
v_cvt_pk_bf16_f32 v94, v220, v221
v_cvt_pk_bf16_f32 v95, v240, v241
ds_write_b64 v88, v[94:95] offset:7616
v_cvt_pk_bf16_f32 v90, v222, v223
v_cvt_pk_bf16_f32 v91, v242, v243
ds_write_b64 v88, v[90:91] offset:8160
ds_read_b128 v[96:99], v89 offset:0
ds_read_b128 v[100:103], v89 offset:64
ds_read_b128 v[104:107], v89 offset:128
ds_read_b128 v[108:111], v89 offset:192
ds_read_b128 v[112:115], v89 offset:256
ds_read_b128 v[116:119], v89 offset:320
ds_read_b128 v[120:123], v89 offset:384
ds_read_b128 v[124:127], v89 offset:448
v_pk_mul_f32 v[216:217], v[208:209], v[62:63] op_sel_hi:[1,0]
v_pk_mul_f32 v[236:237], v[228:229], v[82:83] op_sel_hi:[1,0]
v_pk_mul_f32 v[218:219], v[210:211], v[62:63] op_sel_hi:[1,0]
v_pk_mul_f32 v[238:239], v[230:231], v[82:83] op_sel_hi:[1,0]
v_pk_mul_f32 v[220:221], v[212:213], v[62:63] op_sel_hi:[1,0]
v_pk_mul_f32 v[240:241], v[232:233], v[82:83] op_sel_hi:[1,0]
v_pk_mul_f32 v[222:223], v[214:215], v[62:63] op_sel_hi:[1,0]
v_pk_mul_f32 v[242:243], v[234:235], v[82:83] op_sel_hi:[1,0]
v_pk_fma_f32 v[216:217], v[208:209], v[62:63], v[216:217] op_sel:[1,1,0] op_sel_hi:[0,1,1] neg_lo:[1,0,0]
v_pk_fma_f32 v[236:237], v[228:229], v[82:83], v[236:237] op_sel:[1,1,0] op_sel_hi:[0,1,1] neg_lo:[1,0,0]
v_pk_fma_f32 v[218:219], v[210:211], v[62:63], v[218:219] op_sel:[1,1,0] op_sel_hi:[0,1,1] neg_lo:[1,0,0]
v_pk_fma_f32 v[238:239], v[230:231], v[82:83], v[238:239] op_sel:[1,1,0] op_sel_hi:[0,1,1] neg_lo:[1,0,0]
v_pk_fma_f32 v[220:221], v[212:213], v[62:63], v[220:221] op_sel:[1,1,0] op_sel_hi:[0,1,1] neg_lo:[1,0,0]
v_pk_fma_f32 v[240:241], v[232:233], v[82:83], v[240:241] op_sel:[1,1,0] op_sel_hi:[0,1,1] neg_lo:[1,0,0]
v_pk_fma_f32 v[222:223], v[214:215], v[62:63], v[222:223] op_sel:[1,1,0] op_sel_hi:[0,1,1] neg_lo:[1,0,0]
v_pk_fma_f32 v[242:243], v[234:235], v[82:83], v[242:243] op_sel:[1,1,0] op_sel_hi:[0,1,1] neg_lo:[1,0,0]
v_cvt_pk_bf16_f32 v92, v208, v209
v_cvt_pk_bf16_f32 v93, v228, v229
ds_write_b64 v88, v[92:93] offset:0
v_cvt_pk_bf16_f32 v94, v210, v211
v_cvt_pk_bf16_f32 v95, v230, v231
ds_write_b64 v88, v[94:95] offset:544
v_cvt_pk_bf16_f32 v90, v212, v213
v_cvt_pk_bf16_f32 v91, v232, v233
ds_write_b64 v88, v[90:91] offset:1088
v_cvt_pk_bf16_f32 v92, v214, v215
v_cvt_pk_bf16_f32 v93, v234, v235
ds_write_b64 v88, v[92:93] offset:1632
v_pk_mul_f32 v[208:209], v[216:217], v[62:63] op_sel_hi:[1,0]
v_pk_mul_f32 v[228:229], v[236:237], v[82:83] op_sel_hi:[1,0]
v_pk_mul_f32 v[210:211], v[218:219], v[62:63] op_sel_hi:[1,0]
v_pk_mul_f32 v[230:231], v[238:239], v[82:83] op_sel_hi:[1,0]
v_pk_mul_f32 v[212:213], v[220:221], v[62:63] op_sel_hi:[1,0]
v_pk_mul_f32 v[232:233], v[240:241], v[82:83] op_sel_hi:[1,0]
v_pk_mul_f32 v[214:215], v[222:223], v[62:63] op_sel_hi:[1,0]
v_pk_mul_f32 v[234:235], v[242:243], v[82:83] op_sel_hi:[1,0]
v_pk_fma_f32 v[208:209], v[216:217], v[62:63], v[208:209] op_sel:[1,1,0] op_sel_hi:[0,1,1] neg_lo:[1,0,0]
v_pk_fma_f32 v[228:229], v[236:237], v[82:83], v[228:229] op_sel:[1,1,0] op_sel_hi:[0,1,1] neg_lo:[1,0,0]
v_pk_fma_f32 v[210:211], v[218:219], v[62:63], v[210:211] op_sel:[1,1,0] op_sel_hi:[0,1,1] neg_lo:[1,0,0]
v_pk_fma_f32 v[230:231], v[238:239], v[82:83], v[230:231] op_sel:[1,1,0] op_sel_hi:[0,1,1] neg_lo:[1,0,0]
v_pk_fma_f32 v[212:213], v[220:221], v[62:63], v[212:213] op_sel:[1,1,0] op_sel_hi:[0,1,1] neg_lo:[1,0,0]
v_pk_fma_f32 v[232:233], v[240:241], v[82:83], v[232:233] op_sel:[1,1,0] op_sel_hi:[0,1,1] neg_lo:[1,0,0]
v_pk_fma_f32 v[214:215], v[222:223], v[62:63], v[214:215] op_sel:[1,1,0] op_sel_hi:[0,1,1] neg_lo:[1,0,0]
v_pk_fma_f32 v[234:235], v[242:243], v[82:83], v[234:235] op_sel:[1,1,0] op_sel_hi:[0,1,1] neg_lo:[1,0,0]
v_cvt_pk_bf16_f32 v94, v216, v217
v_cvt_pk_bf16_f32 v95, v236, v237
ds_write_b64 v88, v[94:95] offset:2176
v_cvt_pk_bf16_f32 v90, v218, v219
v_cvt_pk_bf16_f32 v91, v238, v239
ds_write_b64 v88, v[90:91] offset:2720
v_cvt_pk_bf16_f32 v92, v220, v221
v_cvt_pk_bf16_f32 v93, v240, v241
ds_write_b64 v88, v[92:93] offset:3264
v_cvt_pk_bf16_f32 v94, v222, v223
v_cvt_pk_bf16_f32 v95, v242, v243
ds_write_b64 v88, v[94:95] offset:3808
v_pk_mul_f32 v[216:217], v[208:209], v[62:63] op_sel_hi:[1,0]
v_pk_mul_f32 v[236:237], v[228:229], v[82:83] op_sel_hi:[1,0]
v_pk_mul_f32 v[218:219], v[210:211], v[62:63] op_sel_hi:[1,0]
v_pk_mul_f32 v[238:239], v[230:231], v[82:83] op_sel_hi:[1,0]
v_pk_mul_f32 v[220:221], v[212:213], v[62:63] op_sel_hi:[1,0]
v_pk_mul_f32 v[240:241], v[232:233], v[82:83] op_sel_hi:[1,0]
v_pk_mul_f32 v[222:223], v[214:215], v[62:63] op_sel_hi:[1,0]
v_pk_mul_f32 v[242:243], v[234:235], v[82:83] op_sel_hi:[1,0]
v_pk_fma_f32 v[216:217], v[208:209], v[62:63], v[216:217] op_sel:[1,1,0] op_sel_hi:[0,1,1] neg_lo:[1,0,0]
v_pk_fma_f32 v[236:237], v[228:229], v[82:83], v[236:237] op_sel:[1,1,0] op_sel_hi:[0,1,1] neg_lo:[1,0,0]
v_pk_fma_f32 v[218:219], v[210:211], v[62:63], v[218:219] op_sel:[1,1,0] op_sel_hi:[0,1,1] neg_lo:[1,0,0]
v_pk_fma_f32 v[238:239], v[230:231], v[82:83], v[238:239] op_sel:[1,1,0] op_sel_hi:[0,1,1] neg_lo:[1,0,0]
v_pk_fma_f32 v[220:221], v[212:213], v[62:63], v[220:221] op_sel:[1,1,0] op_sel_hi:[0,1,1] neg_lo:[1,0,0]
v_pk_fma_f32 v[240:241], v[232:233], v[82:83], v[240:241] op_sel:[1,1,0] op_sel_hi:[0,1,1] neg_lo:[1,0,0]
v_pk_fma_f32 v[222:223], v[214:215], v[62:63], v[222:223] op_sel:[1,1,0] op_sel_hi:[0,1,1] neg_lo:[1,0,0]
v_pk_fma_f32 v[242:243], v[234:235], v[82:83], v[242:243] op_sel:[1,1,0] op_sel_hi:[0,1,1] neg_lo:[1,0,0]
v_cvt_pk_bf16_f32 v90, v208, v209
v_cvt_pk_bf16_f32 v91, v228, v229
ds_write_b64 v88, v[90:91] offset:4352
v_cvt_pk_bf16_f32 v92, v210, v211
v_cvt_pk_bf16_f32 v93, v230, v231
ds_write_b64 v88, v[92:93] offset:4896
v_cvt_pk_bf16_f32 v94, v212, v213
v_cvt_pk_bf16_f32 v95, v232, v233
ds_write_b64 v88, v[94:95] offset:5440
v_cvt_pk_bf16_f32 v90, v214, v215
v_cvt_pk_bf16_f32 v91, v234, v235
ds_write_b64 v88, v[90:91] offset:5984
v_cvt_pk_bf16_f32 v92, v216, v217
v_cvt_pk_bf16_f32 v93, v236, v237
ds_write_b64 v88, v[92:93] offset:6528
v_cvt_pk_bf16_f32 v94, v218, v219
v_cvt_pk_bf16_f32 v95, v238, v239
ds_write_b64 v88, v[94:95] offset:7072
v_cvt_pk_bf16_f32 v90, v220, v221
v_cvt_pk_bf16_f32 v91, v240, v241
ds_write_b64 v88, v[90:91] offset:7616
v_cvt_pk_bf16_f32 v92, v222, v223
v_cvt_pk_bf16_f32 v93, v242, v243
ds_write_b64 v88, v[92:93] offset:8160
ds_read_b128 v[128:131], v89 offset:0
ds_read_b128 v[132:135], v89 offset:64
ds_read_b128 v[136:139], v89 offset:128
ds_read_b128 v[140:143], v89 offset:192
ds_read_b128 v[144:147], v89 offset:256
ds_read_b128 v[148:151], v89 offset:320
ds_read_b128 v[152:155], v89 offset:384
ds_read_b128 v[156:159], v89 offset:448
v_pk_mul_f32 v[210:211], v[50:51], v[52:53] op_sel_hi:[1,0]
v_pk_mul_f32 v[230:231], v[70:71], v[72:73] op_sel_hi:[1,0]
v_pk_mul_f32 v[212:213], v[50:51], v[58:59] op_sel_hi:[1,0]
v_pk_mul_f32 v[232:233], v[70:71], v[78:79] op_sel_hi:[1,0]
v_pk_mul_f32 v[216:217], v[50:51], v[60:61] op_sel_hi:[1,0]
v_pk_mul_f32 v[236:237], v[70:71], v[80:81] op_sel_hi:[1,0]
v_pk_mul_f32 v[224:225], v[50:51], v[56:57] op_sel_hi:[1,0]
v_pk_mul_f32 v[244:245], v[70:71], v[76:77] op_sel_hi:[1,0]
v_pk_fma_f32 v[210:211], v[50:51], v[52:53], v[210:211] op_sel:[1,1,0] op_sel_hi:[0,1,1] neg_lo:[1,0,0]
v_pk_fma_f32 v[230:231], v[70:71], v[72:73], v[230:231] op_sel:[1,1,0] op_sel_hi:[0,1,1] neg_lo:[1,0,0]
v_pk_fma_f32 v[212:213], v[50:51], v[58:59], v[212:213] op_sel:[1,1,0] op_sel_hi:[0,1,1] neg_lo:[1,0,0]
v_pk_fma_f32 v[232:233], v[70:71], v[78:79], v[232:233] op_sel:[1,1,0] op_sel_hi:[0,1,1] neg_lo:[1,0,0]
v_pk_fma_f32 v[216:217], v[50:51], v[60:61], v[216:217] op_sel:[1,1,0] op_sel_hi:[0,1,1] neg_lo:[1,0,0]
v_pk_fma_f32 v[236:237], v[70:71], v[80:81], v[236:237] op_sel:[1,1,0] op_sel_hi:[0,1,1] neg_lo:[1,0,0]
v_pk_fma_f32 v[224:225], v[50:51], v[56:57], v[224:225] op_sel:[1,1,0] op_sel_hi:[0,1,1] neg_lo:[1,0,0]
v_pk_fma_f32 v[244:245], v[70:71], v[76:77], v[244:245] op_sel:[1,1,0] op_sel_hi:[0,1,1] neg_lo:[1,0,0]
v_cvt_pk_bf16_f32 v94, v50, -v51
v_cvt_pk_bf16_f32 v95, v70, -v71
ds_write_b64 v88, v[94:95] offset:0
v_pk_mul_f32 v[214:215], v[210:211], v[58:59] op_sel_hi:[1,0]
v_pk_mul_f32 v[234:235], v[230:231], v[78:79] op_sel_hi:[1,0]
v_pk_mul_f32 v[218:219], v[210:211], v[60:61] op_sel_hi:[1,0]
v_pk_mul_f32 v[238:239], v[230:231], v[80:81] op_sel_hi:[1,0]
v_pk_mul_f32 v[220:221], v[212:213], v[60:61] op_sel_hi:[1,0]
v_pk_mul_f32 v[240:241], v[232:233], v[80:81] op_sel_hi:[1,0]
v_pk_mul_f32 v[226:227], v[224:225], v[56:57] op_sel_hi:[1,0]
v_pk_mul_f32 v[246:247], v[244:245], v[76:77] op_sel_hi:[1,0]
v_pk_fma_f32 v[214:215], v[210:211], v[58:59], v[214:215] op_sel:[1,1,0] op_sel_hi:[0,1,1] neg_lo:[1,0,0]
v_pk_fma_f32 v[234:235], v[230:231], v[78:79], v[234:235] op_sel:[1,1,0] op_sel_hi:[0,1,1] neg_lo:[1,0,0]
v_pk_fma_f32 v[218:219], v[210:211], v[60:61], v[218:219] op_sel:[1,1,0] op_sel_hi:[0,1,1] neg_lo:[1,0,0]
v_pk_fma_f32 v[238:239], v[230:231], v[80:81], v[238:239] op_sel:[1,1,0] op_sel_hi:[0,1,1] neg_lo:[1,0,0]
v_pk_fma_f32 v[220:221], v[212:213], v[60:61], v[220:221] op_sel:[1,1,0] op_sel_hi:[0,1,1] neg_lo:[1,0,0]
v_pk_fma_f32 v[240:241], v[232:233], v[80:81], v[240:241] op_sel:[1,1,0] op_sel_hi:[0,1,1] neg_lo:[1,0,0]
v_pk_fma_f32 v[226:227], v[224:225], v[56:57], v[226:227] op_sel:[1,1,0] op_sel_hi:[0,1,1] neg_lo:[1,0,0]
v_pk_fma_f32 v[246:247], v[244:245], v[76:77], v[246:247] op_sel:[1,1,0] op_sel_hi:[0,1,1] neg_lo:[1,0,0]
v_cvt_pk_bf16_f32 v90, v210, -v211
v_cvt_pk_bf16_f32 v91, v230, -v231
ds_write_b64 v88, v[90:91] offset:544
v_cvt_pk_bf16_f32 v92, v212, -v213
v_cvt_pk_bf16_f32 v93, v232, -v233
ds_write_b64 v88, v[92:93] offset:1088
v_cvt_pk_bf16_f32 v94, v216, -v217
v_cvt_pk_bf16_f32 v95, v236, -v237
ds_write_b64 v88, v[94:95] offset:2176
v_cvt_pk_bf16_f32 v90, v224, -v225
v_cvt_pk_bf16_f32 v91, v244, -v245
ds_write_b64 v88, v[90:91] offset:4352
v_pk_mul_f32 v[222:223], v[214:215], v[60:61] op_sel_hi:[1,0]
v_pk_mul_f32 v[242:243], v[234:235], v[80:81] op_sel_hi:[1,0]
v_pk_mul_f32 v[208:209], v[224:225], v[58:59] op_sel_hi:[1,0]
v_pk_mul_f32 v[228:229], v[244:245], v[78:79] op_sel_hi:[1,0]
v_pk_mul_f32 v[210:211], v[224:225], v[60:61] op_sel_hi:[1,0]
v_pk_mul_f32 v[230:231], v[244:245], v[80:81] op_sel_hi:[1,0]
v_pk_mul_f32 v[212:213], v[226:227], v[60:61] op_sel_hi:[1,0]
v_pk_mul_f32 v[232:233], v[246:247], v[80:81] op_sel_hi:[1,0]
v_pk_mul_f32 v[216:217], v[226:227], v[56:57] op_sel_hi:[1,0]
v_pk_mul_f32 v[236:237], v[246:247], v[76:77] op_sel_hi:[1,0]
v_pk_fma_f32 v[222:223], v[214:215], v[60:61], v[222:223] op_sel:[1,1,0] op_sel_hi:[0,1,1] neg_lo:[1,0,0]
v_pk_fma_f32 v[242:243], v[234:235], v[80:81], v[242:243] op_sel:[1,1,0] op_sel_hi:[0,1,1] neg_lo:[1,0,0]
v_pk_fma_f32 v[208:209], v[224:225], v[58:59], v[208:209] op_sel:[1,1,0] op_sel_hi:[0,1,1] neg_lo:[1,0,0]
v_pk_fma_f32 v[228:229], v[244:245], v[78:79], v[228:229] op_sel:[1,1,0] op_sel_hi:[0,1,1] neg_lo:[1,0,0]
v_pk_fma_f32 v[210:211], v[224:225], v[60:61], v[210:211] op_sel:[1,1,0] op_sel_hi:[0,1,1] neg_lo:[1,0,0]
v_pk_fma_f32 v[230:231], v[244:245], v[80:81], v[230:231] op_sel:[1,1,0] op_sel_hi:[0,1,1] neg_lo:[1,0,0]
v_pk_fma_f32 v[212:213], v[226:227], v[60:61], v[212:213] op_sel:[1,1,0] op_sel_hi:[0,1,1] neg_lo:[1,0,0]
v_pk_fma_f32 v[232:233], v[246:247], v[80:81], v[232:233] op_sel:[1,1,0] op_sel_hi:[0,1,1] neg_lo:[1,0,0]
v_pk_fma_f32 v[216:217], v[226:227], v[56:57], v[216:217] op_sel:[1,1,0] op_sel_hi:[0,1,1] neg_lo:[1,0,0]
v_pk_fma_f32 v[236:237], v[246:247], v[76:77], v[236:237] op_sel:[1,1,0] op_sel_hi:[0,1,1] neg_lo:[1,0,0]
v_cvt_pk_bf16_f32 v92, v214, -v215
v_cvt_pk_bf16_f32 v93, v234, -v235
ds_write_b64 v88, v[92:93] offset:1632
v_cvt_pk_bf16_f32 v94, v218, -v219
v_cvt_pk_bf16_f32 v95, v238, -v239
ds_write_b64 v88, v[94:95] offset:2720
v_cvt_pk_bf16_f32 v90, v220, -v221
v_cvt_pk_bf16_f32 v91, v240, -v241
ds_write_b64 v88, v[90:91] offset:3264
v_cvt_pk_bf16_f32 v92, v226, -v227
v_cvt_pk_bf16_f32 v93, v246, -v247
ds_write_b64 v88, v[92:93] offset:6528
v_pk_mul_f32 v[214:215], v[208:209], v[60:61] op_sel_hi:[1,0]
v_pk_mul_f32 v[234:235], v[228:229], v[80:81] op_sel_hi:[1,0]
v_pk_mul_f32 v[218:219], v[216:217], v[60:61] op_sel_hi:[1,0]
v_pk_mul_f32 v[238:239], v[236:237], v[80:81] op_sel_hi:[1,0]
v_pk_mul_f32 v[220:221], v[226:227], v[64:65] op_sel_hi:[1,0]
v_pk_mul_f32 v[240:241], v[246:247], v[84:85] op_sel_hi:[1,0]
v_pk_mul_f32 v[224:225], v[216:217], v[64:65] op_sel_hi:[1,0]
v_pk_mul_f32 v[244:245], v[236:237], v[84:85] op_sel_hi:[1,0]
v_pk_fma_f32 v[214:215], v[208:209], v[60:61], v[214:215] op_sel:[1,1,0] op_sel_hi:[0,1,1] neg_lo:[1,0,0]
v_pk_fma_f32 v[234:235], v[228:229], v[80:81], v[234:235] op_sel:[1,1,0] op_sel_hi:[0,1,1] neg_lo:[1,0,0]
v_pk_fma_f32 v[218:219], v[216:217], v[60:61], v[218:219] op_sel:[1,1,0] op_sel_hi:[0,1,1] neg_lo:[1,0,0]
v_pk_fma_f32 v[238:239], v[236:237], v[80:81], v[238:239] op_sel:[1,1,0] op_sel_hi:[0,1,1] neg_lo:[1,0,0]
v_pk_fma_f32 v[220:221], v[226:227], v[64:65], v[220:221] op_sel:[1,1,0] op_sel_hi:[0,1,1] neg_lo:[1,0,0]
v_pk_fma_f32 v[240:241], v[246:247], v[84:85], v[240:241] op_sel:[1,1,0] op_sel_hi:[0,1,1] neg_lo:[1,0,0]
v_pk_fma_f32 v[224:225], v[216:217], v[64:65], v[224:225] op_sel:[1,1,0] op_sel_hi:[0,1,1] neg_lo:[1,0,0]
v_pk_fma_f32 v[244:245], v[236:237], v[84:85], v[244:245] op_sel:[1,1,0] op_sel_hi:[0,1,1] neg_lo:[1,0,0]
v_cvt_pk_bf16_f32 v94, v222, -v223
v_cvt_pk_bf16_f32 v95, v242, -v243
ds_write_b64 v88, v[94:95] offset:3808
v_cvt_pk_bf16_f32 v90, v208, -v209
v_cvt_pk_bf16_f32 v91, v228, -v229
ds_write_b64 v88, v[90:91] offset:4896
v_cvt_pk_bf16_f32 v92, v210, -v211
v_cvt_pk_bf16_f32 v93, v230, -v231
ds_write_b64 v88, v[92:93] offset:5440
v_cvt_pk_bf16_f32 v94, v212, -v213
v_cvt_pk_bf16_f32 v95, v232, -v233
ds_write_b64 v88, v[94:95] offset:7072
v_cvt_pk_bf16_f32 v90, v216, -v217
v_cvt_pk_bf16_f32 v91, v236, -v237
ds_write_b64 v88, v[90:91] offset:7616
v_pk_mul_f32 v[222:223], v[220:221], v[64:65] op_sel_hi:[1,0]
v_pk_mul_f32 v[242:243], v[240:241], v[84:85] op_sel_hi:[1,0]
v_pk_mul_f32 v[208:209], v[224:225], v[64:65] op_sel_hi:[1,0]
v_pk_mul_f32 v[228:229], v[244:245], v[84:85] op_sel_hi:[1,0]
v_pk_fma_f32 v[222:223], v[220:221], v[64:65], v[222:223] op_sel:[1,1,0] op_sel_hi:[0,1,1] neg_lo:[1,0,0]
v_pk_fma_f32 v[242:243], v[240:241], v[84:85], v[242:243] op_sel:[1,1,0] op_sel_hi:[0,1,1] neg_lo:[1,0,0]
v_pk_fma_f32 v[208:209], v[224:225], v[64:65], v[208:209] op_sel:[1,1,0] op_sel_hi:[0,1,1] neg_lo:[1,0,0]
v_pk_fma_f32 v[228:229], v[244:245], v[84:85], v[228:229] op_sel:[1,1,0] op_sel_hi:[0,1,1] neg_lo:[1,0,0]
v_cvt_pk_bf16_f32 v92, v214, -v215
v_cvt_pk_bf16_f32 v93, v234, -v235
ds_write_b64 v88, v[92:93] offset:5984
v_cvt_pk_bf16_f32 v94, v218, -v219
v_cvt_pk_bf16_f32 v95, v238, -v239
ds_write_b64 v88, v[94:95] offset:8160
ds_read_b128 v[160:163], v89 offset:0
ds_read_b128 v[164:167], v89 offset:64
ds_read_b128 v[168:171], v89 offset:128
ds_read_b128 v[172:175], v89 offset:192
ds_read_b128 v[176:179], v89 offset:256
ds_read_b128 v[180:183], v89 offset:320
ds_read_b128 v[184:187], v89 offset:384
ds_read_b128 v[188:191], v89 offset:448
v_pk_mul_f32 v[210:211], v[222:223], v[64:65] op_sel_hi:[1,0]
v_pk_mul_f32 v[230:231], v[242:243], v[84:85] op_sel_hi:[1,0]
v_pk_fma_f32 v[210:211], v[222:223], v[64:65], v[210:211] op_sel:[1,1,0] op_sel_hi:[0,1,1] neg_lo:[1,0,0]
v_pk_fma_f32 v[230:231], v[242:243], v[84:85], v[230:231] op_sel:[1,1,0] op_sel_hi:[0,1,1] neg_lo:[1,0,0]
s_barrier
v_cvt_pk_bf16_f32 v90, v220, -v221
v_cvt_pk_bf16_f32 v91, v240, -v241
ds_write_b64 v88, v[90:91] offset:0
v_cvt_pk_bf16_f32 v92, v224, -v225
v_cvt_pk_bf16_f32 v93, v244, -v245
ds_write_b64 v88, v[92:93] offset:544
v_cvt_pk_bf16_f32 v94, v222, -v223
v_cvt_pk_bf16_f32 v95, v242, -v243
ds_write_b64 v88, v[94:95] offset:1088
v_cvt_pk_bf16_f32 v90, v208, -v209
v_cvt_pk_bf16_f32 v91, v228, -v229
ds_write_b64 v88, v[90:91] offset:1632
v_cvt_pk_bf16_f32 v92, v210, -v211
v_cvt_pk_bf16_f32 v93, v230, -v231
ds_write_b64 v88, v[92:93] offset:2176
ds_read_b128 v[48:51], v89 offset:0
ds_read_b128 v[52:55], v89 offset:64
ds_read_b128 v[56:59], v89 offset:128
ds_read_b128 v[60:63], v89 offset:192
ds_read_b128 v[64:67], v89 offset:256
ds_read_b128 v[68:71], v89 offset:320
ds_read_b128 v[72:75], v89 offset:384
ds_read_b128 v[76:79], v89 offset:448
s_waitcnt lgkmcnt(13)
v_mfma_f32_16x16x32_bf16 v[192:195], v[96:99], v[160:163], 0
v_mfma_f32_16x16x32_bf16 v[200:203], v[128:131], v[160:163], 0
v_mfma_f32_16x16x32_bf16 v[192:195], v[100:103], v[164:167], v[192:195]
v_mfma_f32_16x16x32_bf16 v[200:203], v[132:135], v[164:167], v[200:203]
v_mfma_f32_16x16x32_bf16 v[192:195], v[104:107], v[168:171], v[192:195]
v_mfma_f32_16x16x32_bf16 v[200:203], v[136:139], v[168:171], v[200:203]
v_mfma_f32_16x16x32_bf16 v[192:195], v[108:111], v[172:175], v[192:195]
v_mfma_f32_16x16x32_bf16 v[200:203], v[140:143], v[172:175], v[200:203]
v_mfma_f32_16x16x32_bf16 v[192:195], v[112:115], v[176:179], v[192:195]
v_mfma_f32_16x16x32_bf16 v[200:203], v[144:147], v[176:179], v[200:203]
v_mfma_f32_16x16x32_bf16 v[192:195], v[116:119], v[180:183], v[192:195]
v_mfma_f32_16x16x32_bf16 v[200:203], v[148:151], v[180:183], v[200:203]
v_mfma_f32_16x16x32_bf16 v[192:195], v[120:123], v[184:187], v[192:195]
v_mfma_f32_16x16x32_bf16 v[200:203], v[152:155], v[184:187], v[200:203]
v_mfma_f32_16x16x32_bf16 v[192:195], v[124:127], v[188:191], v[192:195]
v_mfma_f32_16x16x32_bf16 v[200:203], v[156:159], v[188:191], v[200:203]
s_waitcnt lgkmcnt(0)
v_mfma_f32_16x16x32_bf16 v[196:199], v[96:99], v[48:51], 0
v_mfma_f32_16x16x32_bf16 v[204:207], v[128:131], v[48:51], 0
v_mfma_f32_16x16x32_bf16 v[196:199], v[100:103], v[52:55], v[196:199]
v_mfma_f32_16x16x32_bf16 v[204:207], v[132:135], v[52:55], v[204:207]
v_mfma_f32_16x16x32_bf16 v[196:199], v[104:107], v[56:59], v[196:199]
v_mfma_f32_16x16x32_bf16 v[204:207], v[136:139], v[56:59], v[204:207]
v_mfma_f32_16x16x32_bf16 v[196:199], v[108:111], v[60:63], v[196:199]
v_mfma_f32_16x16x32_bf16 v[204:207], v[140:143], v[60:63], v[204:207]
v_mfma_f32_16x16x32_bf16 v[196:199], v[112:115], v[64:67], v[196:199]
v_mfma_f32_16x16x32_bf16 v[204:207], v[144:147], v[64:67], v[204:207]
v_mfma_f32_16x16x32_bf16 v[196:199], v[116:119], v[68:71], v[196:199]
v_mfma_f32_16x16x32_bf16 v[204:207], v[148:151], v[68:71], v[204:207]
v_mfma_f32_16x16x32_bf16 v[196:199], v[120:123], v[72:75], v[196:199]
v_mfma_f32_16x16x32_bf16 v[204:207], v[152:155], v[72:75], v[204:207]
v_mfma_f32_16x16x32_bf16 v[196:199], v[124:127], v[76:79], v[196:199]
v_mfma_f32_16x16x32_bf16 v[204:207], v[156:159], v[76:79], v[204:207]
v_cvt_pk_bf16_f32 v40, v192, v193
v_cvt_pk_bf16_f32 v41, v194, v195
s_lshl_b32 s33, s29, 11
s_add_u32 s33, s33, 152064
v_and_b32 v20, 15, v2
v_lshlrev_b32 v20, 6, v20
v_lshrrev_b32 v21, 4, v2
v_lshl_add_u32 v20, v21, 3, v20
v_add_u32 v20, s33, v20
ds_write_b64 v20, v[40:41] offset:0
v_cvt_pk_bf16_f32 v44, v200, v201
v_cvt_pk_bf16_f32 v45, v202, v203
ds_write_b64 v20, v[44:45] offset:32
v_cvt_pk_bf16_f32 v42, v196, v197
v_cvt_pk_bf16_f32 v43, v198, v199
v_and_b32 v90, 15, v2
v_cmp_gt_u32 vcc, 5, v90
s_nop 1
v_cndmask_b32 v42, 0, v42, vcc
v_cndmask_b32 v43, 0, v43, vcc
ds_write_b64 v20, v[42:43] offset:1024
v_cvt_pk_bf16_f32 v46, v204, v205
v_cvt_pk_bf16_f32 v47, v206, v207
v_cndmask_b32 v46, 0, v46, vcc
v_cndmask_b32 v47, 0, v47, vcc
ds_write_b64 v20, v[46:47] offset:1056
s_branch LBk_84
LBk_85:
s_barrier
LBk_84:
s_setprio 0
s_mov_b32 s39, 2064384
s_add_u32 m0, s37, 64512
s_nop 0
buffer_load_dwordx4 v11, s[8:11], s39 offen lds
s_add_u32 m0, s37, 68608
s_nop 0
buffer_load_dwordx4 v12, s[8:11], s39 offen lds
s_mov_b32 m0, 72704
s_cmp_lg_u32 s29, 3
s_cbranch_scc1 Ld_87
buffer_load_dwordx4 v13, s[8:11], s39 offen lds
Ld_87:
s_mov_b32 s39, 2359296
s_add_u32 m0, s37, 73728
s_nop 0
buffer_load_dwordx4 v11, s[8:11], s39 offen lds
s_add_u32 m0, s37, 77824
s_nop 0
buffer_load_dwordx4 v12, s[8:11], s39 offen lds
s_mov_b32 m0, 81920
s_cmp_lg_u32 s29, 0
s_cbranch_scc1 Ld_88
buffer_load_dwordx4 v13, s[8:11], s39 offen lds
Ld_88:
s_mov_b32 s39, 2654208
s_add_u32 m0, s37, 82944
s_nop 0
buffer_load_dwordx4 v11, s[8:11], s39 offen lds
s_add_u32 m0, s37, 87040
s_nop 0
buffer_load_dwordx4 v12, s[8:11], s39 offen lds
s_mov_b32 m0, 91136
s_cmp_lg_u32 s29, 1
s_cbranch_scc1 Ld_89
buffer_load_dwordx4 v13, s[8:11], s39 offen lds
Ld_89:
s_getpc_b64 s[60:61]
LLpc_90:
s_add_u32 s60, s60, idx_table-LLpc_90
s_addc_u32 s61, s61, 0
s_lshl_b32 s33, s29, 11
v_lshl_add_u32 v136, v2, 5, s33
global_load_dwordx4 v[140:143], v136, s[60:61]
global_load_dwordx2 v[144:145], v136, s[60:61] offset:16
v_mov_b32 v28, 163328
s_mov_b32 s58, 0x100000
LLg_91:
ds_read_b32 v29, v28
s_sub_u32 s58, s58, 1
s_waitcnt lgkmcnt(0)
v_readfirstlane_b32 s68, v29
s_nop 1
s_cmp_lg_u32 s68, 0
s_cbranch_scc1 LBg_92
s_sleep 2
s_cmp_gt_i32 s58, 0
s_cbranch_scc1 LLg_91
LBg_92:
s_lshl_b32 s39, s52, 1
s_and_b32 s33, s39, -4
s_min_u32 s33, s33, 1144
s_sub_u32 s39, s39, s33
s_add_u32 s60, s86, s33
s_addc_u32 s61, s87, 0
s_load_dwordx2 s[66:67], s[60:61], 0
s_lshl_b32 s65, s39, 3
s_lshl_b32 s39, s53, 1
s_and_b32 s33, s39, -4
s_min_u32 s33, s33, 1144
s_sub_u32 s39, s39, s33
s_add_u32 s60, s86, s33
s_addc_u32 s61, s87, 0
s_load_dwordx2 s[70:71], s[60:61], 0
s_lshl_b32 s99, s39, 3
s_lshl_b32 s33, s32, 7
s_lshl_b32 s38, s28, 4
s_add_u32 s33, s33, s38
s_add_u32 s33, s33, 12730368
v_add_lshl_u32 v24, s33, v2, 2
s_mov_b64 exec, 0xffff
buffer_load_dword v25, v24, s[16:19], 0 offen sc1
s_mov_b64 exec, -1
s_waitcnt vmcnt(3)
v_mov_b32 v31, 1
s_mov_b64 exec, s[100:101]
ds_write_b32 v0, v31 offset:16
s_mov_b64 exec, -1
s_mov_b32 s39, 2949120
s_add_u32 m0, s37, 92160
s_nop 0
buffer_load_dwordx4 v11, s[8:11], s39 offen lds
s_add_u32 m0, s37, 96256
s_nop 0
buffer_load_dwordx4 v12, s[8:11], s39 offen lds
s_mov_b32 m0, 100352
s_cmp_lg_u32 s29, 2
s_cbranch_scc1 Ld_93
buffer_load_dwordx4 v13, s[8:11], s39 offen lds
Ld_93:
s_mov_b32 s39, 3244032
s_add_u32 m0, s37, 101376
s_nop 0
buffer_load_dwordx4 v11, s[8:11], s39 offen lds
s_add_u32 m0, s37, 105472
s_nop 0
buffer_load_dwordx4 v12, s[8:11], s39 offen lds
s_mov_b32 m0, 109568
s_cmp_lg_u32 s29, 3
s_cbranch_scc1 Ld_94
buffer_load_dwordx4 v13, s[8:11], s39 offen lds
Ld_94:
s_waitcnt vmcnt(5)
v_and_b32 v240, 0xffff, v140
v_lshrrev_b32 v241, 16, v140
v_and_b32 v242, 0xffff, v141
v_lshrrev_b32 v243, 16, v141
v_and_b32 v244, 0xffff, v142
v_lshrrev_b32 v245, 16, v142
v_and_b32 v246, 0xffff, v143
v_lshrrev_b32 v247, 16, v143
v_and_b32 v248, 0xffff, v144
v_lshrrev_b32 v249, 16, v144
v_and_b32 v250, 0xffff, v145
v_add_u32 v240, 152064, v240
v_add_u32 v241, 152064, v241
v_add_u32 v242, 152064, v242
v_add_u32 v243, 152064, v243
v_add_u32 v244, 152064, v244
v_add_u32 v245, 152064, v245
v_add_u32 v246, 152064, v246
v_add_u32 v247, 152064, v247
v_add_u32 v248, 152064, v248
v_add_u32 v249, 152064, v249
v_add_u32 v250, 152064, v250
s_add_u32 s33, s37, 82944
v_add_u32 v251, s33, v3
v_and_b32 v136, 15, v2
v_lshrrev_b32 v138, 4, v2
s_lshl_b32 s33, s29, 13
v_add_u32 v252, s33, v3
v_lshrrev_b32 v137, 1, v138
v_lshl_add_u32 v139, v136, 1, v137
v_mul_u32_u24 v139, 48, v139
v_and_b32 v137, 1, v138
v_lshl_add_u32 v139, v137, 3, v139
s_mul_i32 s33, s29, 3072
s_add_u32 s33, s33, 139680
v_add_u32 v253, s33, v139
v_and_b32 v139, 1, v138
v_lshl_add_u32 v139, v139, 4, v136
s_lshl_b32 s33, s29, 5
v_add_u32 v139, s33, v139
v_and_b32 v137, 1, v139
v_lshrrev_b32 v139, 1, v139
v_mul_u32_u24 v139, 36864, v139
v_lshl_add_u32 v139, v137, 5, v139
v_lshrrev_b32 v138, 1, v138
v_lshl_add_u32 v254, v138, 4, v139
s_sub_u32 s33, s49, 18432
v_mov_b32 v20, s48
v_mov_b32 v21, s33
v_cmp_gt_u32 vcc, 18432, v14
s_nop 1
v_cndmask_b32 v20, v21, v20, vcc
v_add_u32 v17, v20, v14
v_mov_b32 v20, s48
v_mov_b32 v21, s33
v_cmp_gt_u32 vcc, 18432, v15
s_nop 1
v_cndmask_b32 v20, v21, v20, vcc
v_add_u32 v18, v20, v15
v_mov_b32 v20, s48
v_mov_b32 v21, s33
v_cmp_gt_u32 vcc, 18432, v16
s_nop 1
v_cndmask_b32 v20, v21, v20, vcc
v_add_u32 v19, v20, v16
s_waitcnt lgkmcnt(0)
s_lshr_b64 s[66:67], s[66:67], s65
s_lshl_b32 s62, s66, 16
s_and_b32 s63, s66, 0xffff0000
s_lshr_b64 s[70:71], s[70:71], s99
s_lshl_b32 s64, s70, 16
v_mov_b32 v28, 0
v_mov_b32 v29, 0
v_mov_b32 v30, 0
v_mov_b32 v31, 0
s_mul_i32 s33, s29, 480
s_add_u32 s33, s33, 138240
v_add_u32 v27, s33, v3
s_cmp_eq_u32 s29, 3
s_cselect_b32 exec_lo, 0, 0x3fffffff
s_mov_b32 exec_hi, 0
ds_write_b128 v27, v[28:31]
s_mov_b64 exec, -1
s_waitcnt lgkmcnt(0)
s_waitcnt vmcnt(4)
s_mov_b64 exec, 0xffff
s_mov_b32 s58, 0x8000
LLp_95:
v_cmp_ne_u32 vcc, s68, v25
s_nop 4
s_cbranch_vccz LBq_96
buffer_load_dword v25, v24, s[16:19], 0 offen sc1
s_sub_u32 s58, s58, 1
s_waitcnt vmcnt(0)
s_cmp_gt_i32 s58, 0
s_cbranch_scc1 LLp_95
LBq_96:
s_mov_b64 exec, -1
s_waitcnt vmcnt(0)
v_mov_b32 v31, 2
s_mov_b64 exec, s[100:101]
ds_write_b32 v0, v31 offset:16
s_mov_b64 exec, -1
s_mov_b32 s58, 0x100000
LLs_97:
ds_read_b32 v31, v0 offset:16
s_sub_u32 s58, s58, 1
s_waitcnt lgkmcnt(0)
v_cmp_gt_u32 vcc, 1, v31
s_nop 1
s_and_b32 s33, vcc_lo, 15
s_cbranch_scc0 LBs_98
s_sleep 2
s_cmp_gt_i32 s58, 0
s_cbranch_scc1 LLs_97
LBs_98:
s_mov_b32 s39, 3538944
s_add_u32 m0, s37, 110592
s_nop 0
buffer_load_dwordx4 v11, s[8:11], s39 offen lds
s_add_u32 m0, s37, 114688
s_nop 0
buffer_load_dwordx4 v12, s[8:11], s39 offen lds
s_mov_b32 m0, 118784
s_cmp_lg_u32 s29, 0
s_cbranch_scc1 Ld_99
buffer_load_dwordx4 v13, s[8:11], s39 offen lds
Ld_99:
s_mov_b32 s39, 3833856
s_add_u32 m0, s37, 119808
s_nop 0
buffer_load_dwordx4 v11, s[8:11], s39 offen lds
s_add_u32 m0, s37, 123904
s_nop 0
buffer_load_dwordx4 v12, s[8:11], s39 offen lds
s_mov_b32 m0, 128000
s_cmp_lg_u32 s29, 1
s_cbranch_scc1 Ld_100
buffer_load_dwordx4 v13, s[8:11], s39 offen lds
Ld_100:
buffer_load_dwordx4 v[136:139], v3, s[16:19], s34 offen offset:0 sc1
buffer_load_dwordx4 v[140:143], v3, s[16:19], s35 offen offset:0 sc1
buffer_load_dwordx4 v[144:147], v3, s[16:19], s34 offen offset:1024 sc1
buffer_load_dwordx4 v[148:151], v3, s[16:19], s35 offen offset:1024 sc1
buffer_load_dwordx4 v[152:155], v3, s[16:19], s34 offen offset:2048 sc1
buffer_load_dwordx4 v[156:159], v3, s[16:19], s35 offen offset:2048 sc1
s_mov_b32 s39, 4128768
s_add_u32 m0, s37, 129024
s_nop 0
buffer_load_dwordx4 v11, s[8:11], s39 offen lds
s_add_u32 m0, s37, 133120
s_nop 0
buffer_load_dwordx4 v12, s[8:11], s39 offen lds
s_mov_b32 m0, 137216
s_cmp_lg_u32 s29, 2
s_cbranch_scc1 Ld_101
buffer_load_dwordx4 v13, s[8:11], s39 offen lds
Ld_101:
ds_read_b64_tr_b16 v[104:105], v8 offset:0
ds_read_b64_tr_b16 v[106:107], v8 offset:4608
ds_read_b64_tr_b16 v[108:109], v8 offset:32
ds_read_b64_tr_b16 v[110:111], v8 offset:4640
ds_read_b64_tr_b16 v[112:113], v8 offset:64
ds_read_b64_tr_b16 v[114:115], v8 offset:4672
ds_read_b64_tr_b16 v[116:117], v8 offset:96
ds_read_b64_tr_b16 v[118:119], v8 offset:4704
s_waitcnt vmcnt(8)
s_barrier
s_waitcnt vmcnt(6)
s_waitcnt lgkmcnt(4)
v_mfma_f32_16x16x32_bf16 v[32:35], v[104:107], v[136:139], 0
ds_read_b64_tr_b16 v[120:121], v8 offset:128
buffer_load_dwordx4 v[160:163], v3, s[16:19], s34 offen offset:3072 sc1
v_mfma_f32_16x16x32_bf16 v[36:39], v[104:107], v[140:143], 0
ds_read_b64_tr_b16 v[122:123], v8 offset:4736
buffer_load_dwordx4 v[164:167], v3, s[16:19], s35 offen offset:3072 sc1
v_mfma_f32_16x16x32_bf16 v[44:47], v[108:111], v[140:143], 0
ds_read_b64_tr_b16 v[124:125], v8 offset:160
buffer_load_dwordx4 v[168:171], v4, s[16:19], s34 offen offset:0 sc1
v_mfma_f32_16x16x32_bf16 v[40:43], v[108:111], v[136:139], 0
ds_read_b64_tr_b16 v[126:127], v8 offset:4768
s_waitcnt lgkmcnt(4)
v_mfma_f32_16x16x32_bf16 v[48:51], v[112:115], v[136:139], 0
ds_read_b64_tr_b16 v[128:129], v8 offset:192
buffer_load_dwordx4 v[172:175], v4, s[16:19], s35 offen offset:0 sc1
v_mfma_f32_16x16x32_bf16 v[52:55], v[112:115], v[140:143], 0
ds_read_b64_tr_b16 v[130:131], v8 offset:4800
v_mfma_f32_16x16x32_bf16 v[60:63], v[116:119], v[140:143], 0
ds_read_b64_tr_b16 v[132:133], v8 offset:224
v_mfma_f32_16x16x32_bf16 v[56:59], v[116:119], v[136:139], 0
ds_read_b64_tr_b16 v[134:135], v8 offset:4832
s_waitcnt lgkmcnt(4)
v_mfma_f32_16x16x32_bf16 v[64:67], v[120:123], v[136:139], 0
ds_read_b64_tr_b16 v[104:105], v8 offset:256
v_mfma_f32_16x16x32_bf16 v[68:71], v[120:123], v[140:143], 0
ds_read_b64_tr_b16 v[106:107], v8 offset:4864
v_mfma_f32_16x16x32_bf16 v[76:79], v[124:127], v[140:143], 0
ds_read_b64_tr_b16 v[108:109], v8 offset:9216
v_mfma_f32_16x16x32_bf16 v[72:75], v[124:127], v[136:139], 0
ds_read_b64_tr_b16 v[110:111], v8 offset:13824
s_waitcnt lgkmcnt(4)
v_mfma_f32_16x16x32_bf16 v[80:83], v[128:131], v[136:139], 0
ds_read_b64_tr_b16 v[112:113], v8 offset:9248
v_mfma_f32_16x16x32_bf16 v[84:87], v[128:131], v[140:143], 0
ds_read_b64_tr_b16 v[114:115], v8 offset:13856
v_mfma_f32_16x16x32_bf16 v[92:95], v[132:135], v[140:143], 0
ds_read_b64_tr_b16 v[116:117], v8 offset:9280
v_mfma_f32_16x16x32_bf16 v[88:91], v[132:135], v[136:139], 0
ds_read_b64_tr_b16 v[118:119], v8 offset:13888
s_waitcnt lgkmcnt(4)
v_mfma_f32_16x16x32_bf16 v[96:99], v[104:107], v[136:139], 0
ds_read_b64_tr_b16 v[120:121], v8 offset:9312
v_mfma_f32_16x16x32_bf16 v[100:103], v[104:107], v[140:143], 0
ds_read_b64_tr_b16 v[122:123], v8 offset:13920
s_waitcnt vmcnt(4)
s_barrier
v_mfma_f32_16x16x32_bf16 v[36:39], v[108:111], v[148:151], v[36:39]
ds_read_b64_tr_b16 v[124:125], v8 offset:9344
buffer_load_dwordx4 v[176:179], v4, s[16:19], s34 offen offset:1024 sc1
v_mfma_f32_16x16x32_bf16 v[32:35], v[108:111], v[144:147], v[32:35]
ds_read_b64_tr_b16 v[126:127], v8 offset:13952
s_waitcnt lgkmcnt(4)
v_mfma_f32_16x16x32_bf16 v[40:43], v[112:115], v[144:147], v[40:43]
ds_read_b64_tr_b16 v[128:129], v8 offset:9376
buffer_load_dwordx4 v[180:183], v4, s[16:19], s35 offen offset:1024 sc1
v_mfma_f32_16x16x32_bf16 v[44:47], v[112:115], v[148:151], v[44:47]
ds_read_b64_tr_b16 v[130:131], v8 offset:13984
buffer_load_dwordx4 v[184:187], v4, s[16:19], s34 offen offset:2048 sc1
v_mfma_f32_16x16x32_bf16 v[52:55], v[116:119], v[148:151], v[52:55]
ds_read_b64_tr_b16 v[132:133], v8 offset:9408
buffer_load_dwordx4 v[188:191], v4, s[16:19], s35 offen offset:2048 sc1
v_mfma_f32_16x16x32_bf16 v[48:51], v[116:119], v[144:147], v[48:51]
ds_read_b64_tr_b16 v[134:135], v8 offset:14016
s_waitcnt lgkmcnt(4)
v_mfma_f32_16x16x32_bf16 v[56:59], v[120:123], v[144:147], v[56:59]
ds_read_b64_tr_b16 v[104:105], v8 offset:9440
v_mfma_f32_16x16x32_bf16 v[60:63], v[120:123], v[148:151], v[60:63]
ds_read_b64_tr_b16 v[106:107], v8 offset:14048
v_mfma_f32_16x16x32_bf16 v[68:71], v[124:127], v[148:151], v[68:71]
ds_read_b64_tr_b16 v[108:109], v8 offset:9472
v_mfma_f32_16x16x32_bf16 v[64:67], v[124:127], v[144:147], v[64:67]
ds_read_b64_tr_b16 v[110:111], v8 offset:14080
s_waitcnt lgkmcnt(4)
v_mfma_f32_16x16x32_bf16 v[72:75], v[128:131], v[144:147], v[72:75]
ds_read_b64_tr_b16 v[112:113], v8 offset:18432
v_mfma_f32_16x16x32_bf16 v[76:79], v[128:131], v[148:151], v[76:79]
ds_read_b64_tr_b16 v[114:115], v8 offset:23040
v_mfma_f32_16x16x32_bf16 v[84:87], v[132:135], v[148:151], v[84:87]
ds_read_b64_tr_b16 v[116:117], v8 offset:18464
v_mfma_f32_16x16x32_bf16 v[80:83], v[132:135], v[144:147], v[80:83]
ds_read_b64_tr_b16 v[118:119], v8 offset:23072
s_waitcnt lgkmcnt(4)
v_mfma_f32_16x16x32_bf16 v[88:91], v[104:107], v[144:147], v[88:91]
ds_read_b64_tr_b16 v[120:121], v8 offset:18496
v_mfma_f32_16x16x32_bf16 v[92:95], v[104:107], v[148:151], v[92:95]
ds_read_b64_tr_b16 v[122:123], v8 offset:23104
v_mfma_f32_16x16x32_bf16 v[100:103], v[108:111], v[148:151], v[100:103]
ds_read_b64_tr_b16 v[124:125], v8 offset:18528
v_mfma_f32_16x16x32_bf16 v[96:99], v[108:111], v[144:147], v[96:99]
ds_read_b64_tr_b16 v[126:127], v8 offset:23136
s_barrier
s_waitcnt lgkmcnt(4)
v_mfma_f32_16x16x32_bf16 v[32:35], v[112:115], v[152:155], v[32:35]
ds_read_b64_tr_b16 v[128:129], v8 offset:18560
buffer_load_dwordx4 v[192:195], v4, s[16:19], s34 offen offset:3072 sc1
v_mfma_f32_16x16x32_bf16 v[36:39], v[112:115], v[156:159], v[36:39]
ds_read_b64_tr_b16 v[130:131], v8 offset:23168
buffer_load_dwordx4 v[196:199], v4, s[16:19], s35 offen offset:3072 sc1
v_mfma_f32_16x16x32_bf16 v[44:47], v[116:119], v[156:159], v[44:47]
ds_read_b64_tr_b16 v[132:133], v8 offset:18592
buffer_load_dwordx4 v[200:203], v5, s[16:19], s34 offen offset:0 sc1
v_mfma_f32_16x16x32_bf16 v[40:43], v[116:119], v[152:155], v[40:43]
ds_read_b64_tr_b16 v[134:135], v8 offset:23200
s_waitcnt lgkmcnt(4)
v_mfma_f32_16x16x32_bf16 v[48:51], v[120:123], v[152:155], v[48:51]
ds_read_b64_tr_b16 v[104:105], v8 offset:18624
buffer_load_dwordx4 v[204:207], v5, s[16:19], s35 offen offset:0 sc1
v_mfma_f32_16x16x32_bf16 v[52:55], v[120:123], v[156:159], v[52:55]
ds_read_b64_tr_b16 v[106:107], v8 offset:23232
v_mfma_f32_16x16x32_bf16 v[60:63], v[124:127], v[156:159], v[60:63]
ds_read_b64_tr_b16 v[108:109], v8 offset:18656
v_mfma_f32_16x16x32_bf16 v[56:59], v[124:127], v[152:155], v[56:59]
ds_read_b64_tr_b16 v[110:111], v8 offset:23264
s_waitcnt lgkmcnt(4)
v_mfma_f32_16x16x32_bf16 v[64:67], v[128:131], v[152:155], v[64:67]
ds_read_b64_tr_b16 v[112:113], v8 offset:18688
v_mfma_f32_16x16x32_bf16 v[68:71], v[128:131], v[156:159], v[68:71]
ds_read_b64_tr_b16 v[114:115], v8 offset:23296
v_mfma_f32_16x16x32_bf16 v[76:79], v[132:135], v[156:159], v[76:79]
ds_read_b64_tr_b16 v[116:117], v8 offset:27648
v_mfma_f32_16x16x32_bf16 v[72:75], v[132:135], v[152:155], v[72:75]
ds_read_b64_tr_b16 v[118:119], v8 offset:32256
s_waitcnt lgkmcnt(4)
v_mfma_f32_16x16x32_bf16 v[80:83], v[104:107], v[152:155], v[80:83]
ds_read_b64_tr_b16 v[120:121], v8 offset:27680
v_mfma_f32_16x16x32_bf16 v[84:87], v[104:107], v[156:159], v[84:87]
ds_read_b64_tr_b16 v[122:123], v8 offset:32288
v_mfma_f32_16x16x32_bf16 v[92:95], v[108:111], v[156:159], v[92:95]
ds_read_b64_tr_b16 v[124:125], v8 offset:27712
v_mfma_f32_16x16x32_bf16 v[88:91], v[108:111], v[152:155], v[88:91]
ds_read_b64_tr_b16 v[126:127], v8 offset:32320
s_waitcnt lgkmcnt(4)
v_mfma_f32_16x16x32_bf16 v[96:99], v[112:115], v[152:155], v[96:99]
ds_read_b64_tr_b16 v[128:129], v8 offset:27744
v_mfma_f32_16x16x32_bf16 v[100:103], v[112:115], v[156:159], v[100:103]
ds_read_b64_tr_b16 v[130:131], v8 offset:32352
s_barrier
s_waitcnt vmcnt(10)
v_mfma_f32_16x16x32_bf16 v[36:39], v[116:119], v[164:167], v[36:39]
ds_read_b64_tr_b16 v[132:133], v8 offset:27776
buffer_load_dwordx4 v[208:211], v5, s[16:19], s34 offen offset:1024 sc1
v_mfma_f32_16x16x32_bf16 v[32:35], v[116:119], v[160:163], v[32:35]
ds_read_b64_tr_b16 v[134:135], v8 offset:32384
s_waitcnt lgkmcnt(4)
v_mfma_f32_16x16x32_bf16 v[40:43], v[120:123], v[160:163], v[40:43]
ds_read_b64_tr_b16 v[104:105], v8 offset:27808
buffer_load_dwordx4 v[212:215], v5, s[16:19], s35 offen offset:1024 sc1
v_mfma_f32_16x16x32_bf16 v[44:47], v[120:123], v[164:167], v[44:47]
ds_read_b64_tr_b16 v[106:107], v8 offset:32416
buffer_load_dwordx4 v[216:219], v5, s[16:19], s34 offen offset:2048 sc1
v_mfma_f32_16x16x32_bf16 v[52:55], v[124:127], v[164:167], v[52:55]
ds_read_b64_tr_b16 v[108:109], v8 offset:27840
buffer_load_dwordx4 v[220:223], v5, s[16:19], s35 offen offset:2048 sc1
v_mfma_f32_16x16x32_bf16 v[48:51], v[124:127], v[160:163], v[48:51]
ds_read_b64_tr_b16 v[110:111], v8 offset:32448
s_waitcnt lgkmcnt(4)
v_mfma_f32_16x16x32_bf16 v[56:59], v[128:131], v[160:163], v[56:59]
ds_read_b64_tr_b16 v[112:113], v8 offset:27872
v_mfma_f32_16x16x32_bf16 v[60:63], v[128:131], v[164:167], v[60:63]
ds_read_b64_tr_b16 v[114:115], v8 offset:32480
v_mfma_f32_16x16x32_bf16 v[68:71], v[132:135], v[164:167], v[68:71]
ds_read_b64_tr_b16 v[116:117], v8 offset:27904
v_mfma_f32_16x16x32_bf16 v[64:67], v[132:135], v[160:163], v[64:67]
ds_read_b64_tr_b16 v[118:119], v8 offset:32512
s_waitcnt lgkmcnt(4)
v_mfma_f32_16x16x32_bf16 v[72:75], v[104:107], v[160:163], v[72:75]
ds_read_b64_tr_b16 v[120:121], v8 offset:36864
v_mfma_f32_16x16x32_bf16 v[76:79], v[104:107], v[164:167], v[76:79]
ds_read_b64_tr_b16 v[122:123], v8 offset:41472
v_mfma_f32_16x16x32_bf16 v[84:87], v[108:111], v[164:167], v[84:87]
ds_read_b64_tr_b16 v[124:125], v8 offset:36896
v_mfma_f32_16x16x32_bf16 v[80:83], v[108:111], v[160:163], v[80:83]
ds_read_b64_tr_b16 v[126:127], v8 offset:41504
s_waitcnt lgkmcnt(4)
v_mfma_f32_16x16x32_bf16 v[88:91], v[112:115], v[160:163], v[88:91]
ds_read_b64_tr_b16 v[128:129], v8 offset:36928
v_mfma_f32_16x16x32_bf16 v[92:95], v[112:115], v[164:167], v[92:95]
ds_read_b64_tr_b16 v[130:131], v8 offset:41536
v_mfma_f32_16x16x32_bf16 v[100:103], v[116:119], v[164:167], v[100:103]
ds_read_b64_tr_b16 v[132:133], v8 offset:36960
v_mfma_f32_16x16x32_bf16 v[96:99], v[116:119], v[160:163], v[96:99]
ds_read_b64_tr_b16 v[134:135], v8 offset:41568
s_barrier
s_mov_b32 s33, 0x55555556
v_mul_hi_u32 v21, v2, s33
v_mul_u32_u24 v20, 3, v21
v_sub_u32 v20, v2, v20
v_mul_u32_u24 v21, 1152, v21
v_lshl_add_u32 v20, v20, 7, v21
s_lshl_b32 s33, s32, 2
s_add_u32 s33, s33, s29
s_mul_i32 s39, s33, 20736
s_add_u32 s39, s39, 0
s_bfm_b64 exec, 54, 0
buffer_load_dword v21, v20, s[12:15], s39 offen
s_mov_b64 exec, -1
s_waitcnt vmcnt(13)
s_waitcnt lgkmcnt(4)
v_mfma_f32_16x16x32_bf16 v[32:35], v[120:123], v[168:171], v[32:35]
ds_read_b64_tr_b16 v[104:105], v8 offset:36992
buffer_load_dwordx4 v[224:227], v5, s[16:19], s34 offen offset:3072 sc1
v_mfma_f32_16x16x32_bf16 v[36:39], v[120:123], v[172:175], v[36:39]
ds_read_b64_tr_b16 v[106:107], v8 offset:41600
buffer_load_dwordx4 v[228:231], v5, s[16:19], s35 offen offset:3072 sc1
v_mfma_f32_16x16x32_bf16 v[44:47], v[124:127], v[172:175], v[44:47]
ds_read_b64_tr_b16 v[108:109], v8 offset:37024
buffer_load_dwordx4 v[136:139], v6, s[16:19], s34 offen offset:0 sc1
v_mfma_f32_16x16x32_bf16 v[40:43], v[124:127], v[168:171], v[40:43]
ds_read_b64_tr_b16 v[110:111], v8 offset:41632
s_waitcnt lgkmcnt(4)
v_mfma_f32_16x16x32_bf16 v[48:51], v[128:131], v[168:171], v[48:51]
ds_read_b64_tr_b16 v[112:113], v8 offset:37056
buffer_load_dwordx4 v[140:143], v6, s[16:19], s35 offen offset:0 sc1
v_mfma_f32_16x16x32_bf16 v[52:55], v[128:131], v[172:175], v[52:55]
ds_read_b64_tr_b16 v[114:115], v8 offset:41664
v_mfma_f32_16x16x32_bf16 v[60:63], v[132:135], v[172:175], v[60:63]
ds_read_b64_tr_b16 v[116:117], v8 offset:37088
v_mfma_f32_16x16x32_bf16 v[56:59], v[132:135], v[168:171], v[56:59]
ds_read_b64_tr_b16 v[118:119], v8 offset:41696
s_waitcnt lgkmcnt(4)
v_mfma_f32_16x16x32_bf16 v[64:67], v[104:107], v[168:171], v[64:67]
ds_read_b64_tr_b16 v[120:121], v8 offset:37120
v_mfma_f32_16x16x32_bf16 v[68:71], v[104:107], v[172:175], v[68:71]
ds_read_b64_tr_b16 v[122:123], v8 offset:41728
v_mfma_f32_16x16x32_bf16 v[76:79], v[108:111], v[172:175], v[76:79]
ds_read_b64_tr_b16 v[124:125], v8 offset:46080
v_mfma_f32_16x16x32_bf16 v[72:75], v[108:111], v[168:171], v[72:75]
ds_read_b64_tr_b16 v[126:127], v8 offset:50688
s_waitcnt lgkmcnt(4)
v_mfma_f32_16x16x32_bf16 v[80:83], v[112:115], v[168:171], v[80:83]
ds_read_b64_tr_b16 v[128:129], v8 offset:46112
v_mfma_f32_16x16x32_bf16 v[84:87], v[112:115], v[172:175], v[84:87]
ds_read_b64_tr_b16 v[130:131], v8 offset:50720
v_mfma_f32_16x16x32_bf16 v[92:95], v[116:119], v[172:175], v[92:95]
ds_read_b64_tr_b16 v[132:133], v8 offset:46144
v_mfma_f32_16x16x32_bf16 v[88:91], v[116:119], v[168:171], v[88:91]
ds_read_b64_tr_b16 v[134:135], v8 offset:50752
s_waitcnt lgkmcnt(4)
v_mfma_f32_16x16x32_bf16 v[96:99], v[120:123], v[168:171], v[96:99]
ds_read_b64_tr_b16 v[104:105], v8 offset:46176
v_mfma_f32_16x16x32_bf16 v[100:103], v[120:123], v[172:175], v[100:103]
ds_read_b64_tr_b16 v[106:107], v8 offset:50784
s_barrier
s_waitcnt vmcnt(15)
v_mfma_f32_16x16x32_bf16 v[36:39], v[124:127], v[180:183], v[36:39]
ds_read_b64_tr_b16 v[108:109], v8 offset:46208
buffer_load_dwordx4 v[144:147], v6, s[16:19], s34 offen offset:1024 sc1
v_mfma_f32_16x16x32_bf16 v[32:35], v[124:127], v[176:179], v[32:35]
ds_read_b64_tr_b16 v[110:111], v8 offset:50816
s_waitcnt lgkmcnt(4)
v_mfma_f32_16x16x32_bf16 v[40:43], v[128:131], v[176:179], v[40:43]
ds_read_b64_tr_b16 v[112:113], v8 offset:46240
buffer_load_dwordx4 v[148:151], v6, s[16:19], s35 offen offset:1024 sc1
v_mfma_f32_16x16x32_bf16 v[44:47], v[128:131], v[180:183], v[44:47]
ds_read_b64_tr_b16 v[114:115], v8 offset:50848
buffer_load_dwordx4 v[152:155], v6, s[16:19], s34 offen offset:2048 sc1
v_mfma_f32_16x16x32_bf16 v[52:55], v[132:135], v[180:183], v[52:55]
ds_read_b64_tr_b16 v[116:117], v8 offset:46272
buffer_load_dwordx4 v[156:159], v6, s[16:19], s35 offen offset:2048 sc1
v_mfma_f32_16x16x32_bf16 v[48:51], v[132:135], v[176:179], v[48:51]
ds_read_b64_tr_b16 v[118:119], v8 offset:50880
s_waitcnt lgkmcnt(4)
v_mfma_f32_16x16x32_bf16 v[56:59], v[104:107], v[176:179], v[56:59]
ds_read_b64_tr_b16 v[120:121], v8 offset:46304
v_mfma_f32_16x16x32_bf16 v[60:63], v[104:107], v[180:183], v[60:63]
ds_read_b64_tr_b16 v[122:123], v8 offset:50912
v_mfma_f32_16x16x32_bf16 v[68:71], v[108:111], v[180:183], v[68:71]
ds_read_b64_tr_b16 v[124:125], v8 offset:46336
v_mfma_f32_16x16x32_bf16 v[64:67], v[108:111], v[176:179], v[64:67]
ds_read_b64_tr_b16 v[126:127], v8 offset:50944
s_waitcnt lgkmcnt(4)
v_mfma_f32_16x16x32_bf16 v[72:75], v[112:115], v[176:179], v[72:75]
ds_read_b64_tr_b16 v[128:129], v9 offset:0
v_mfma_f32_16x16x32_bf16 v[76:79], v[112:115], v[180:183], v[76:79]
ds_read_b64_tr_b16 v[130:131], v9 offset:4608
v_mfma_f32_16x16x32_bf16 v[84:87], v[116:119], v[180:183], v[84:87]
ds_read_b64_tr_b16 v[132:133], v9 offset:32
v_mfma_f32_16x16x32_bf16 v[80:83], v[116:119], v[176:179], v[80:83]
ds_read_b64_tr_b16 v[134:135], v9 offset:4640
s_waitcnt lgkmcnt(4)
v_mfma_f32_16x16x32_bf16 v[88:91], v[120:123], v[176:179], v[88:91]
ds_read_b64_tr_b16 v[104:105], v9 offset:64
v_mfma_f32_16x16x32_bf16 v[92:95], v[120:123], v[180:183], v[92:95]
ds_read_b64_tr_b16 v[106:107], v9 offset:4672
v_mfma_f32_16x16x32_bf16 v[100:103], v[124:127], v[180:183], v[100:103]
ds_read_b64_tr_b16 v[108:109], v9 offset:96
v_mfma_f32_16x16x32_bf16 v[96:99], v[124:127], v[176:179], v[96:99]
ds_read_b64_tr_b16 v[110:111], v9 offset:4704
s_barrier
s_waitcnt vmcnt(17)
s_waitcnt lgkmcnt(4)
v_mfma_f32_16x16x32_bf16 v[32:35], v[128:131], v[184:187], v[32:35]
ds_read_b64_tr_b16 v[112:113], v9 offset:128
buffer_load_dwordx4 v[160:163], v6, s[16:19], s34 offen offset:3072 sc1
v_mfma_f32_16x16x32_bf16 v[36:39], v[128:131], v[188:191], v[36:39]
ds_read_b64_tr_b16 v[114:115], v9 offset:4736
buffer_load_dwordx4 v[164:167], v6, s[16:19], s35 offen offset:3072 sc1
v_mfma_f32_16x16x32_bf16 v[44:47], v[132:135], v[188:191], v[44:47]
ds_read_b64_tr_b16 v[116:117], v9 offset:160
buffer_load_dwordx4 v[168:171], v7, s[16:19], s34 offen offset:0 sc1
v_mfma_f32_16x16x32_bf16 v[40:43], v[132:135], v[184:187], v[40:43]
ds_read_b64_tr_b16 v[118:119], v9 offset:4768
s_waitcnt lgkmcnt(4)
v_mfma_f32_16x16x32_bf16 v[48:51], v[104:107], v[184:187], v[48:51]
ds_read_b64_tr_b16 v[120:121], v9 offset:192
buffer_load_dwordx4 v[172:175], v7, s[16:19], s35 offen offset:0 sc1
v_mfma_f32_16x16x32_bf16 v[52:55], v[104:107], v[188:191], v[52:55]
ds_read_b64_tr_b16 v[122:123], v9 offset:4800
v_mfma_f32_16x16x32_bf16 v[60:63], v[108:111], v[188:191], v[60:63]
ds_read_b64_tr_b16 v[124:125], v9 offset:224
v_mfma_f32_16x16x32_bf16 v[56:59], v[108:111], v[184:187], v[56:59]
ds_read_b64_tr_b16 v[126:127], v9 offset:4832
s_waitcnt lgkmcnt(4)
v_mfma_f32_16x16x32_bf16 v[64:67], v[112:115], v[184:187], v[64:67]
ds_read_b64_tr_b16 v[128:129], v9 offset:256
v_mfma_f32_16x16x32_bf16 v[68:71], v[112:115], v[188:191], v[68:71]
ds_read_b64_tr_b16 v[130:131], v9 offset:4864
v_mfma_f32_16x16x32_bf16 v[76:79], v[116:119], v[188:191], v[76:79]
ds_read_b64_tr_b16 v[132:133], v9 offset:9216
v_mfma_f32_16x16x32_bf16 v[72:75], v[116:119], v[184:187], v[72:75]
ds_read_b64_tr_b16 v[134:135], v9 offset:13824
s_waitcnt lgkmcnt(4)
v_mfma_f32_16x16x32_bf16 v[80:83], v[120:123], v[184:187], v[80:83]
ds_read_b64_tr_b16 v[104:105], v9 offset:9248
v_mfma_f32_16x16x32_bf16 v[84:87], v[120:123], v[188:191], v[84:87]
ds_read_b64_tr_b16 v[106:107], v9 offset:13856
v_mfma_f32_16x16x32_bf16 v[92:95], v[124:127], v[188:191], v[92:95]
ds_read_b64_tr_b16 v[108:109], v9 offset:9280
v_mfma_f32_16x16x32_bf16 v[88:91], v[124:127], v[184:187], v[88:91]
ds_read_b64_tr_b16 v[110:111], v9 offset:13888
s_waitcnt lgkmcnt(4)
v_mfma_f32_16x16x32_bf16 v[96:99], v[128:131], v[184:187], v[96:99]
ds_read_b64_tr_b16 v[112:113], v9 offset:9312
v_mfma_f32_16x16x32_bf16 v[100:103], v[128:131], v[188:191], v[100:103]
ds_read_b64_tr_b16 v[114:115], v9 offset:13920
s_waitcnt vmcnt(19)
v_mfma_f32_16x16x32_bf16 v[36:39], v[132:135], v[196:199], v[36:39]
ds_read_b64_tr_b16 v[116:117], v9 offset:9344
buffer_load_dwordx4 v[176:179], v7, s[16:19], s34 offen offset:1024 sc1
v_mfma_f32_16x16x32_bf16 v[32:35], v[132:135], v[192:195], v[32:35]
ds_read_b64_tr_b16 v[118:119], v9 offset:13952
s_waitcnt lgkmcnt(4)
v_mfma_f32_16x16x32_bf16 v[40:43], v[104:107], v[192:195], v[40:43]
ds_read_b64_tr_b16 v[120:121], v9 offset:9376
buffer_load_dwordx4 v[180:183], v7, s[16:19], s35 offen offset:1024 sc1
v_mfma_f32_16x16x32_bf16 v[44:47], v[104:107], v[196:199], v[44:47]
ds_read_b64_tr_b16 v[122:123], v9 offset:13984
v_mfma_f32_16x16x32_bf16 v[52:55], v[108:111], v[196:199], v[52:55]
ds_read_b64_tr_b16 v[124:125], v9 offset:9408
v_mfma_f32_16x16x32_bf16 v[48:51], v[108:111], v[192:195], v[48:51]
ds_read_b64_tr_b16 v[126:127], v9 offset:14016
s_waitcnt lgkmcnt(4)
v_mfma_f32_16x16x32_bf16 v[56:59], v[112:115], v[192:195], v[56:59]
ds_read_b64_tr_b16 v[128:129], v9 offset:9440
v_mfma_f32_16x16x32_bf16 v[60:63], v[112:115], v[196:199], v[60:63]
ds_read_b64_tr_b16 v[130:131], v9 offset:14048
v_mfma_f32_16x16x32_bf16 v[68:71], v[116:119], v[196:199], v[68:71]
ds_read_b64_tr_b16 v[132:133], v9 offset:9472
v_mfma_f32_16x16x32_bf16 v[64:67], v[116:119], v[192:195], v[64:67]
ds_read_b64_tr_b16 v[134:135], v9 offset:14080
s_waitcnt lgkmcnt(4)
v_mfma_f32_16x16x32_bf16 v[72:75], v[120:123], v[192:195], v[72:75]
ds_read_b64_tr_b16 v[104:105], v9 offset:18432
v_mfma_f32_16x16x32_bf16 v[76:79], v[120:123], v[196:199], v[76:79]
ds_read_b64_tr_b16 v[106:107], v9 offset:23040
v_mfma_f32_16x16x32_bf16 v[84:87], v[124:127], v[196:199], v[84:87]
ds_read_b64_tr_b16 v[108:109], v9 offset:18464
v_mfma_f32_16x16x32_bf16 v[80:83], v[124:127], v[192:195], v[80:83]
ds_read_b64_tr_b16 v[110:111], v9 offset:23072
s_waitcnt lgkmcnt(4)
v_mfma_f32_16x16x32_bf16 v[88:91], v[128:131], v[192:195], v[88:91]
ds_read_b64_tr_b16 v[112:113], v9 offset:18496
v_mfma_f32_16x16x32_bf16 v[92:95], v[128:131], v[196:199], v[92:95]
ds_read_b64_tr_b16 v[114:115], v9 offset:23104
v_mfma_f32_16x16x32_bf16 v[100:103], v[132:135], v[196:199], v[100:103]
ds_read_b64_tr_b16 v[116:117], v9 offset:18528
v_mfma_f32_16x16x32_bf16 v[96:99], v[132:135], v[192:195], v[96:99]
ds_read_b64_tr_b16 v[118:119], v9 offset:23136
s_waitcnt vmcnt(19)
s_waitcnt lgkmcnt(4)
v_mfma_f32_16x16x32_bf16 v[32:35], v[104:107], v[200:203], v[32:35]
ds_read_b64_tr_b16 v[120:121], v9 offset:18560
v_mfma_f32_16x16x32_bf16 v[36:39], v[104:107], v[204:207], v[36:39]
ds_read_b64_tr_b16 v[122:123], v9 offset:23168
v_mfma_f32_16x16x32_bf16 v[44:47], v[108:111], v[204:207], v[44:47]
ds_read_b64_tr_b16 v[124:125], v9 offset:18592
v_mfma_f32_16x16x32_bf16 v[40:43], v[108:111], v[200:203], v[40:43]
ds_read_b64_tr_b16 v[126:127], v9 offset:23200
s_waitcnt lgkmcnt(4)
v_mfma_f32_16x16x32_bf16 v[48:51], v[112:115], v[200:203], v[48:51]
ds_read_b64_tr_b16 v[128:129], v9 offset:18624
v_mfma_f32_16x16x32_bf16 v[52:55], v[112:115], v[204:207], v[52:55]
ds_read_b64_tr_b16 v[130:131], v9 offset:23232
v_mfma_f32_16x16x32_bf16 v[60:63], v[116:119], v[204:207], v[60:63]
ds_read_b64_tr_b16 v[132:133], v9 offset:18656
v_mfma_f32_16x16x32_bf16 v[56:59], v[116:119], v[200:203], v[56:59]
ds_read_b64_tr_b16 v[134:135], v9 offset:23264
s_waitcnt lgkmcnt(4)
v_mfma_f32_16x16x32_bf16 v[64:67], v[120:123], v[200:203], v[64:67]
ds_read_b64_tr_b16 v[104:105], v9 offset:18688
v_mfma_f32_16x16x32_bf16 v[68:71], v[120:123], v[204:207], v[68:71]
ds_read_b64_tr_b16 v[106:107], v9 offset:23296
v_mfma_f32_16x16x32_bf16 v[76:79], v[124:127], v[204:207], v[76:79]
ds_read_b64_tr_b16 v[108:109], v9 offset:27648
v_mfma_f32_16x16x32_bf16 v[72:75], v[124:127], v[200:203], v[72:75]
ds_read_b64_tr_b16 v[110:111], v9 offset:32256
s_waitcnt lgkmcnt(4)
v_mfma_f32_16x16x32_bf16 v[80:83], v[128:131], v[200:203], v[80:83]
ds_read_b64_tr_b16 v[112:113], v9 offset:27680
v_mfma_f32_16x16x32_bf16 v[84:87], v[128:131], v[204:207], v[84:87]
ds_read_b64_tr_b16 v[114:115], v9 offset:32288
v_mfma_f32_16x16x32_bf16 v[92:95], v[132:135], v[204:207], v[92:95]
ds_read_b64_tr_b16 v[116:117], v9 offset:27712
v_mfma_f32_16x16x32_bf16 v[88:91], v[132:135], v[200:203], v[88:91]
ds_read_b64_tr_b16 v[118:119], v9 offset:32320
s_waitcnt lgkmcnt(4)
v_mfma_f32_16x16x32_bf16 v[96:99], v[104:107], v[200:203], v[96:99]
ds_read_b64_tr_b16 v[120:121], v9 offset:27744
v_mfma_f32_16x16x32_bf16 v[100:103], v[104:107], v[204:207], v[100:103]
ds_read_b64_tr_b16 v[122:123], v9 offset:32352
s_waitcnt vmcnt(17)
v_mfma_f32_16x16x32_bf16 v[36:39], v[108:111], v[212:215], v[36:39]
ds_read_b64_tr_b16 v[124:125], v9 offset:27776
v_mov_b32 v31, 3
s_mov_b64 exec, s[100:101]
ds_write_b32 v0, v31 offset:16
s_mov_b64 exec, -1
v_mfma_f32_16x16x32_bf16 v[32:35], v[108:111], v[208:211], v[32:35]
ds_read_b64_tr_b16 v[126:127], v9 offset:32384
s_waitcnt lgkmcnt(4)
v_mfma_f32_16x16x32_bf16 v[40:43], v[112:115], v[208:211], v[40:43]
ds_read_b64_tr_b16 v[128:129], v9 offset:27808
v_mfma_f32_16x16x32_bf16 v[44:47], v[112:115], v[212:215], v[44:47]
ds_read_b64_tr_b16 v[130:131], v9 offset:32416
v_mfma_f32_16x16x32_bf16 v[52:55], v[116:119], v[212:215], v[52:55]
ds_read_b64_tr_b16 v[132:133], v9 offset:27840
v_mfma_f32_16x16x32_bf16 v[48:51], v[116:119], v[208:211], v[48:51]
ds_read_b64_tr_b16 v[134:135], v9 offset:32448
s_waitcnt lgkmcnt(4)
v_mfma_f32_16x16x32_bf16 v[56:59], v[120:123], v[208:211], v[56:59]
ds_read_b64_tr_b16 v[104:105], v9 offset:27872
v_mfma_f32_16x16x32_bf16 v[60:63], v[120:123], v[212:215], v[60:63]
ds_read_b64_tr_b16 v[106:107], v9 offset:32480
v_mfma_f32_16x16x32_bf16 v[68:71], v[124:127], v[212:215], v[68:71]
ds_read_b64_tr_b16 v[108:109], v9 offset:27904
v_mfma_f32_16x16x32_bf16 v[64:67], v[124:127], v[208:211], v[64:67]
ds_read_b64_tr_b16 v[110:111], v9 offset:32512
s_waitcnt lgkmcnt(4)
v_mfma_f32_16x16x32_bf16 v[72:75], v[128:131], v[208:211], v[72:75]
ds_read_b64_tr_b16 v[112:113], v9 offset:36864
v_mfma_f32_16x16x32_bf16 v[76:79], v[128:131], v[212:215], v[76:79]
ds_read_b64_tr_b16 v[114:115], v9 offset:41472
v_mfma_f32_16x16x32_bf16 v[84:87], v[132:135], v[212:215], v[84:87]
ds_read_b64_tr_b16 v[116:117], v9 offset:36896
v_mfma_f32_16x16x32_bf16 v[80:83], v[132:135], v[208:211], v[80:83]
ds_read_b64_tr_b16 v[118:119], v9 offset:41504
s_waitcnt lgkmcnt(4)
v_mfma_f32_16x16x32_bf16 v[88:91], v[104:107], v[208:211], v[88:91]
ds_read_b64_tr_b16 v[120:121], v9 offset:36928
v_mfma_f32_16x16x32_bf16 v[92:95], v[104:107], v[212:215], v[92:95]
ds_read_b64_tr_b16 v[122:123], v9 offset:41536
v_mfma_f32_16x16x32_bf16 v[100:103], v[108:111], v[212:215], v[100:103]
ds_read_b64_tr_b16 v[124:125], v9 offset:36960
v_mfma_f32_16x16x32_bf16 v[96:99], v[108:111], v[208:211], v[96:99]
ds_read_b64_tr_b16 v[126:127], v9 offset:41568
s_waitcnt vmcnt(15)
s_waitcnt lgkmcnt(4)
v_mfma_f32_16x16x32_bf16 v[32:35], v[112:115], v[216:219], v[32:35]
ds_read_b64_tr_b16 v[128:129], v9 offset:36992
v_mfma_f32_16x16x32_bf16 v[36:39], v[112:115], v[220:223], v[36:39]
ds_read_b64_tr_b16 v[130:131], v9 offset:41600
v_mfma_f32_16x16x32_bf16 v[44:47], v[116:119], v[220:223], v[44:47]
ds_read_b64_tr_b16 v[132:133], v9 offset:37024
v_mfma_f32_16x16x32_bf16 v[40:43], v[116:119], v[216:219], v[40:43]
ds_read_b64_tr_b16 v[134:135], v9 offset:41632
s_waitcnt lgkmcnt(4)
v_mfma_f32_16x16x32_bf16 v[48:51], v[120:123], v[216:219], v[48:51]
ds_read_b64_tr_b16 v[104:105], v9 offset:37056
v_mfma_f32_16x16x32_bf16 v[52:55], v[120:123], v[220:223], v[52:55]
ds_read_b64_tr_b16 v[106:107], v9 offset:41664
v_mfma_f32_16x16x32_bf16 v[60:63], v[124:127], v[220:223], v[60:63]
ds_read_b64_tr_b16 v[108:109], v9 offset:37088
v_mfma_f32_16x16x32_bf16 v[56:59], v[124:127], v[216:219], v[56:59]
ds_read_b64_tr_b16 v[110:111], v9 offset:41696
s_waitcnt lgkmcnt(4)
v_mfma_f32_16x16x32_bf16 v[64:67], v[128:131], v[216:219], v[64:67]
ds_read_b64_tr_b16 v[112:113], v9 offset:37120
v_mfma_f32_16x16x32_bf16 v[68:71], v[128:131], v[220:223], v[68:71]
ds_read_b64_tr_b16 v[114:115], v9 offset:41728
v_mfma_f32_16x16x32_bf16 v[76:79], v[132:135], v[220:223], v[76:79]
ds_read_b64_tr_b16 v[116:117], v9 offset:46080
v_mfma_f32_16x16x32_bf16 v[72:75], v[132:135], v[216:219], v[72:75]
ds_read_b64_tr_b16 v[118:119], v9 offset:50688
s_waitcnt lgkmcnt(4)
v_mfma_f32_16x16x32_bf16 v[80:83], v[104:107], v[216:219], v[80:83]
ds_read_b64_tr_b16 v[120:121], v9 offset:46112
v_mfma_f32_16x16x32_bf16 v[84:87], v[104:107], v[220:223], v[84:87]
ds_read_b64_tr_b16 v[122:123], v9 offset:50720
v_mfma_f32_16x16x32_bf16 v[92:95], v[108:111], v[220:223], v[92:95]
ds_read_b64_tr_b16 v[124:125], v9 offset:46144
v_mfma_f32_16x16x32_bf16 v[88:91], v[108:111], v[216:219], v[88:91]
ds_read_b64_tr_b16 v[126:127], v9 offset:50752
s_waitcnt lgkmcnt(4)
v_mfma_f32_16x16x32_bf16 v[96:99], v[112:115], v[216:219], v[96:99]
ds_read_b64_tr_b16 v[128:129], v9 offset:46176
v_mfma_f32_16x16x32_bf16 v[100:103], v[112:115], v[220:223], v[100:103]
ds_read_b64_tr_b16 v[130:131], v9 offset:50784
s_waitcnt vmcnt(12)
v_mfma_f32_16x16x32_bf16 v[36:39], v[116:119], v[228:231], v[36:39]
ds_read_b64_tr_b16 v[132:133], v9 offset:46208
v_mfma_f32_16x16x32_bf16 v[32:35], v[116:119], v[224:227], v[32:35]
ds_read_b64_tr_b16 v[134:135], v9 offset:50816
s_waitcnt lgkmcnt(4)
v_mfma_f32_16x16x32_bf16 v[40:43], v[120:123], v[224:227], v[40:43]
ds_read_b64_tr_b16 v[104:105], v9 offset:46240
v_mfma_f32_16x16x32_bf16 v[44:47], v[120:123], v[228:231], v[44:47]
ds_read_b64_tr_b16 v[106:107], v9 offset:50848
v_mfma_f32_16x16x32_bf16 v[52:55], v[124:127], v[228:231], v[52:55]
ds_read_b64_tr_b16 v[108:109], v9 offset:46272
v_mfma_f32_16x16x32_bf16 v[48:51], v[124:127], v[224:227], v[48:51]
ds_read_b64_tr_b16 v[110:111], v9 offset:50880
s_waitcnt lgkmcnt(4)
v_mfma_f32_16x16x32_bf16 v[56:59], v[128:131], v[224:227], v[56:59]
ds_read_b64_tr_b16 v[112:113], v9 offset:46304
v_mfma_f32_16x16x32_bf16 v[60:63], v[128:131], v[228:231], v[60:63]
ds_read_b64_tr_b16 v[114:115], v9 offset:50912
v_mfma_f32_16x16x32_bf16 v[68:71], v[132:135], v[228:231], v[68:71]
ds_read_b64_tr_b16 v[116:117], v9 offset:46336
v_mfma_f32_16x16x32_bf16 v[64:67], v[132:135], v[224:227], v[64:67]
ds_read_b64_tr_b16 v[118:119], v9 offset:50944
s_waitcnt lgkmcnt(4)
v_mfma_f32_16x16x32_bf16 v[72:75], v[104:107], v[224:227], v[72:75]
ds_read_b64_tr_b16 v[120:121], v10 offset:0
v_mfma_f32_16x16x32_bf16 v[76:79], v[104:107], v[228:231], v[76:79]
ds_read_b64_tr_b16 v[122:123], v10 offset:4608
v_mfma_f32_16x16x32_bf16 v[84:87], v[108:111], v[228:231], v[84:87]
ds_read_b64_tr_b16 v[124:125], v10 offset:32
v_mfma_f32_16x16x32_bf16 v[80:83], v[108:111], v[224:227], v[80:83]
ds_read_b64_tr_b16 v[126:127], v10 offset:4640
s_waitcnt lgkmcnt(4)
v_mfma_f32_16x16x32_bf16 v[88:91], v[112:115], v[224:227], v[88:91]
ds_read_b64_tr_b16 v[128:129], v10 offset:64
v_mfma_f32_16x16x32_bf16 v[92:95], v[112:115], v[228:231], v[92:95]
ds_read_b64_tr_b16 v[130:131], v10 offset:4672
v_mfma_f32_16x16x32_bf16 v[100:103], v[116:119], v[228:231], v[100:103]
ds_read_b64_tr_b16 v[132:133], v10 offset:96
v_mfma_f32_16x16x32_bf16 v[96:99], v[116:119], v[224:227], v[96:99]
ds_read_b64_tr_b16 v[134:135], v10 offset:4704
s_waitcnt vmcnt(10)
s_waitcnt lgkmcnt(4)
v_mfma_f32_16x16x32_bf16 v[32:35], v[120:123], v[136:139], v[32:35]
ds_read_b64_tr_b16 v[104:105], v10 offset:128
v_mfma_f32_16x16x32_bf16 v[36:39], v[120:123], v[140:143], v[36:39]
ds_read_b64_tr_b16 v[106:107], v10 offset:4736
v_mfma_f32_16x16x32_bf16 v[44:47], v[124:127], v[140:143], v[44:47]
ds_read_b64_tr_b16 v[108:109], v10 offset:160
v_mfma_f32_16x16x32_bf16 v[40:43], v[124:127], v[136:139], v[40:43]
ds_read_b64_tr_b16 v[110:111], v10 offset:4768
s_waitcnt lgkmcnt(4)
v_mfma_f32_16x16x32_bf16 v[48:51], v[128:131], v[136:139], v[48:51]
ds_read_b64_tr_b16 v[112:113], v10 offset:192
v_mfma_f32_16x16x32_bf16 v[52:55], v[128:131], v[140:143], v[52:55]
ds_read_b64_tr_b16 v[114:115], v10 offset:4800
v_mfma_f32_16x16x32_bf16 v[60:63], v[132:135], v[140:143], v[60:63]
ds_read_b64_tr_b16 v[116:117], v10 offset:224
v_mfma_f32_16x16x32_bf16 v[56:59], v[132:135], v[136:139], v[56:59]
ds_read_b64_tr_b16 v[118:119], v10 offset:4832
s_waitcnt lgkmcnt(4)
v_mfma_f32_16x16x32_bf16 v[64:67], v[104:107], v[136:139], v[64:67]
ds_read_b64_tr_b16 v[120:121], v10 offset:256
v_mfma_f32_16x16x32_bf16 v[68:71], v[104:107], v[140:143], v[68:71]
ds_read_b64_tr_b16 v[122:123], v10 offset:4864
v_mfma_f32_16x16x32_bf16 v[76:79], v[108:111], v[140:143], v[76:79]
ds_read_b64_tr_b16 v[124:125], v10 offset:9216
v_mfma_f32_16x16x32_bf16 v[72:75], v[108:111], v[136:139], v[72:75]
ds_read_b64_tr_b16 v[126:127], v10 offset:13824
s_waitcnt lgkmcnt(4)
v_mfma_f32_16x16x32_bf16 v[80:83], v[112:115], v[136:139], v[80:83]
ds_read_b64_tr_b16 v[128:129], v10 offset:9248
v_mfma_f32_16x16x32_bf16 v[84:87], v[112:115], v[140:143], v[84:87]
ds_read_b64_tr_b16 v[130:131], v10 offset:13856
v_mfma_f32_16x16x32_bf16 v[92:95], v[116:119], v[140:143], v[92:95]
ds_read_b64_tr_b16 v[132:133], v10 offset:9280
v_mfma_f32_16x16x32_bf16 v[88:91], v[116:119], v[136:139], v[88:91]
ds_read_b64_tr_b16 v[134:135], v10 offset:13888
s_waitcnt lgkmcnt(4)
v_mfma_f32_16x16x32_bf16 v[96:99], v[120:123], v[136:139], v[96:99]
ds_read_b64_tr_b16 v[104:105], v10 offset:9312
v_mfma_f32_16x16x32_bf16 v[100:103], v[120:123], v[140:143], v[100:103]
ds_read_b64_tr_b16 v[106:107], v10 offset:13920
s_waitcnt vmcnt(8)
v_mfma_f32_16x16x32_bf16 v[36:39], v[124:127], v[148:151], v[36:39]
ds_read_b64_tr_b16 v[108:109], v10 offset:9344
v_mfma_f32_16x16x32_bf16 v[32:35], v[124:127], v[144:147], v[32:35]
ds_read_b64_tr_b16 v[110:111], v10 offset:13952
s_waitcnt lgkmcnt(4)
v_mfma_f32_16x16x32_bf16 v[40:43], v[128:131], v[144:147], v[40:43]
ds_read_b64_tr_b16 v[112:113], v10 offset:9376
v_mfma_f32_16x16x32_bf16 v[44:47], v[128:131], v[148:151], v[44:47]
ds_read_b64_tr_b16 v[114:115], v10 offset:13984
v_mfma_f32_16x16x32_bf16 v[52:55], v[132:135], v[148:151], v[52:55]
ds_read_b64_tr_b16 v[116:117], v10 offset:9408
v_mfma_f32_16x16x32_bf16 v[48:51], v[132:135], v[144:147], v[48:51]
ds_read_b64_tr_b16 v[118:119], v10 offset:14016
s_waitcnt lgkmcnt(4)
v_mfma_f32_16x16x32_bf16 v[56:59], v[104:107], v[144:147], v[56:59]
ds_read_b64_tr_b16 v[120:121], v10 offset:9440
v_mfma_f32_16x16x32_bf16 v[60:63], v[104:107], v[148:151], v[60:63]
ds_read_b64_tr_b16 v[122:123], v10 offset:14048
v_mfma_f32_16x16x32_bf16 v[68:71], v[108:111], v[148:151], v[68:71]
ds_read_b64_tr_b16 v[124:125], v10 offset:9472
v_mfma_f32_16x16x32_bf16 v[64:67], v[108:111], v[144:147], v[64:67]
ds_read_b64_tr_b16 v[126:127], v10 offset:14080
s_waitcnt lgkmcnt(4)
v_mfma_f32_16x16x32_bf16 v[72:75], v[112:115], v[144:147], v[72:75]
ds_read_b64_tr_b16 v[128:129], v10 offset:18432
v_mfma_f32_16x16x32_bf16 v[76:79], v[112:115], v[148:151], v[76:79]
ds_read_b64_tr_b16 v[130:131], v10 offset:23040
v_mfma_f32_16x16x32_bf16 v[84:87], v[116:119], v[148:151], v[84:87]
ds_read_b64_tr_b16 v[132:133], v10 offset:18464
v_mfma_f32_16x16x32_bf16 v[80:83], v[116:119], v[144:147], v[80:83]
ds_read_b64_tr_b16 v[134:135], v10 offset:23072
s_waitcnt lgkmcnt(4)
v_mfma_f32_16x16x32_bf16 v[88:91], v[120:123], v[144:147], v[88:91]
ds_read_b64_tr_b16 v[104:105], v10 offset:18496
v_mfma_f32_16x16x32_bf16 v[92:95], v[120:123], v[148:151], v[92:95]
ds_read_b64_tr_b16 v[106:107], v10 offset:23104
v_mfma_f32_16x16x32_bf16 v[100:103], v[124:127], v[148:151], v[100:103]
ds_read_b64_tr_b16 v[108:109], v10 offset:18528
v_mfma_f32_16x16x32_bf16 v[96:99], v[124:127], v[144:147], v[96:99]
ds_read_b64_tr_b16 v[110:111], v10 offset:23136
s_waitcnt vmcnt(6)
s_waitcnt lgkmcnt(4)
v_mfma_f32_16x16x32_bf16 v[32:35], v[128:131], v[152:155], v[32:35]
ds_read_b64_tr_b16 v[112:113], v10 offset:18560
v_mfma_f32_16x16x32_bf16 v[36:39], v[128:131], v[156:159], v[36:39]
ds_read_b64_tr_b16 v[114:115], v10 offset:23168
v_mfma_f32_16x16x32_bf16 v[44:47], v[132:135], v[156:159], v[44:47]
ds_read_b64_tr_b16 v[116:117], v10 offset:18592
v_mfma_f32_16x16x32_bf16 v[40:43], v[132:135], v[152:155], v[40:43]
ds_read_b64_tr_b16 v[118:119], v10 offset:23200
s_waitcnt lgkmcnt(4)
v_mfma_f32_16x16x32_bf16 v[48:51], v[104:107], v[152:155], v[48:51]
ds_read_b64_tr_b16 v[120:121], v10 offset:18624
v_mfma_f32_16x16x32_bf16 v[52:55], v[104:107], v[156:159], v[52:55]
ds_read_b64_tr_b16 v[122:123], v10 offset:23232
v_mfma_f32_16x16x32_bf16 v[60:63], v[108:111], v[156:159], v[60:63]
ds_read_b64_tr_b16 v[124:125], v10 offset:18656
v_mfma_f32_16x16x32_bf16 v[56:59], v[108:111], v[152:155], v[56:59]
ds_read_b64_tr_b16 v[126:127], v10 offset:23264
s_waitcnt lgkmcnt(4)
v_mfma_f32_16x16x32_bf16 v[64:67], v[112:115], v[152:155], v[64:67]
ds_read_b64_tr_b16 v[128:129], v10 offset:18688
v_mfma_f32_16x16x32_bf16 v[68:71], v[112:115], v[156:159], v[68:71]
ds_read_b64_tr_b16 v[130:131], v10 offset:23296
v_mfma_f32_16x16x32_bf16 v[76:79], v[116:119], v[156:159], v[76:79]
ds_read_b64_tr_b16 v[132:133], v8 offset:0
v_mfma_f32_16x16x32_bf16 v[72:75], v[116:119], v[152:155], v[72:75]
ds_read_b64_tr_b16 v[134:135], v8 offset:4608
s_waitcnt lgkmcnt(4)
v_mfma_f32_16x16x32_bf16 v[80:83], v[120:123], v[152:155], v[80:83]
ds_read_b64_tr_b16 v[104:105], v8 offset:32
v_mfma_f32_16x16x32_bf16 v[84:87], v[120:123], v[156:159], v[84:87]
ds_read_b64_tr_b16 v[106:107], v8 offset:4640
v_mfma_f32_16x16x32_bf16 v[92:95], v[124:127], v[156:159], v[92:95]
ds_read_b64_tr_b16 v[108:109], v8 offset:64
v_mfma_f32_16x16x32_bf16 v[88:91], v[124:127], v[152:155], v[88:91]
ds_read_b64_tr_b16 v[110:111], v8 offset:4672
s_waitcnt lgkmcnt(4)
v_mfma_f32_16x16x32_bf16 v[96:99], v[128:131], v[152:155], v[96:99]
ds_read_b64_tr_b16 v[112:113], v8 offset:96
v_mfma_f32_16x16x32_bf16 v[100:103], v[128:131], v[156:159], v[100:103]
ds_read_b64_tr_b16 v[114:115], v8 offset:4704
s_waitcnt vmcnt(4)
v_mfma_f32_16x16x32_bf16 v[36:39], v[132:135], v[164:167], v[36:39]
ds_read_b64_tr_b16 v[116:117], v8 offset:128
v_mov_b32 v31, 4
s_mov_b64 exec, s[100:101]
ds_write_b32 v0, v31 offset:16
s_mov_b64 exec, -1
v_mfma_f32_16x16x32_bf16 v[32:35], v[132:135], v[160:163], v[32:35]
ds_read_b64_tr_b16 v[118:119], v8 offset:4736
s_waitcnt lgkmcnt(4)
v_mfma_f32_16x16x32_bf16 v[40:43], v[104:107], v[160:163], v[40:43]
ds_read_b64_tr_b16 v[120:121], v8 offset:160
v_mfma_f32_16x16x32_bf16 v[44:47], v[104:107], v[164:167], v[44:47]
ds_read_b64_tr_b16 v[122:123], v8 offset:4768
v_mfma_f32_16x16x32_bf16 v[52:55], v[108:111], v[164:167], v[52:55]
ds_read_b64_tr_b16 v[124:125], v8 offset:192
v_mfma_f32_16x16x32_bf16 v[48:51], v[108:111], v[160:163], v[48:51]
ds_read_b64_tr_b16 v[126:127], v8 offset:4800
s_waitcnt lgkmcnt(4)
v_mfma_f32_16x16x32_bf16 v[56:59], v[112:115], v[160:163], v[56:59]
ds_read_b64_tr_b16 v[128:129], v8 offset:224
v_mfma_f32_16x16x32_bf16 v[60:63], v[112:115], v[164:167], v[60:63]
ds_read_b64_tr_b16 v[130:131], v8 offset:4832
v_mfma_f32_16x16x32_bf16 v[68:71], v[116:119], v[164:167], v[68:71]
ds_read_b64_tr_b16 v[132:133], v8 offset:256
v_mfma_f32_16x16x32_bf16 v[64:67], v[116:119], v[160:163], v[64:67]
ds_read_b64_tr_b16 v[134:135], v8 offset:4864
s_waitcnt lgkmcnt(4)
v_mfma_f32_16x16x32_bf16 v[72:75], v[120:123], v[160:163], v[72:75]
ds_read_b64_tr_b16 v[104:105], v8 offset:9216
v_mfma_f32_16x16x32_bf16 v[76:79], v[120:123], v[164:167], v[76:79]
ds_read_b64_tr_b16 v[106:107], v8 offset:13824
v_mfma_f32_16x16x32_bf16 v[84:87], v[124:127], v[164:167], v[84:87]
ds_read_b64_tr_b16 v[108:109], v8 offset:9248
v_mfma_f32_16x16x32_bf16 v[80:83], v[124:127], v[160:163], v[80:83]
ds_read_b64_tr_b16 v[110:111], v8 offset:13856
s_waitcnt lgkmcnt(4)
v_mfma_f32_16x16x32_bf16 v[88:91], v[128:131], v[160:163], v[88:91]
ds_read_b64_tr_b16 v[112:113], v8 offset:9280
v_mfma_f32_16x16x32_bf16 v[92:95], v[128:131], v[164:167], v[92:95]
ds_read_b64_tr_b16 v[114:115], v8 offset:13888
v_mfma_f32_16x16x32_bf16 v[100:103], v[132:135], v[164:167], v[100:103]
ds_read_b64_tr_b16 v[116:117], v8 offset:9312
v_mfma_f32_16x16x32_bf16 v[96:99], v[132:135], v[160:163], v[96:99]
ds_read_b64_tr_b16 v[118:119], v8 offset:13920
s_waitcnt vmcnt(2)
s_waitcnt lgkmcnt(4)
v_mfma_f32_16x16x32_bf16 v[32:35], v[104:107], v[168:171], v[32:35]
ds_read_b64_tr_b16 v[120:121], v8 offset:9344
v_mfma_f32_16x16x32_bf16 v[36:39], v[104:107], v[172:175], v[36:39]
ds_read_b64_tr_b16 v[122:123], v8 offset:13952
v_mfma_f32_16x16x32_bf16 v[44:47], v[108:111], v[172:175], v[44:47]
ds_read_b64_tr_b16 v[124:125], v8 offset:9376
v_mfma_f32_16x16x32_bf16 v[40:43], v[108:111], v[168:171], v[40:43]
ds_read_b64_tr_b16 v[126:127], v8 offset:13984
s_waitcnt lgkmcnt(4)
v_mfma_f32_16x16x32_bf16 v[48:51], v[112:115], v[168:171], v[48:51]
ds_read_b64_tr_b16 v[128:129], v8 offset:9408
v_mfma_f32_16x16x32_bf16 v[52:55], v[112:115], v[172:175], v[52:55]
ds_read_b64_tr_b16 v[130:131], v8 offset:14016
v_mfma_f32_16x16x32_bf16 v[60:63], v[116:119], v[172:175], v[60:63]
ds_read_b64_tr_b16 v[132:133], v8 offset:9440
v_mfma_f32_16x16x32_bf16 v[56:59], v[116:119], v[168:171], v[56:59]
ds_read_b64_tr_b16 v[134:135], v8 offset:14048
s_waitcnt lgkmcnt(4)
v_mfma_f32_16x16x32_bf16 v[64:67], v[120:123], v[168:171], v[64:67]
ds_read_b64_tr_b16 v[104:105], v8 offset:9472
v_mfma_f32_16x16x32_bf16 v[68:71], v[120:123], v[172:175], v[68:71]
ds_read_b64_tr_b16 v[106:107], v8 offset:14080
v_mfma_f32_16x16x32_bf16 v[76:79], v[124:127], v[172:175], v[76:79]
ds_read_b64_tr_b16 v[108:109], v8 offset:18432
v_mfma_f32_16x16x32_bf16 v[72:75], v[124:127], v[168:171], v[72:75]
ds_read_b64_tr_b16 v[110:111], v8 offset:23040
s_waitcnt lgkmcnt(4)
v_mfma_f32_16x16x32_bf16 v[80:83], v[128:131], v[168:171], v[80:83]
ds_read_b64_tr_b16 v[112:113], v8 offset:18464
v_mfma_f32_16x16x32_bf16 v[84:87], v[128:131], v[172:175], v[84:87]
ds_read_b64_tr_b16 v[114:115], v8 offset:23072
v_mfma_f32_16x16x32_bf16 v[92:95], v[132:135], v[172:175], v[92:95]
ds_read_b64_tr_b16 v[116:117], v8 offset:18496
v_mfma_f32_16x16x32_bf16 v[88:91], v[132:135], v[168:171], v[88:91]
ds_read_b64_tr_b16 v[118:119], v8 offset:23104
s_waitcnt lgkmcnt(4)
v_mfma_f32_16x16x32_bf16 v[96:99], v[104:107], v[168:171], v[96:99]
ds_read_b64_tr_b16 v[120:121], v8 offset:18528
v_mfma_f32_16x16x32_bf16 v[100:103], v[104:107], v[172:175], v[100:103]
ds_read_b64_tr_b16 v[122:123], v8 offset:23136
s_waitcnt vmcnt(0)
v_mfma_f32_16x16x32_bf16 v[36:39], v[108:111], v[180:183], v[36:39]
ds_read_b64_tr_b16 v[124:125], v8 offset:18560
v_mfma_f32_16x16x32_bf16 v[32:35], v[108:111], v[176:179], v[32:35]
ds_read_b64_tr_b16 v[126:127], v8 offset:23168
s_waitcnt lgkmcnt(4)
v_mfma_f32_16x16x32_bf16 v[40:43], v[112:115], v[176:179], v[40:43]
ds_read_b64_tr_b16 v[128:129], v8 offset:18592
v_mfma_f32_16x16x32_bf16 v[44:47], v[112:115], v[180:183], v[44:47]
ds_read_b64_tr_b16 v[130:131], v8 offset:23200
v_mfma_f32_16x16x32_bf16 v[52:55], v[116:119], v[180:183], v[52:55]
ds_read_b64_tr_b16 v[132:133], v8 offset:18624
v_mfma_f32_16x16x32_bf16 v[48:51], v[116:119], v[176:179], v[48:51]
ds_read_b64_tr_b16 v[134:135], v8 offset:23232
s_waitcnt lgkmcnt(4)
v_mfma_f32_16x16x32_bf16 v[56:59], v[120:123], v[176:179], v[56:59]
ds_read_b64_tr_b16 v[104:105], v8 offset:18656
v_mfma_f32_16x16x32_bf16 v[60:63], v[120:123], v[180:183], v[60:63]
ds_read_b64_tr_b16 v[106:107], v8 offset:23264
v_mfma_f32_16x16x32_bf16 v[68:71], v[124:127], v[180:183], v[68:71]
ds_read_b64_tr_b16 v[108:109], v8 offset:18688
v_mfma_f32_16x16x32_bf16 v[64:67], v[124:127], v[176:179], v[64:67]
ds_read_b64_tr_b16 v[110:111], v8 offset:23296
s_waitcnt lgkmcnt(4)
v_mfma_f32_16x16x32_bf16 v[72:75], v[128:131], v[176:179], v[72:75]
v_mfma_f32_16x16x32_bf16 v[76:79], v[128:131], v[180:183], v[76:79]
v_mfma_f32_16x16x32_bf16 v[84:87], v[132:135], v[180:183], v[84:87]
v_mfma_f32_16x16x32_bf16 v[80:83], v[132:135], v[176:179], v[80:83]
s_waitcnt lgkmcnt(0)
v_mfma_f32_16x16x32_bf16 v[88:91], v[104:107], v[176:179], v[88:91]
v_mfma_f32_16x16x32_bf16 v[92:95], v[104:107], v[180:183], v[92:95]
v_mfma_f32_16x16x32_bf16 v[100:103], v[108:111], v[180:183], v[100:103]
v_mfma_f32_16x16x32_bf16 v[96:99], v[108:111], v[176:179], v[96:99]
s_mov_b32 s58, 0x100000
LLs_102:
ds_read_b32 v31, v0 offset:16
s_sub_u32 s58, s58, 1
s_waitcnt lgkmcnt(0)
v_cmp_gt_u32 vcc, 4, v31
s_nop 1
s_and_b32 s33, vcc_lo, 15
s_cbranch_scc0 LBs_103
s_sleep 2
s_cmp_gt_i32 s58, 0
s_cbranch_scc1 LLs_102
LBs_103:
ds_read_u16 v224, v240 offset:2048
ds_read_u16 v225, v241 offset:2048
ds_read_u16 v226, v242 offset:2048
ds_read_u16 v227, v243 offset:2048
ds_read_u16 v228, v244 offset:2048
ds_read_u16 v229, v245 offset:2048
ds_read_u16 v230, v246 offset:2048
ds_read_u16 v231, v247 offset:2048
ds_read_u16 v232, v248 offset:2048
ds_read_u16 v233, v249 offset:2048
ds_read_u16 v234, v250 offset:2048
ds_read_u16 v120, v240 offset:4096
ds_read_u16 v121, v241 offset:4096
ds_read_u16 v122, v242 offset:4096
ds_read_u16 v123, v243 offset:4096
ds_read_u16 v124, v244 offset:4096
ds_read_u16 v125, v245 offset:4096
ds_read_u16 v126, v246 offset:4096
ds_read_u16 v127, v247 offset:4096
ds_read_u16 v128, v248 offset:4096
ds_read_u16 v129, v249 offset:4096
ds_read_u16 v130, v250 offset:4096
s_waitcnt lgkmcnt(0)
v_lshl_or_b32 v208, v225, 16, v224
v_lshl_or_b32 v209, v227, 16, v226
v_lshl_or_b32 v210, v229, 16, v228
v_lshl_or_b32 v211, v231, 16, v230
ds_write_b128 v251, v[208:211] offset:18432
v_lshl_or_b32 v212, v226, 16, v225
v_lshl_or_b32 v213, v228, 16, v227
v_lshl_or_b32 v214, v230, 16, v229
v_lshl_or_b32 v215, v232, 16, v231
ds_write_b128 v251, v[212:215] offset:22592
v_lshl_or_b32 v216, v227, 16, v226
v_lshl_or_b32 v217, v229, 16, v228
v_lshl_or_b32 v218, v231, 16, v230
v_lshl_or_b32 v219, v233, 16, v232
ds_write_b128 v251, v[216:219] offset:26752
v_lshl_or_b32 v220, v228, 16, v227
v_lshl_or_b32 v221, v230, 16, v229
v_lshl_or_b32 v222, v232, 16, v231
v_lshl_or_b32 v223, v234, 16, v233
ds_write_b128 v251, v[220:223] offset:30912
s_waitcnt lgkmcnt(0)
v_mov_b32 v31, 5
s_mov_b64 exec, s[100:101]
ds_write_b32 v0, v31 offset:16
s_mov_b64 exec, -1
v_exp_f32 v20, -v32
v_exp_f32 v21, -v33
v_exp_f32 v22, -v34
v_exp_f32 v23, -v35
v_exp_f32 v24, -v36
v_exp_f32 v25, -v37
v_exp_f32 v26, -v38
v_exp_f32 v27, -v39
v_add_f32 v20, 1.0, v20
v_add_f32 v21, 1.0, v21
v_add_f32 v22, 1.0, v22
v_add_f32 v23, 1.0, v23
v_add_f32 v24, 1.0, v24
v_add_f32 v25, 1.0, v25
v_add_f32 v26, 1.0, v26
v_add_f32 v27, 1.0, v27
v_rcp_f32 v20, v20
v_rcp_f32 v21, v21
v_rcp_f32 v22, v22
v_rcp_f32 v23, v23
v_rcp_f32 v24, v24
v_rcp_f32 v25, v25
v_rcp_f32 v26, v26
v_rcp_f32 v27, v27
v_mul_f32 v20, v32, v20
v_mul_f32 v21, v33, v21
v_mul_f32 v22, v34, v22
v_mul_f32 v23, v35, v23
v_cvt_pk_bf16_f32 v136, v20, v21
v_cvt_pk_bf16_f32 v137, v22, v23
v_mul_f32 v24, v36, v24
v_mul_f32 v25, v37, v25
v_mul_f32 v26, v38, v26
v_mul_f32 v27, v39, v27
v_cvt_pk_bf16_f32 v140, v24, v25
v_cvt_pk_bf16_f32 v141, v26, v27
s_waitcnt lgkmcnt(0)
v_lshl_or_b32 v104, v121, 16, v120
v_lshl_or_b32 v105, v123, 16, v122
v_lshl_or_b32 v106, v125, 16, v124
v_lshl_or_b32 v107, v127, 16, v126
ds_write_b128 v251, v[104:107] offset:36864
v_lshl_or_b32 v108, v122, 16, v121
v_lshl_or_b32 v109, v124, 16, v123
v_lshl_or_b32 v110, v126, 16, v125
v_lshl_or_b32 v111, v128, 16, v127
ds_write_b128 v251, v[108:111] offset:41024
v_lshl_or_b32 v112, v123, 16, v122
v_lshl_or_b32 v113, v125, 16, v124
v_lshl_or_b32 v114, v127, 16, v126
v_lshl_or_b32 v115, v129, 16, v128
ds_write_b128 v251, v[112:115] offset:45184
v_lshl_or_b32 v116, v124, 16, v123
v_lshl_or_b32 v117, v126, 16, v125
v_lshl_or_b32 v118, v128, 16, v127
v_lshl_or_b32 v119, v130, 16, v129
ds_write_b128 v251, v[116:119] offset:49344
v_exp_f32 v20, -v40
v_exp_f32 v21, -v41
v_exp_f32 v22, -v42
v_exp_f32 v23, -v43
v_exp_f32 v24, -v44
v_exp_f32 v25, -v45
v_exp_f32 v26, -v46
v_exp_f32 v27, -v47
v_add_f32 v20, 1.0, v20
v_add_f32 v21, 1.0, v21
v_add_f32 v22, 1.0, v22
v_add_f32 v23, 1.0, v23
v_add_f32 v24, 1.0, v24
v_add_f32 v25, 1.0, v25
v_add_f32 v26, 1.0, v26
v_add_f32 v27, 1.0, v27
v_rcp_f32 v20, v20
v_rcp_f32 v21, v21
v_rcp_f32 v22, v22
v_rcp_f32 v23, v23
v_rcp_f32 v24, v24
v_rcp_f32 v25, v25
v_rcp_f32 v26, v26
v_rcp_f32 v27, v27
v_mul_f32 v20, v40, v20
v_mul_f32 v21, v41, v21
v_mul_f32 v22, v42, v22
v_mul_f32 v23, v43, v23
v_cvt_pk_bf16_f32 v138, v20, v21
v_cvt_pk_bf16_f32 v139, v22, v23
v_mul_f32 v24, v44, v24
v_mul_f32 v25, v45, v25
v_mul_f32 v26, v46, v26
v_mul_f32 v27, v47, v27
v_cvt_pk_bf16_f32 v142, v24, v25
v_cvt_pk_bf16_f32 v143, v26, v27
buffer_store_dwordx4 v[136:139], v3, s[16:19], s44 offen offset:0 sc1
buffer_store_dwordx4 v[140:143], v3, s[16:19], s44 offen offset:1024 sc1
v_exp_f32 v20, -v48
v_exp_f32 v21, -v49
v_exp_f32 v22, -v50
v_exp_f32 v23, -v51
v_exp_f32 v24, -v52
v_exp_f32 v25, -v53
v_exp_f32 v26, -v54
v_exp_f32 v27, -v55
v_add_f32 v20, 1.0, v20
v_add_f32 v21, 1.0, v21
v_add_f32 v22, 1.0, v22
v_add_f32 v23, 1.0, v23
v_add_f32 v24, 1.0, v24
v_add_f32 v25, 1.0, v25
v_add_f32 v26, 1.0, v26
v_add_f32 v27, 1.0, v27
v_rcp_f32 v20, v20
v_rcp_f32 v21, v21
v_rcp_f32 v22, v22
v_rcp_f32 v23, v23
v_rcp_f32 v24, v24
v_rcp_f32 v25, v25
v_rcp_f32 v26, v26
v_rcp_f32 v27, v27
v_mul_f32 v20, v48, v20
v_mul_f32 v21, v49, v21
v_mul_f32 v22, v50, v22
v_mul_f32 v23, v51, v23
v_cvt_pk_bf16_f32 v144, v20, v21
v_cvt_pk_bf16_f32 v145, v22, v23
v_mul_f32 v24, v52, v24
v_mul_f32 v25, v53, v25
v_mul_f32 v26, v54, v26
v_mul_f32 v27, v55, v27
v_cvt_pk_bf16_f32 v148, v24, v25
v_cvt_pk_bf16_f32 v149, v26, v27
v_exp_f32 v20, -v56
v_exp_f32 v21, -v57
v_exp_f32 v22, -v58
v_exp_f32 v23, -v59
v_exp_f32 v24, -v60
v_exp_f32 v25, -v61
v_exp_f32 v26, -v62
v_exp_f32 v27, -v63
v_add_f32 v20, 1.0, v20
v_add_f32 v21, 1.0, v21
v_add_f32 v22, 1.0, v22
v_add_f32 v23, 1.0, v23
v_add_f32 v24, 1.0, v24
v_add_f32 v25, 1.0, v25
v_add_f32 v26, 1.0, v26
v_add_f32 v27, 1.0, v27
v_rcp_f32 v20, v20
v_rcp_f32 v21, v21
v_rcp_f32 v22, v22
v_rcp_f32 v23, v23
v_rcp_f32 v24, v24
v_rcp_f32 v25, v25
v_rcp_f32 v26, v26
v_rcp_f32 v27, v27
v_mul_f32 v20, v56, v20
v_mul_f32 v21, v57, v21
v_mul_f32 v22, v58, v22
v_mul_f32 v23, v59, v23
v_cvt_pk_bf16_f32 v146, v20, v21
v_cvt_pk_bf16_f32 v147, v22, v23
v_mul_f32 v24, v60, v24
v_mul_f32 v25, v61, v25
v_mul_f32 v26, v62, v26
v_mul_f32 v27, v63, v27
v_cvt_pk_bf16_f32 v150, v24, v25
v_cvt_pk_bf16_f32 v151, v26, v27
buffer_store_dwordx4 v[144:147], v3, s[16:19], s44 offen offset:2048 sc1
buffer_store_dwordx4 v[148:151], v3, s[16:19], s44 offen offset:3072 sc1
v_exp_f32 v20, -v64
v_exp_f32 v21, -v65
v_exp_f32 v22, -v66
v_exp_f32 v23, -v67
v_exp_f32 v24, -v68
v_exp_f32 v25, -v69
v_exp_f32 v26, -v70
v_exp_f32 v27, -v71
v_add_f32 v20, 1.0, v20
v_add_f32 v21, 1.0, v21
v_add_f32 v22, 1.0, v22
v_add_f32 v23, 1.0, v23
v_add_f32 v24, 1.0, v24
v_add_f32 v25, 1.0, v25
v_add_f32 v26, 1.0, v26
v_add_f32 v27, 1.0, v27
v_rcp_f32 v20, v20
v_rcp_f32 v21, v21
v_rcp_f32 v22, v22
v_rcp_f32 v23, v23
v_rcp_f32 v24, v24
v_rcp_f32 v25, v25
v_rcp_f32 v26, v26
v_rcp_f32 v27, v27
v_mul_f32 v20, v64, v20
v_mul_f32 v21, v65, v21
v_mul_f32 v22, v66, v22
v_mul_f32 v23, v67, v23
v_cvt_pk_bf16_f32 v152, v20, v21
v_cvt_pk_bf16_f32 v153, v22, v23
v_mul_f32 v24, v68, v24
v_mul_f32 v25, v69, v25
v_mul_f32 v26, v70, v26
v_mul_f32 v27, v71, v27
v_cvt_pk_bf16_f32 v156, v24, v25
v_cvt_pk_bf16_f32 v157, v26, v27
s_mov_b32 s58, 0x100000
LLs_104:
ds_read_b32 v31, v0 offset:0
s_sub_u32 s58, s58, 1
s_waitcnt lgkmcnt(0)
v_cmp_gt_u32 vcc, 2, v31
s_nop 1
s_and_b32 s33, vcc_lo, 15
s_cbranch_scc0 LBs_105
s_sleep 2
s_cmp_gt_i32 s58, 0
s_cbranch_scc1 LLs_104
LBs_105:
ds_read_b128 v[208:211], v252 offset:0
ds_read_b128 v[212:215], v252 offset:1024
ds_read_b128 v[216:219], v252 offset:2048
ds_read_b128 v[220:223], v252 offset:3072
ds_read_b128 v[224:227], v252 offset:4096
ds_read_b128 v[228:231], v252 offset:5120
ds_read_b128 v[232:235], v252 offset:6144
ds_read_b128 v[236:239], v252 offset:7168
ds_read_b64 v[168:169], v253 offset:0
ds_read_b64 v[170:171], v253 offset:1536
s_waitcnt lgkmcnt(0)
v_mov_b32 v31, 7
s_mov_b64 exec, s[100:101]
ds_write_b32 v0, v31 offset:16
s_mov_b64 exec, -1
s_add_u32 s39, s49, 36864
s_add_u32 m0, s37, 82944
s_nop 0
buffer_load_dwordx4 v14, s[12:15], s39 offen lds
s_add_u32 m0, s37, 87040
s_nop 0
buffer_load_dwordx4 v15, s[12:15], s39 offen lds
s_mov_b32 m0, 91136
s_cmp_lg_u32 s29, 3
s_cbranch_scc1 Ld_106
buffer_load_dwordx4 v16, s[12:15], s39 offen lds
Ld_106:
v_add_f32 v208, v208, v212
v_add_f32 v216, v216, v220
v_add_f32 v209, v209, v213
v_add_f32 v217, v217, v221
v_add_f32 v210, v210, v214
v_add_f32 v218, v218, v222
v_add_f32 v211, v211, v215
v_add_f32 v219, v219, v223
v_add_f32 v208, v208, v216
v_add_f32 v209, v209, v217
v_add_f32 v210, v210, v218
v_add_f32 v211, v211, v219
v_cvt_pk_bf16_f32 v212, v208, v209
v_lshlrev_b32 v214, 16, v168
v_and_b32 v215, 0xffff0000, v168
v_mul_f32 v214, s62, v214
v_mul_f32 v215, s62, v215
v_lshlrev_b32 v208, 16, v212
v_and_b32 v209, 0xffff0000, v212
v_cvt_pk_bf16_f32 v213, v214, v215
v_lshlrev_b32 v214, 16, v213
v_and_b32 v215, 0xffff0000, v213
v_add_f32 v208, v208, v214
v_add_f32 v209, v209, v215
v_cvt_pk_bf16_f32 v172, v208, v209
v_cvt_pk_bf16_f32 v212, v210, v211
v_lshlrev_b32 v214, 16, v169
v_and_b32 v215, 0xffff0000, v169
v_mul_f32 v214, s62, v214
v_mul_f32 v215, s62, v215
v_lshlrev_b32 v210, 16, v212
v_and_b32 v211, 0xffff0000, v212
v_cvt_pk_bf16_f32 v213, v214, v215
v_lshlrev_b32 v214, 16, v213
v_and_b32 v215, 0xffff0000, v213
v_add_f32 v210, v210, v214
v_add_f32 v211, v211, v215
v_cvt_pk_bf16_f32 v173, v210, v211
v_add_f32 v224, v224, v228
v_add_f32 v232, v232, v236
v_add_f32 v225, v225, v229
v_add_f32 v233, v233, v237
v_add_f32 v226, v226, v230
v_add_f32 v234, v234, v238
v_add_f32 v227, v227, v231
v_add_f32 v235, v235, v239
v_add_f32 v224, v224, v232
v_add_f32 v225, v225, v233
v_add_f32 v226, v226, v234
v_add_f32 v227, v227, v235
v_cvt_pk_bf16_f32 v228, v224, v225
v_lshlrev_b32 v230, 16, v170
v_and_b32 v231, 0xffff0000, v170
v_mul_f32 v230, s62, v230
v_mul_f32 v231, s62, v231
v_lshlrev_b32 v224, 16, v228
v_and_b32 v225, 0xffff0000, v228
v_cvt_pk_bf16_f32 v229, v230, v231
v_lshlrev_b32 v230, 16, v229
v_and_b32 v231, 0xffff0000, v229
v_add_f32 v224, v224, v230
v_add_f32 v225, v225, v231
v_cvt_pk_bf16_f32 v174, v224, v225
v_cvt_pk_bf16_f32 v228, v226, v227
v_lshlrev_b32 v230, 16, v171
v_and_b32 v231, 0xffff0000, v171
v_mul_f32 v230, s62, v230
v_mul_f32 v231, s62, v231
v_lshlrev_b32 v226, 16, v228
v_and_b32 v227, 0xffff0000, v228
v_cvt_pk_bf16_f32 v229, v230, v231
v_lshlrev_b32 v230, 16, v229
v_and_b32 v231, 0xffff0000, v229
v_add_f32 v226, v226, v230
v_add_f32 v227, v227, v231
v_cvt_pk_bf16_f32 v175, v226, v227
v_permlane16_swap_b32 v172, v174
s_nop 0
v_permlane16_swap_b32 v173, v175
s_add_u32 s33, s52, 0
s_lshl_b32 s33, s33, 6
s_add_u32 s33, s33, 6815744
buffer_store_dwordx4 v[172:175], v254, s[16:19], s33 offen sc1
s_add_u32 s39, s49, 73728
s_add_u32 m0, s37, 92160
s_nop 0
buffer_load_dwordx4 v14, s[12:15], s39 offen lds
s_add_u32 m0, s37, 96256
s_nop 0
buffer_load_dwordx4 v15, s[12:15], s39 offen lds
s_mov_b32 m0, 100352
s_cmp_lg_u32 s29, 0
s_cbranch_scc1 Ld_107
buffer_load_dwordx4 v16, s[12:15], s39 offen lds
Ld_107:
v_exp_f32 v20, -v72
v_exp_f32 v21, -v73
v_exp_f32 v22, -v74
v_exp_f32 v23, -v75
v_exp_f32 v24, -v76
v_exp_f32 v25, -v77
v_exp_f32 v26, -v78
v_exp_f32 v27, -v79
v_add_f32 v20, 1.0, v20
v_add_f32 v21, 1.0, v21
v_add_f32 v22, 1.0, v22
v_add_f32 v23, 1.0, v23
v_add_f32 v24, 1.0, v24
v_add_f32 v25, 1.0, v25
v_add_f32 v26, 1.0, v26
v_add_f32 v27, 1.0, v27
v_rcp_f32 v20, v20
v_rcp_f32 v21, v21
v_rcp_f32 v22, v22
v_rcp_f32 v23, v23
v_rcp_f32 v24, v24
v_rcp_f32 v25, v25
v_rcp_f32 v26, v26
v_rcp_f32 v27, v27
v_mul_f32 v20, v72, v20
v_mul_f32 v21, v73, v21
v_mul_f32 v22, v74, v22
v_mul_f32 v23, v75, v23
v_cvt_pk_bf16_f32 v154, v20, v21
v_cvt_pk_bf16_f32 v155, v22, v23
v_mul_f32 v24, v76, v24
v_mul_f32 v25, v77, v25
v_mul_f32 v26, v78, v26
v_mul_f32 v27, v79, v27
v_cvt_pk_bf16_f32 v158, v24, v25
v_cvt_pk_bf16_f32 v159, v26, v27
buffer_store_dwordx4 v[152:155], v4, s[16:19], s44 offen offset:0 sc1
buffer_store_dwordx4 v[156:159], v4, s[16:19], s44 offen offset:1024 sc1
v_exp_f32 v20, -v80
v_exp_f32 v21, -v81
v_exp_f32 v22, -v82
v_exp_f32 v23, -v83
v_exp_f32 v24, -v84
v_exp_f32 v25, -v85
v_exp_f32 v26, -v86
v_exp_f32 v27, -v87
v_add_f32 v20, 1.0, v20
v_add_f32 v21, 1.0, v21
v_add_f32 v22, 1.0, v22
v_add_f32 v23, 1.0, v23
v_add_f32 v24, 1.0, v24
v_add_f32 v25, 1.0, v25
v_add_f32 v26, 1.0, v26
v_add_f32 v27, 1.0, v27
v_rcp_f32 v20, v20
v_rcp_f32 v21, v21
v_rcp_f32 v22, v22
v_rcp_f32 v23, v23
v_rcp_f32 v24, v24
v_rcp_f32 v25, v25
v_rcp_f32 v26, v26
v_rcp_f32 v27, v27
v_mul_f32 v20, v80, v20
v_mul_f32 v21, v81, v21
v_mul_f32 v22, v82, v22
v_mul_f32 v23, v83, v23
v_cvt_pk_bf16_f32 v160, v20, v21
v_cvt_pk_bf16_f32 v161, v22, v23
v_mul_f32 v24, v84, v24
v_mul_f32 v25, v85, v25
v_mul_f32 v26, v86, v26
v_mul_f32 v27, v87, v27
v_cvt_pk_bf16_f32 v164, v24, v25
v_cvt_pk_bf16_f32 v165, v26, v27
s_mov_b32 s58, 0x100000
LLs_108:
ds_read_b32 v31, v0 offset:0
s_sub_u32 s58, s58, 1
s_waitcnt lgkmcnt(0)
v_cmp_gt_u32 vcc, 3, v31
s_nop 1
s_and_b32 s33, vcc_lo, 15
s_cbranch_scc0 LBs_109
s_sleep 2
s_cmp_gt_i32 s58, 0
s_cbranch_scc1 LLs_108
LBs_109:
ds_read_b128 v[208:211], v252 offset:0
ds_read_b128 v[212:215], v252 offset:1024
ds_read_b128 v[216:219], v252 offset:2048
ds_read_b128 v[220:223], v252 offset:3072
ds_read_b128 v[224:227], v252 offset:4096
ds_read_b128 v[228:231], v252 offset:5120
ds_read_b128 v[232:235], v252 offset:6144
ds_read_b128 v[236:239], v252 offset:7168
ds_read_b64 v[168:169], v253 offset:16
ds_read_b64 v[170:171], v253 offset:1552
s_waitcnt lgkmcnt(0)
v_mov_b32 v31, 8
s_mov_b64 exec, s[100:101]
ds_write_b32 v0, v31 offset:16
s_mov_b64 exec, -1
s_add_u32 s39, s49, 110592
s_add_u32 m0, s37, 101376
s_nop 0
buffer_load_dwordx4 v14, s[12:15], s39 offen lds
s_add_u32 m0, s37, 105472
s_nop 0
buffer_load_dwordx4 v15, s[12:15], s39 offen lds
s_mov_b32 m0, 109568
s_cmp_lg_u32 s29, 1
s_cbranch_scc1 Ld_110
buffer_load_dwordx4 v16, s[12:15], s39 offen lds
Ld_110:
s_mov_b32 s39, 147456
s_add_u32 m0, s37, 110592
s_nop 0
buffer_load_dwordx4 v17, s[12:15], s39 offen lds
s_add_u32 m0, s37, 114688
s_nop 0
buffer_load_dwordx4 v18, s[12:15], s39 offen lds
s_mov_b32 m0, 118784
s_cmp_lg_u32 s29, 2
s_cbranch_scc1 Ld_111
buffer_load_dwordx4 v19, s[12:15], s39 offen lds
Ld_111:
v_exp_f32 v20, -v88
v_exp_f32 v21, -v89
v_exp_f32 v22, -v90
v_exp_f32 v23, -v91
v_exp_f32 v24, -v92
v_exp_f32 v25, -v93
v_exp_f32 v26, -v94
v_exp_f32 v27, -v95
v_add_f32 v20, 1.0, v20
v_add_f32 v21, 1.0, v21
v_add_f32 v22, 1.0, v22
v_add_f32 v23, 1.0, v23
v_add_f32 v24, 1.0, v24
v_add_f32 v25, 1.0, v25
v_add_f32 v26, 1.0, v26
v_add_f32 v27, 1.0, v27
v_rcp_f32 v20, v20
v_rcp_f32 v21, v21
v_rcp_f32 v22, v22
v_rcp_f32 v23, v23
v_rcp_f32 v24, v24
v_rcp_f32 v25, v25
v_rcp_f32 v26, v26
v_rcp_f32 v27, v27
v_mul_f32 v20, v88, v20
v_mul_f32 v21, v89, v21
v_mul_f32 v22, v90, v22
v_mul_f32 v23, v91, v23
v_cvt_pk_bf16_f32 v162, v20, v21
v_cvt_pk_bf16_f32 v163, v22, v23
v_mul_f32 v24, v92, v24
v_mul_f32 v25, v93, v25
v_mul_f32 v26, v94, v26
v_mul_f32 v27, v95, v27
v_cvt_pk_bf16_f32 v166, v24, v25
v_cvt_pk_bf16_f32 v167, v26, v27
buffer_store_dwordx4 v[160:163], v4, s[16:19], s44 offen offset:2048 sc1
buffer_store_dwordx4 v[164:167], v4, s[16:19], s44 offen offset:3072 sc1
s_mov_b32 s58, 0x100000
LLs_112:
ds_read_b32 v31, v0 offset:0
s_sub_u32 s58, s58, 1
s_waitcnt lgkmcnt(0)
v_cmp_gt_u32 vcc, 4, v31
s_nop 1
s_and_b32 s33, vcc_lo, 15
s_cbranch_scc0 LBs_113
s_sleep 2
s_cmp_gt_i32 s58, 0
s_cbranch_scc1 LLs_112
LBs_113:
s_add_u32 s39, s50, 0
s_add_u32 m0, s37, 119808
s_nop 0
buffer_load_dwordx4 v14, s[12:15], s39 offen lds
s_add_u32 m0, s37, 123904
s_nop 0
buffer_load_dwordx4 v15, s[12:15], s39 offen lds
s_mov_b32 m0, 128000
s_cmp_lg_u32 s29, 3
s_cbranch_scc1 Ld_114
buffer_load_dwordx4 v16, s[12:15], s39 offen lds
Ld_114:
s_add_u32 s39, s50, 36864
s_add_u32 m0, s37, 129024
s_nop 0
buffer_load_dwordx4 v14, s[12:15], s39 offen lds
s_add_u32 m0, s37, 133120
s_nop 0
buffer_load_dwordx4 v15, s[12:15], s39 offen lds
s_mov_b32 m0, 137216
s_cmp_lg_u32 s29, 0
s_cbranch_scc1 Ld_115
buffer_load_dwordx4 v16, s[12:15], s39 offen lds
Ld_115:
s_waitcnt vmcnt(6)
v_mov_b32 v31, 9
s_mov_b64 exec, s[100:101]
ds_write_b32 v0, v31 offset:16
s_mov_b64 exec, -1
s_mov_b32 s58, 0x100000
LLs_116:
ds_read_b32 v31, v0 offset:16
s_sub_u32 s58, s58, 1
s_waitcnt lgkmcnt(0)
v_cmp_gt_u32 vcc, 8, v31
s_nop 1
s_and_b32 s33, vcc_lo, 15
s_cbranch_scc0 LBs_117
s_sleep 2
s_cmp_gt_i32 s58, 0
s_cbranch_scc1 LLs_116
LBs_117:
s_add_u32 s39, s50, 73728
s_add_u32 m0, s37, 0
s_nop 0
buffer_load_dwordx4 v14, s[12:15], s39 offen lds
s_add_u32 m0, s37, 4096
s_nop 0
buffer_load_dwordx4 v15, s[12:15], s39 offen lds
s_mov_b32 m0, 8192
s_cmp_lg_u32 s29, 1
s_cbranch_scc1 Ld_118
buffer_load_dwordx4 v16, s[12:15], s39 offen lds
Ld_118:
s_add_u32 s39, s50, 110592
s_add_u32 m0, s37, 9216
s_nop 0
buffer_load_dwordx4 v14, s[12:15], s39 offen lds
s_add_u32 m0, s37, 13312
s_nop 0
buffer_load_dwordx4 v15, s[12:15], s39 offen lds
s_mov_b32 m0, 17408
s_cmp_lg_u32 s29, 2
s_cbranch_scc1 Ld_119
buffer_load_dwordx4 v16, s[12:15], s39 offen lds
Ld_119:
v_exp_f32 v20, -v96
v_exp_f32 v21, -v97
v_exp_f32 v22, -v98
v_exp_f32 v23, -v99
v_exp_f32 v24, -v100
v_exp_f32 v25, -v101
v_exp_f32 v26, -v102
v_exp_f32 v27, -v103
v_add_f32 v20, 1.0, v20
v_add_f32 v21, 1.0, v21
v_add_f32 v22, 1.0, v22
v_add_f32 v23, 1.0, v23
v_add_f32 v24, 1.0, v24
v_add_f32 v25, 1.0, v25
v_add_f32 v26, 1.0, v26
v_add_f32 v27, 1.0, v27
v_rcp_f32 v20, v20
v_rcp_f32 v21, v21
v_rcp_f32 v22, v22
v_rcp_f32 v23, v23
v_rcp_f32 v24, v24
v_rcp_f32 v25, v25
v_rcp_f32 v26, v26
v_rcp_f32 v27, v27
v_mul_f32 v20, v96, v20
v_mul_f32 v21, v97, v21
v_mul_f32 v22, v98, v22
v_mul_f32 v23, v99, v23
v_cvt_pk_bf16_f32 v200, v20, v21
v_cvt_pk_bf16_f32 v201, v22, v23
v_cvt_pk_bf16_f32 v28, v20, v21
v_cvt_pk_bf16_f32 v29, v22, v23
v_mul_f32 v24, v100, v24
v_mul_f32 v25, v101, v25
v_mul_f32 v26, v102, v26
v_mul_f32 v27, v103, v27
v_cvt_pk_bf16_f32 v204, v24, v25
v_cvt_pk_bf16_f32 v205, v26, v27
v_cvt_pk_bf16_f32 v30, v24, v25
v_cvt_pk_bf16_f32 v31, v26, v27
buffer_store_dwordx4 v[28:31], v5, s[16:19], s44 offen sc1
s_add_u32 s39, s51, 0
s_add_u32 m0, s37, 18432
s_nop 0
buffer_load_dwordx4 v14, s[12:15], s39 offen lds
s_add_u32 m0, s37, 22528
s_nop 0
buffer_load_dwordx4 v15, s[12:15], s39 offen lds
s_mov_b32 m0, 26624
s_cmp_lg_u32 s29, 3
s_cbranch_scc1 Ld_120
buffer_load_dwordx4 v16, s[12:15], s39 offen lds
Ld_120:
s_add_u32 s39, s51, 36864
s_add_u32 m0, s37, 27648
s_nop 0
buffer_load_dwordx4 v14, s[12:15], s39 offen lds
s_add_u32 m0, s37, 31744
s_nop 0
buffer_load_dwordx4 v15, s[12:15], s39 offen lds
s_mov_b32 m0, 35840
s_cmp_lg_u32 s29, 0
s_cbranch_scc1 Ld_121
buffer_load_dwordx4 v16, s[12:15], s39 offen lds
Ld_121:
s_waitcnt vmcnt(7)
v_mov_b32 v31, 10
s_mov_b64 exec, s[100:101]
ds_write_b32 v0, v31 offset:16
s_mov_b64 exec, -1
v_add_f32 v208, v208, v212
v_add_f32 v216, v216, v220
v_add_f32 v209, v209, v213
v_add_f32 v217, v217, v221
v_add_f32 v210, v210, v214
v_add_f32 v218, v218, v222
v_add_f32 v211, v211, v215
v_add_f32 v219, v219, v223
v_add_f32 v208, v208, v216
v_add_f32 v209, v209, v217
v_add_f32 v210, v210, v218
v_add_f32 v211, v211, v219
v_cvt_pk_bf16_f32 v212, v208, v209
v_lshlrev_b32 v214, 16, v168
v_and_b32 v215, 0xffff0000, v168
v_mul_f32 v214, s63, v214
v_mul_f32 v215, s63, v215
v_lshlrev_b32 v208, 16, v212
v_and_b32 v209, 0xffff0000, v212
v_cvt_pk_bf16_f32 v213, v214, v215
v_lshlrev_b32 v214, 16, v213
v_and_b32 v215, 0xffff0000, v213
v_add_f32 v208, v208, v214
v_add_f32 v209, v209, v215
v_cvt_pk_bf16_f32 v172, v208, v209
v_cvt_pk_bf16_f32 v212, v210, v211
v_lshlrev_b32 v214, 16, v169
v_and_b32 v215, 0xffff0000, v169
v_mul_f32 v214, s63, v214
v_mul_f32 v215, s63, v215
v_lshlrev_b32 v210, 16, v212
v_and_b32 v211, 0xffff0000, v212
v_cvt_pk_bf16_f32 v213, v214, v215
v_lshlrev_b32 v214, 16, v213
v_and_b32 v215, 0xffff0000, v213
v_add_f32 v210, v210, v214
v_add_f32 v211, v211, v215
v_cvt_pk_bf16_f32 v173, v210, v211
v_add_f32 v224, v224, v228
v_add_f32 v232, v232, v236
v_add_f32 v225, v225, v229
v_add_f32 v233, v233, v237
v_add_f32 v226, v226, v230
v_add_f32 v234, v234, v238
v_add_f32 v227, v227, v231
v_add_f32 v235, v235, v239
v_add_f32 v224, v224, v232
v_add_f32 v225, v225, v233
v_add_f32 v226, v226, v234
v_add_f32 v227, v227, v235
v_cvt_pk_bf16_f32 v228, v224, v225
v_lshlrev_b32 v230, 16, v170
v_and_b32 v231, 0xffff0000, v170
v_mul_f32 v230, s63, v230
v_mul_f32 v231, s63, v231
v_lshlrev_b32 v224, 16, v228
v_and_b32 v225, 0xffff0000, v228
v_cvt_pk_bf16_f32 v229, v230, v231
v_lshlrev_b32 v230, 16, v229
v_and_b32 v231, 0xffff0000, v229
v_add_f32 v224, v224, v230
v_add_f32 v225, v225, v231
v_cvt_pk_bf16_f32 v174, v224, v225
v_cvt_pk_bf16_f32 v228, v226, v227
v_lshlrev_b32 v230, 16, v171
v_and_b32 v231, 0xffff0000, v171
v_mul_f32 v230, s63, v230
v_mul_f32 v231, s63, v231
v_lshlrev_b32 v226, 16, v228
v_and_b32 v227, 0xffff0000, v228
v_cvt_pk_bf16_f32 v229, v230, v231
v_lshlrev_b32 v230, 16, v229
v_and_b32 v231, 0xffff0000, v229
v_add_f32 v226, v226, v230
v_add_f32 v227, v227, v231
v_cvt_pk_bf16_f32 v175, v226, v227
v_permlane16_swap_b32 v172, v174
s_nop 0
v_permlane16_swap_b32 v173, v175
s_add_u32 s33, s52, 1
s_lshl_b32 s33, s33, 6
s_add_u32 s33, s33, 6815744
buffer_store_dwordx4 v[172:175], v254, s[16:19], s33 offen sc1
v_add_u32 v252, 152064, v3
v_and_b32 v208, 15, v2
v_lshrrev_b32 v210, 4, v2
v_lshrrev_b32 v209, 1, v210
v_lshl_add_u32 v211, v208, 1, v209
v_mul_u32_u24 v211, 48, v211
v_and_b32 v209, 1, v210
v_lshl_add_u32 v211, v209, 3, v211
s_mul_i32 s33, s31, 1536
s_add_u32 s38, s33, 139680
v_add_u32 v253, s38, v211
s_sub_u32 s38, 150432, s33
v_add_u32 v255, s38, v211
s_lshl_b32 s33, s31, 1
s_sub_u32 s33, 7, s33
v_mul_u32_u24 v209, s33, v209
v_add_u32 v209, s31, v209
v_lshl_add_u32 v211, v209, 4, v208
v_and_b32 v209, 1, v211
v_lshrrev_b32 v211, 1, v211
v_mul_u32_u24 v211, 36864, v211
v_lshl_add_u32 v211, v209, 5, v211
v_lshrrev_b32 v210, 1, v210
v_lshl_add_u32 v254, v210, 4, v211
s_andn2_b32 s33, s96, 3
s_add_u32 s33, s33, 12582912
v_add_lshl_u32 v28, s33, v2, 2
s_waitcnt vmcnt(5)
s_lshl_b32 s33, s96, 2
s_add_u32 s33, s33, 50331648
v_mov_b32 v30, 0
v_mov_b32 v31, s68
s_mov_b64 exec, 1
buffer_store_dword v31, v30, s[16:19], s33 offen sc1
s_mov_b64 exec, -1
ds_read_b128 v[208:211], v252 offset:0
ds_read_b128 v[212:215], v252 offset:1024
ds_read_b128 v[216:219], v252 offset:2048
ds_read_b128 v[220:223], v252 offset:3072
ds_read_b128 v[224:227], v252 offset:4096
ds_read_b128 v[228:231], v252 offset:5120
ds_read_b128 v[232:235], v252 offset:6144
ds_read_b128 v[236:239], v252 offset:7168
ds_read_b64 v[168:169], v253 offset:32
ds_read_b64 v[170:171], v255 offset:32
s_waitcnt lgkmcnt(0)
s_cmp_lg_u32 s29, 0
s_cbranch_scc1 Le_122
v_add_f32 v208, v208, v212
v_add_f32 v216, v216, v220
v_add_f32 v209, v209, v213
v_add_f32 v217, v217, v221
v_add_f32 v210, v210, v214
v_add_f32 v218, v218, v222
v_add_f32 v211, v211, v215
v_add_f32 v219, v219, v223
v_add_f32 v208, v208, v216
v_add_f32 v209, v209, v217
v_add_f32 v210, v210, v218
v_add_f32 v211, v211, v219
v_cvt_pk_bf16_f32 v212, v208, v209
v_lshlrev_b32 v214, 16, v168
v_and_b32 v215, 0xffff0000, v168
v_mul_f32 v214, s64, v214
v_mul_f32 v215, s64, v215
v_lshlrev_b32 v208, 16, v212
v_and_b32 v209, 0xffff0000, v212
v_cvt_pk_bf16_f32 v213, v214, v215
v_lshlrev_b32 v214, 16, v213
v_and_b32 v215, 0xffff0000, v213
v_add_f32 v208, v208, v214
v_add_f32 v209, v209, v215
v_cvt_pk_bf16_f32 v172, v208, v209
v_cvt_pk_bf16_f32 v212, v210, v211
v_lshlrev_b32 v214, 16, v169
v_and_b32 v215, 0xffff0000, v169
v_mul_f32 v214, s64, v214
v_mul_f32 v215, s64, v215
v_lshlrev_b32 v210, 16, v212
v_and_b32 v211, 0xffff0000, v212
v_cvt_pk_bf16_f32 v213, v214, v215
v_lshlrev_b32 v214, 16, v213
v_and_b32 v215, 0xffff0000, v213
v_add_f32 v210, v210, v214
v_add_f32 v211, v211, v215
v_cvt_pk_bf16_f32 v173, v210, v211
v_add_f32 v224, v224, v228
v_add_f32 v232, v232, v236
v_add_f32 v225, v225, v229
v_add_f32 v233, v233, v237
v_add_f32 v226, v226, v230
v_add_f32 v234, v234, v238
v_add_f32 v227, v227, v231
v_add_f32 v235, v235, v239
v_add_f32 v224, v224, v232
v_add_f32 v225, v225, v233
v_add_f32 v226, v226, v234
v_add_f32 v227, v227, v235
v_cvt_pk_bf16_f32 v228, v224, v225
v_lshlrev_b32 v230, 16, v170
v_and_b32 v231, 0xffff0000, v170
v_mul_f32 v230, s64, v230
v_mul_f32 v231, s64, v231
v_lshlrev_b32 v224, 16, v228
v_and_b32 v225, 0xffff0000, v228
v_cvt_pk_bf16_f32 v229, v230, v231
v_lshlrev_b32 v230, 16, v229
v_and_b32 v231, 0xffff0000, v229
v_add_f32 v224, v224, v230
v_add_f32 v225, v225, v231
v_cvt_pk_bf16_f32 v174, v224, v225
v_cvt_pk_bf16_f32 v228, v226, v227
v_lshlrev_b32 v230, 16, v171
v_and_b32 v231, 0xffff0000, v171
v_mul_f32 v230, s64, v230
v_mul_f32 v231, s64, v231
v_lshlrev_b32 v226, 16, v228
v_and_b32 v227, 0xffff0000, v228
v_cvt_pk_bf16_f32 v229, v230, v231
v_lshlrev_b32 v230, 16, v229
v_and_b32 v231, 0xffff0000, v229
v_add_f32 v226, v226, v230
v_add_f32 v227, v227, v231
v_cvt_pk_bf16_f32 v175, v226, v227
v_permlane16_swap_b32 v172, v174
s_nop 0
v_permlane16_swap_b32 v173, v175
s_mov_b32 s33, s53
s_lshl_b32 s33, s33, 6
s_add_u32 s33, s33, 6815744
buffer_store_dwordx4 v[172:175], v254, s[16:19], s33 offen sc1
Le_122:
s_lshl_b32 s69, s32, 4
s_add_u32 s69, s69, s30
s_add_u32 s69, s69, 8
s_lshl_b32 s33, s69, 4
v_and_b32 v20, 15, v2
v_add_u32 v20, s33, v20
v_mul_u32_u24 v20, 1152, v20
v_lshrrev_b32 v21, 4, v2
v_lshl_add_u32 v20, v21, 3, v20
s_mul_i32 s33, s31, 288
v_add_u32 v20, s33, v20
s_lshl_b32 s61, s29, 6
buffer_load_dwordx2 v[22:23], v20, s[20:23], s61 offen
buffer_load_dwordx2 v[24:25], v20, s[20:23], s61 offen offset:32
buffer_load_dwordx2 v[26:27], v20, s[20:23], 0 offen offset:256
ds_read_b64_tr_b16 v[112:113], v8 offset:36864
ds_read_b64_tr_b16 v[114:115], v8 offset:41472
ds_read_b64_tr_b16 v[116:117], v8 offset:36896
ds_read_b64_tr_b16 v[118:119], v8 offset:41504
ds_read_b64_tr_b16 v[120:121], v8 offset:36928
ds_read_b64_tr_b16 v[122:123], v8 offset:41536
ds_read_b64_tr_b16 v[124:125], v8 offset:36960
ds_read_b64_tr_b16 v[126:127], v8 offset:41568
s_barrier
s_mov_b64 exec, 0xf
buffer_load_dword v29, v28, s[16:19], 0 offen sc1
s_mov_b64 exec, -1
s_waitcnt lgkmcnt(4)
v_mfma_f32_16x16x32_bf16 v[32:35], v[112:115], v[136:139], 0
ds_read_b64_tr_b16 v[128:129], v8 offset:36992
v_mfma_f32_16x16x32_bf16 v[36:39], v[112:115], v[140:143], 0
ds_read_b64_tr_b16 v[130:131], v8 offset:41600
v_mfma_f32_16x16x32_bf16 v[44:47], v[116:119], v[140:143], 0
ds_read_b64_tr_b16 v[132:133], v8 offset:37024
v_mfma_f32_16x16x32_bf16 v[40:43], v[116:119], v[136:139], 0
ds_read_b64_tr_b16 v[134:135], v8 offset:41632
s_waitcnt lgkmcnt(4)
v_mfma_f32_16x16x32_bf16 v[48:51], v[120:123], v[136:139], 0
ds_read_b64_tr_b16 v[104:105], v8 offset:37056
v_mfma_f32_16x16x32_bf16 v[52:55], v[120:123], v[140:143], 0
ds_read_b64_tr_b16 v[106:107], v8 offset:41664
v_mfma_f32_16x16x32_bf16 v[60:63], v[124:127], v[140:143], 0
ds_read_b64_tr_b16 v[108:109], v8 offset:37088
v_mfma_f32_16x16x32_bf16 v[56:59], v[124:127], v[136:139], 0
ds_read_b64_tr_b16 v[110:111], v8 offset:41696
s_waitcnt lgkmcnt(4)
v_mfma_f32_16x16x32_bf16 v[64:67], v[128:131], v[136:139], 0
ds_read_b64_tr_b16 v[112:113], v8 offset:37120
v_mfma_f32_16x16x32_bf16 v[68:71], v[128:131], v[140:143], 0
ds_read_b64_tr_b16 v[114:115], v8 offset:41728
v_mfma_f32_16x16x32_bf16 v[76:79], v[132:135], v[140:143], 0
ds_read_b64_tr_b16 v[116:117], v8 offset:46080
v_mfma_f32_16x16x32_bf16 v[72:75], v[132:135], v[136:139], 0
ds_read_b64_tr_b16 v[118:119], v8 offset:50688
s_waitcnt lgkmcnt(4)
v_mfma_f32_16x16x32_bf16 v[80:83], v[104:107], v[136:139], 0
ds_read_b64_tr_b16 v[120:121], v8 offset:46112
v_mfma_f32_16x16x32_bf16 v[84:87], v[104:107], v[140:143], 0
ds_read_b64_tr_b16 v[122:123], v8 offset:50720
v_mfma_f32_16x16x32_bf16 v[92:95], v[108:111], v[140:143], 0
ds_read_b64_tr_b16 v[124:125], v8 offset:46144
v_mfma_f32_16x16x32_bf16 v[88:91], v[108:111], v[136:139], 0
ds_read_b64_tr_b16 v[126:127], v8 offset:50752
s_waitcnt lgkmcnt(4)
v_mfma_f32_16x16x32_bf16 v[96:99], v[112:115], v[136:139], 0
ds_read_b64_tr_b16 v[128:129], v8 offset:46176
v_mfma_f32_16x16x32_bf16 v[100:103], v[112:115], v[140:143], 0
ds_read_b64_tr_b16 v[130:131], v8 offset:50784
s_waitcnt vmcnt(6)
s_barrier
s_waitcnt vmcnt(0)
s_mov_b64 exec, 0xf
s_mov_b32 s58, 0x8000
LLp_123:
v_cmp_ne_u32 vcc, s68, v29
s_nop 4
s_cbranch_vccz LBq_124
buffer_load_dword v29, v28, s[16:19], 0 offen sc1
s_sub_u32 s58, s58, 1
s_waitcnt vmcnt(0)
s_cmp_gt_i32 s58, 0
s_cbranch_scc1 LLp_123
LBq_124:
s_mov_b64 exec, -1
v_mfma_f32_16x16x32_bf16 v[36:39], v[116:119], v[148:151], v[36:39]
ds_read_b64_tr_b16 v[132:133], v8 offset:46208
buffer_load_dwordx4 v[168:171], v3, s[16:19], s45 offen offset:0 sc1
v_mfma_f32_16x16x32_bf16 v[32:35], v[116:119], v[144:147], v[32:35]
ds_read_b64_tr_b16 v[134:135], v8 offset:50816
s_waitcnt lgkmcnt(4)
v_mfma_f32_16x16x32_bf16 v[40:43], v[120:123], v[144:147], v[40:43]
ds_read_b64_tr_b16 v[104:105], v8 offset:46240
buffer_load_dwordx4 v[172:175], v3, s[16:19], s45 offen offset:1024 sc1
v_mfma_f32_16x16x32_bf16 v[44:47], v[120:123], v[148:151], v[44:47]
ds_read_b64_tr_b16 v[106:107], v8 offset:50848
buffer_load_dwordx4 v[176:179], v3, s[16:19], s45 offen offset:2048 sc1
v_mfma_f32_16x16x32_bf16 v[52:55], v[124:127], v[148:151], v[52:55]
ds_read_b64_tr_b16 v[108:109], v8 offset:46272
buffer_load_dwordx4 v[180:183], v3, s[16:19], s45 offen offset:3072 sc1
v_mfma_f32_16x16x32_bf16 v[48:51], v[124:127], v[144:147], v[48:51]
ds_read_b64_tr_b16 v[110:111], v8 offset:50880
s_waitcnt lgkmcnt(4)
v_mfma_f32_16x16x32_bf16 v[56:59], v[128:131], v[144:147], v[56:59]
ds_read_b64_tr_b16 v[112:113], v8 offset:46304
v_mfma_f32_16x16x32_bf16 v[60:63], v[128:131], v[148:151], v[60:63]
ds_read_b64_tr_b16 v[114:115], v8 offset:50912
v_mfma_f32_16x16x32_bf16 v[68:71], v[132:135], v[148:151], v[68:71]
ds_read_b64_tr_b16 v[116:117], v8 offset:46336
v_mfma_f32_16x16x32_bf16 v[64:67], v[132:135], v[144:147], v[64:67]
ds_read_b64_tr_b16 v[118:119], v8 offset:50944
s_waitcnt lgkmcnt(4)
v_mfma_f32_16x16x32_bf16 v[72:75], v[104:107], v[144:147], v[72:75]
ds_read_b64_tr_b16 v[120:121], v9 offset:0
v_mfma_f32_16x16x32_bf16 v[76:79], v[104:107], v[148:151], v[76:79]
ds_read_b64_tr_b16 v[122:123], v9 offset:4608
v_mfma_f32_16x16x32_bf16 v[84:87], v[108:111], v[148:151], v[84:87]
ds_read_b64_tr_b16 v[124:125], v9 offset:32
v_mfma_f32_16x16x32_bf16 v[80:83], v[108:111], v[144:147], v[80:83]
ds_read_b64_tr_b16 v[126:127], v9 offset:4640
s_waitcnt lgkmcnt(4)
v_mfma_f32_16x16x32_bf16 v[88:91], v[112:115], v[144:147], v[88:91]
ds_read_b64_tr_b16 v[128:129], v9 offset:64
v_mfma_f32_16x16x32_bf16 v[92:95], v[112:115], v[148:151], v[92:95]
ds_read_b64_tr_b16 v[130:131], v9 offset:4672
v_mfma_f32_16x16x32_bf16 v[100:103], v[116:119], v[148:151], v[100:103]
ds_read_b64_tr_b16 v[132:133], v9 offset:96
v_mfma_f32_16x16x32_bf16 v[96:99], v[116:119], v[144:147], v[96:99]
ds_read_b64_tr_b16 v[134:135], v9 offset:4704
s_barrier
s_waitcnt lgkmcnt(4)
v_mfma_f32_16x16x32_bf16 v[32:35], v[120:123], v[152:155], v[32:35]
ds_read_b64_tr_b16 v[104:105], v9 offset:128
s_cmp_lg_u32 s29, 0
s_cbranch_scc1 Lz_125
s_lshl_b32 s33, s98, 2
s_add_u32 s33, s33, 50855936
v_mov_b32 v30, 0
v_mov_b32 v31, s68
s_mov_b64 exec, 1
buffer_store_dword v31, v30, s[16:19], s33 offen sc1
s_mov_b64 exec, -1
Lz_125:
v_mfma_f32_16x16x32_bf16 v[36:39], v[120:123], v[156:159], v[36:39]
ds_read_b64_tr_b16 v[106:107], v9 offset:4736
buffer_load_dwordx4 v[184:187], v4, s[16:19], s45 offen offset:0 sc1
v_mfma_f32_16x16x32_bf16 v[44:47], v[124:127], v[156:159], v[44:47]
ds_read_b64_tr_b16 v[108:109], v9 offset:160
buffer_load_dwordx4 v[188:191], v4, s[16:19], s45 offen offset:1024 sc1
v_mfma_f32_16x16x32_bf16 v[40:43], v[124:127], v[152:155], v[40:43]
ds_read_b64_tr_b16 v[110:111], v9 offset:4768
s_waitcnt lgkmcnt(4)
v_mfma_f32_16x16x32_bf16 v[48:51], v[128:131], v[152:155], v[48:51]
ds_read_b64_tr_b16 v[112:113], v9 offset:192
buffer_load_dwordx4 v[192:195], v4, s[16:19], s45 offen offset:2048 sc1
v_mfma_f32_16x16x32_bf16 v[52:55], v[128:131], v[156:159], v[52:55]
ds_read_b64_tr_b16 v[114:115], v9 offset:4800
buffer_load_dwordx4 v[196:199], v4, s[16:19], s45 offen offset:3072 sc1
v_mfma_f32_16x16x32_bf16 v[60:63], v[132:135], v[156:159], v[60:63]
ds_read_b64_tr_b16 v[116:117], v9 offset:224
buffer_load_dwordx2 v[202:203], v5, s[16:19], s45 offen offset:0 sc1
v_mfma_f32_16x16x32_bf16 v[56:59], v[132:135], v[152:155], v[56:59]
ds_read_b64_tr_b16 v[118:119], v9 offset:4832
s_waitcnt lgkmcnt(4)
v_mfma_f32_16x16x32_bf16 v[64:67], v[104:107], v[152:155], v[64:67]
ds_read_b64_tr_b16 v[120:121], v9 offset:256
buffer_load_dwordx2 v[206:207], v5, s[16:19], s45 offen offset:8 sc1
v_mfma_f32_16x16x32_bf16 v[68:71], v[104:107], v[156:159], v[68:71]
ds_read_b64_tr_b16 v[122:123], v9 offset:4864
v_mfma_f32_16x16x32_bf16 v[76:79], v[108:111], v[156:159], v[76:79]
ds_read_b64_tr_b16 v[124:125], v9 offset:9216
v_mfma_f32_16x16x32_bf16 v[72:75], v[108:111], v[152:155], v[72:75]
ds_read_b64_tr_b16 v[126:127], v9 offset:13824
s_waitcnt lgkmcnt(4)
v_mfma_f32_16x16x32_bf16 v[80:83], v[112:115], v[152:155], v[80:83]
ds_read_b64_tr_b16 v[128:129], v9 offset:9248
v_mfma_f32_16x16x32_bf16 v[84:87], v[112:115], v[156:159], v[84:87]
ds_read_b64_tr_b16 v[130:131], v9 offset:13856
v_mfma_f32_16x16x32_bf16 v[92:95], v[116:119], v[156:159], v[92:95]
ds_read_b64_tr_b16 v[132:133], v9 offset:9280
v_mfma_f32_16x16x32_bf16 v[88:91], v[116:119], v[152:155], v[88:91]
ds_read_b64_tr_b16 v[134:135], v9 offset:13888
s_waitcnt lgkmcnt(4)
v_mfma_f32_16x16x32_bf16 v[96:99], v[120:123], v[152:155], v[96:99]
ds_read_b64_tr_b16 v[104:105], v9 offset:9312
v_mfma_f32_16x16x32_bf16 v[100:103], v[120:123], v[156:159], v[100:103]
ds_read_b64_tr_b16 v[106:107], v9 offset:13920
s_barrier
v_mfma_f32_16x16x32_bf16 v[36:39], v[124:127], v[164:167], v[36:39]
ds_read_b64_tr_b16 v[108:109], v9 offset:9344
buffer_load_dwordx4 v[208:211], v3, s[16:19], s46 offen offset:0 sc1
v_mfma_f32_16x16x32_bf16 v[32:35], v[124:127], v[160:163], v[32:35]
ds_read_b64_tr_b16 v[110:111], v9 offset:13952
s_waitcnt lgkmcnt(4)
v_mfma_f32_16x16x32_bf16 v[40:43], v[128:131], v[160:163], v[40:43]
ds_read_b64_tr_b16 v[112:113], v9 offset:9376
buffer_load_dwordx4 v[212:215], v3, s[16:19], s46 offen offset:1024 sc1
v_mfma_f32_16x16x32_bf16 v[44:47], v[128:131], v[164:167], v[44:47]
ds_read_b64_tr_b16 v[114:115], v9 offset:13984
buffer_load_dwordx4 v[216:219], v3, s[16:19], s46 offen offset:2048 sc1
v_mfma_f32_16x16x32_bf16 v[52:55], v[132:135], v[164:167], v[52:55]
ds_read_b64_tr_b16 v[116:117], v9 offset:9408
buffer_load_dwordx4 v[220:223], v3, s[16:19], s46 offen offset:3072 sc1
v_mfma_f32_16x16x32_bf16 v[48:51], v[132:135], v[160:163], v[48:51]
ds_read_b64_tr_b16 v[118:119], v9 offset:14016
s_waitcnt lgkmcnt(4)
v_mfma_f32_16x16x32_bf16 v[56:59], v[104:107], v[160:163], v[56:59]
ds_read_b64_tr_b16 v[120:121], v9 offset:9440
buffer_load_dwordx4 v[224:227], v4, s[16:19], s46 offen offset:0 sc1
v_mfma_f32_16x16x32_bf16 v[60:63], v[104:107], v[164:167], v[60:63]
ds_read_b64_tr_b16 v[122:123], v9 offset:14048
buffer_load_dwordx4 v[228:231], v4, s[16:19], s46 offen offset:1024 sc1
v_mfma_f32_16x16x32_bf16 v[68:71], v[108:111], v[164:167], v[68:71]
ds_read_b64_tr_b16 v[124:125], v9 offset:9472
v_mfma_f32_16x16x32_bf16 v[64:67], v[108:111], v[160:163], v[64:67]
ds_read_b64_tr_b16 v[126:127], v9 offset:14080
s_waitcnt lgkmcnt(4)
v_mfma_f32_16x16x32_bf16 v[72:75], v[112:115], v[160:163], v[72:75]
ds_read_b64_tr_b16 v[128:129], v9 offset:18432
v_mfma_f32_16x16x32_bf16 v[76:79], v[112:115], v[164:167], v[76:79]
ds_read_b64_tr_b16 v[130:131], v9 offset:23040
v_mfma_f32_16x16x32_bf16 v[84:87], v[116:119], v[164:167], v[84:87]
ds_read_b64_tr_b16 v[132:133], v9 offset:18464
v_mfma_f32_16x16x32_bf16 v[80:83], v[116:119], v[160:163], v[80:83]
ds_read_b64_tr_b16 v[134:135], v9 offset:23072
s_waitcnt lgkmcnt(4)
v_mfma_f32_16x16x32_bf16 v[88:91], v[120:123], v[160:163], v[88:91]
ds_read_b64_tr_b16 v[104:105], v9 offset:18496
v_mfma_f32_16x16x32_bf16 v[92:95], v[120:123], v[164:167], v[92:95]
ds_read_b64_tr_b16 v[106:107], v9 offset:23104
v_mfma_f32_16x16x32_bf16 v[100:103], v[124:127], v[164:167], v[100:103]
ds_read_b64_tr_b16 v[108:109], v9 offset:18528
v_mfma_f32_16x16x32_bf16 v[96:99], v[124:127], v[160:163], v[96:99]
ds_read_b64_tr_b16 v[110:111], v9 offset:23136
s_barrier
s_waitcnt vmcnt(14)
s_waitcnt lgkmcnt(4)
v_mfma_f32_16x16x32_bf16 v[32:35], v[128:131], v[168:171], v[32:35]
ds_read_b64_tr_b16 v[112:113], v9 offset:18560
buffer_load_dwordx4 v[232:235], v4, s[16:19], s46 offen offset:2048 sc1
v_mfma_f32_16x16x32_bf16 v[36:39], v[128:131], v[172:175], v[36:39]
ds_read_b64_tr_b16 v[114:115], v9 offset:23168
buffer_load_dwordx4 v[236:239], v4, s[16:19], s46 offen offset:3072 sc1
v_mfma_f32_16x16x32_bf16 v[44:47], v[132:135], v[172:175], v[44:47]
ds_read_b64_tr_b16 v[116:117], v9 offset:18592
buffer_load_dwordx4 v[240:243], v3, s[16:19], s47 offen offset:0 sc1
v_mfma_f32_16x16x32_bf16 v[40:43], v[132:135], v[168:171], v[40:43]
ds_read_b64_tr_b16 v[118:119], v9 offset:23200
s_waitcnt lgkmcnt(4)
v_mfma_f32_16x16x32_bf16 v[48:51], v[104:107], v[168:171], v[48:51]
ds_read_b64_tr_b16 v[120:121], v9 offset:18624
buffer_load_dwordx4 v[244:247], v3, s[16:19], s47 offen offset:1024 sc1
v_mfma_f32_16x16x32_bf16 v[52:55], v[104:107], v[172:175], v[52:55]
ds_read_b64_tr_b16 v[122:123], v9 offset:23232
buffer_load_dwordx4 v[248:251], v3, s[16:19], s47 offen offset:2048 sc1
v_mfma_f32_16x16x32_bf16 v[60:63], v[108:111], v[172:175], v[60:63]
ds_read_b64_tr_b16 v[124:125], v9 offset:18656
buffer_load_dwordx4 v[252:255], v3, s[16:19], s47 offen offset:3072 sc1
v_mfma_f32_16x16x32_bf16 v[56:59], v[108:111], v[168:171], v[56:59]
ds_read_b64_tr_b16 v[126:127], v9 offset:23264
s_waitcnt lgkmcnt(4)
v_mfma_f32_16x16x32_bf16 v[64:67], v[112:115], v[168:171], v[64:67]
ds_read_b64_tr_b16 v[128:129], v9 offset:18688
v_mfma_f32_16x16x32_bf16 v[68:71], v[112:115], v[172:175], v[68:71]
ds_read_b64_tr_b16 v[130:131], v9 offset:23296
v_mfma_f32_16x16x32_bf16 v[76:79], v[116:119], v[172:175], v[76:79]
ds_read_b64_tr_b16 v[132:133], v9 offset:27648
v_mfma_f32_16x16x32_bf16 v[72:75], v[116:119], v[168:171], v[72:75]
ds_read_b64_tr_b16 v[134:135], v9 offset:32256
s_waitcnt lgkmcnt(4)
v_mfma_f32_16x16x32_bf16 v[80:83], v[120:123], v[168:171], v[80:83]
ds_read_b64_tr_b16 v[104:105], v9 offset:27680
v_mfma_f32_16x16x32_bf16 v[84:87], v[120:123], v[172:175], v[84:87]
ds_read_b64_tr_b16 v[106:107], v9 offset:32288
v_mfma_f32_16x16x32_bf16 v[92:95], v[124:127], v[172:175], v[92:95]
ds_read_b64_tr_b16 v[108:109], v9 offset:27712
v_mfma_f32_16x16x32_bf16 v[88:91], v[124:127], v[168:171], v[88:91]
ds_read_b64_tr_b16 v[110:111], v9 offset:32320
s_waitcnt lgkmcnt(4)
v_mfma_f32_16x16x32_bf16 v[96:99], v[128:131], v[168:171], v[96:99]
ds_read_b64_tr_b16 v[112:113], v9 offset:27744
v_mfma_f32_16x16x32_bf16 v[100:103], v[128:131], v[172:175], v[100:103]
ds_read_b64_tr_b16 v[114:115], v9 offset:32352
s_barrier
s_waitcnt vmcnt(18)
v_mfma_f32_16x16x32_bf16 v[36:39], v[132:135], v[180:183], v[36:39]
ds_read_b64_tr_b16 v[116:117], v9 offset:27776
v_mfma_f32_16x16x32_bf16 v[32:35], v[132:135], v[176:179], v[32:35]
ds_read_b64_tr_b16 v[118:119], v9 offset:32384
s_waitcnt lgkmcnt(4)
v_mfma_f32_16x16x32_bf16 v[40:43], v[104:107], v[176:179], v[40:43]
ds_read_b64_tr_b16 v[120:121], v9 offset:27808
v_mfma_f32_16x16x32_bf16 v[44:47], v[104:107], v[180:183], v[44:47]
ds_read_b64_tr_b16 v[122:123], v9 offset:32416
v_mfma_f32_16x16x32_bf16 v[52:55], v[108:111], v[180:183], v[52:55]
ds_read_b64_tr_b16 v[124:125], v9 offset:27840
v_mfma_f32_16x16x32_bf16 v[48:51], v[108:111], v[176:179], v[48:51]
ds_read_b64_tr_b16 v[126:127], v9 offset:32448
s_waitcnt lgkmcnt(4)
v_mfma_f32_16x16x32_bf16 v[56:59], v[112:115], v[176:179], v[56:59]
ds_read_b64_tr_b16 v[128:129], v9 offset:27872
v_mfma_f32_16x16x32_bf16 v[60:63], v[112:115], v[180:183], v[60:63]
ds_read_b64_tr_b16 v[130:131], v9 offset:32480
v_mfma_f32_16x16x32_bf16 v[68:71], v[116:119], v[180:183], v[68:71]
ds_read_b64_tr_b16 v[132:133], v9 offset:27904
v_mfma_f32_16x16x32_bf16 v[64:67], v[116:119], v[176:179], v[64:67]
ds_read_b64_tr_b16 v[134:135], v9 offset:32512
s_waitcnt lgkmcnt(4)
v_mfma_f32_16x16x32_bf16 v[72:75], v[120:123], v[176:179], v[72:75]
ds_read_b64_tr_b16 v[104:105], v9 offset:36864
v_mfma_f32_16x16x32_bf16 v[76:79], v[120:123], v[180:183], v[76:79]
ds_read_b64_tr_b16 v[106:107], v9 offset:41472
v_mfma_f32_16x16x32_bf16 v[84:87], v[124:127], v[180:183], v[84:87]
ds_read_b64_tr_b16 v[108:109], v9 offset:36896
v_mfma_f32_16x16x32_bf16 v[80:83], v[124:127], v[176:179], v[80:83]
ds_read_b64_tr_b16 v[110:111], v9 offset:41504
s_waitcnt lgkmcnt(4)
v_mfma_f32_16x16x32_bf16 v[88:91], v[128:131], v[176:179], v[88:91]
ds_read_b64_tr_b16 v[112:113], v9 offset:36928
v_mfma_f32_16x16x32_bf16 v[92:95], v[128:131], v[180:183], v[92:95]
ds_read_b64_tr_b16 v[114:115], v9 offset:41536
v_mfma_f32_16x16x32_bf16 v[100:103], v[132:135], v[180:183], v[100:103]
ds_read_b64_tr_b16 v[116:117], v9 offset:36960
v_mfma_f32_16x16x32_bf16 v[96:99], v[132:135], v[176:179], v[96:99]
ds_read_b64_tr_b16 v[118:119], v9 offset:41568
s_barrier
s_waitcnt vmcnt(16)
s_waitcnt lgkmcnt(4)
v_mfma_f32_16x16x32_bf16 v[32:35], v[104:107], v[184:187], v[32:35]
ds_read_b64_tr_b16 v[120:121], v9 offset:36992
buffer_load_dwordx4 v[136:139], v4, s[16:19], s47 offen offset:0 sc1
v_mfma_f32_16x16x32_bf16 v[36:39], v[104:107], v[188:191], v[36:39]
ds_read_b64_tr_b16 v[122:123], v9 offset:41600
buffer_load_dwordx4 v[140:143], v4, s[16:19], s47 offen offset:1024 sc1
v_mfma_f32_16x16x32_bf16 v[44:47], v[108:111], v[188:191], v[44:47]
ds_read_b64_tr_b16 v[124:125], v9 offset:37024
v_mfma_f32_16x16x32_bf16 v[40:43], v[108:111], v[184:187], v[40:43]
ds_read_b64_tr_b16 v[126:127], v9 offset:41632
s_waitcnt lgkmcnt(4)
v_mfma_f32_16x16x32_bf16 v[48:51], v[112:115], v[184:187], v[48:51]
ds_read_b64_tr_b16 v[128:129], v9 offset:37056
v_mfma_f32_16x16x32_bf16 v[52:55], v[112:115], v[188:191], v[52:55]
ds_read_b64_tr_b16 v[130:131], v9 offset:41664
v_mfma_f32_16x16x32_bf16 v[60:63], v[116:119], v[188:191], v[60:63]
ds_read_b64_tr_b16 v[132:133], v9 offset:37088
v_mfma_f32_16x16x32_bf16 v[56:59], v[116:119], v[184:187], v[56:59]
ds_read_b64_tr_b16 v[134:135], v9 offset:41696
s_waitcnt lgkmcnt(4)
v_mfma_f32_16x16x32_bf16 v[64:67], v[120:123], v[184:187], v[64:67]
ds_read_b64_tr_b16 v[104:105], v9 offset:37120
v_mfma_f32_16x16x32_bf16 v[68:71], v[120:123], v[188:191], v[68:71]
ds_read_b64_tr_b16 v[106:107], v9 offset:41728
v_mfma_f32_16x16x32_bf16 v[76:79], v[124:127], v[188:191], v[76:79]
ds_read_b64_tr_b16 v[108:109], v9 offset:46080
v_mfma_f32_16x16x32_bf16 v[72:75], v[124:127], v[184:187], v[72:75]
ds_read_b64_tr_b16 v[110:111], v9 offset:50688
s_waitcnt lgkmcnt(4)
v_mfma_f32_16x16x32_bf16 v[80:83], v[128:131], v[184:187], v[80:83]
ds_read_b64_tr_b16 v[112:113], v9 offset:46112
v_mfma_f32_16x16x32_bf16 v[84:87], v[128:131], v[188:191], v[84:87]
ds_read_b64_tr_b16 v[114:115], v9 offset:50720
v_mfma_f32_16x16x32_bf16 v[92:95], v[132:135], v[188:191], v[92:95]
ds_read_b64_tr_b16 v[116:117], v9 offset:46144
v_mfma_f32_16x16x32_bf16 v[88:91], v[132:135], v[184:187], v[88:91]
ds_read_b64_tr_b16 v[118:119], v9 offset:50752
s_waitcnt lgkmcnt(4)
v_mfma_f32_16x16x32_bf16 v[96:99], v[104:107], v[184:187], v[96:99]
ds_read_b64_tr_b16 v[120:121], v9 offset:46176
v_mfma_f32_16x16x32_bf16 v[100:103], v[104:107], v[188:191], v[100:103]
ds_read_b64_tr_b16 v[122:123], v9 offset:50784
s_waitcnt vmcnt(16)
v_mfma_f32_16x16x32_bf16 v[36:39], v[108:111], v[196:199], v[36:39]
ds_read_b64_tr_b16 v[124:125], v9 offset:46208
buffer_load_dwordx4 v[144:147], v4, s[16:19], s47 offen offset:2048 sc1
v_mfma_f32_16x16x32_bf16 v[32:35], v[108:111], v[192:195], v[32:35]
ds_read_b64_tr_b16 v[126:127], v9 offset:50816
s_waitcnt lgkmcnt(4)
v_mfma_f32_16x16x32_bf16 v[40:43], v[112:115], v[192:195], v[40:43]
ds_read_b64_tr_b16 v[128:129], v9 offset:46240
buffer_load_dwordx4 v[148:151], v4, s[16:19], s47 offen offset:3072 sc1
v_mfma_f32_16x16x32_bf16 v[44:47], v[112:115], v[196:199], v[44:47]
ds_read_b64_tr_b16 v[130:131], v9 offset:50848
v_mfma_f32_16x16x32_bf16 v[52:55], v[116:119], v[196:199], v[52:55]
ds_read_b64_tr_b16 v[132:133], v9 offset:46272
v_mfma_f32_16x16x32_bf16 v[48:51], v[116:119], v[192:195], v[48:51]
ds_read_b64_tr_b16 v[134:135], v9 offset:50880
s_waitcnt lgkmcnt(4)
v_mfma_f32_16x16x32_bf16 v[56:59], v[120:123], v[192:195], v[56:59]
ds_read_b64_tr_b16 v[104:105], v9 offset:46304
v_mfma_f32_16x16x32_bf16 v[60:63], v[120:123], v[196:199], v[60:63]
ds_read_b64_tr_b16 v[106:107], v9 offset:50912
v_mfma_f32_16x16x32_bf16 v[68:71], v[124:127], v[196:199], v[68:71]
ds_read_b64_tr_b16 v[108:109], v9 offset:46336
v_mfma_f32_16x16x32_bf16 v[64:67], v[124:127], v[192:195], v[64:67]
ds_read_b64_tr_b16 v[110:111], v9 offset:50944
s_waitcnt lgkmcnt(4)
v_mfma_f32_16x16x32_bf16 v[72:75], v[128:131], v[192:195], v[72:75]
ds_read_b64_tr_b16 v[112:113], v10 offset:0
v_mfma_f32_16x16x32_bf16 v[76:79], v[128:131], v[196:199], v[76:79]
ds_read_b64_tr_b16 v[114:115], v10 offset:4608
v_mfma_f32_16x16x32_bf16 v[84:87], v[132:135], v[196:199], v[84:87]
ds_read_b64_tr_b16 v[116:117], v10 offset:32
v_mfma_f32_16x16x32_bf16 v[80:83], v[132:135], v[192:195], v[80:83]
ds_read_b64_tr_b16 v[118:119], v10 offset:4640
s_waitcnt lgkmcnt(4)
v_mfma_f32_16x16x32_bf16 v[88:91], v[104:107], v[192:195], v[88:91]
ds_read_b64_tr_b16 v[120:121], v10 offset:64
v_mfma_f32_16x16x32_bf16 v[92:95], v[104:107], v[196:199], v[92:95]
ds_read_b64_tr_b16 v[122:123], v10 offset:4672
v_mfma_f32_16x16x32_bf16 v[100:103], v[108:111], v[196:199], v[100:103]
ds_read_b64_tr_b16 v[124:125], v10 offset:96
v_mfma_f32_16x16x32_bf16 v[96:99], v[108:111], v[192:195], v[96:99]
ds_read_b64_tr_b16 v[126:127], v10 offset:4704
s_waitcnt vmcnt(16)
s_waitcnt lgkmcnt(4)
v_mfma_f32_16x16x32_bf16 v[32:35], v[112:115], v[200:203], v[32:35]
ds_read_b64_tr_b16 v[128:129], v10 offset:128
buffer_load_dwordx2 v[152:153], v5, s[16:19], s46 offen offset:0 sc1
v_mfma_f32_16x16x32_bf16 v[36:39], v[112:115], v[204:207], v[36:39]
ds_read_b64_tr_b16 v[130:131], v10 offset:4736
buffer_load_dwordx2 v[154:155], v5, s[16:19], s47 offen offset:0 sc1
v_mfma_f32_16x16x32_bf16 v[44:47], v[116:119], v[204:207], v[44:47]
ds_read_b64_tr_b16 v[132:133], v10 offset:160
buffer_load_dwordx2 v[156:157], v5, s[16:19], s46 offen offset:8 sc1
v_mfma_f32_16x16x32_bf16 v[40:43], v[116:119], v[200:203], v[40:43]
ds_read_b64_tr_b16 v[134:135], v10 offset:4768
s_waitcnt lgkmcnt(4)
v_mfma_f32_16x16x32_bf16 v[48:51], v[120:123], v[200:203], v[48:51]
ds_read_b64_tr_b16 v[104:105], v10 offset:192
buffer_load_dwordx2 v[158:159], v5, s[16:19], s47 offen offset:8 sc1
v_mfma_f32_16x16x32_bf16 v[52:55], v[120:123], v[204:207], v[52:55]
ds_read_b64_tr_b16 v[106:107], v10 offset:4800
v_mfma_f32_16x16x32_bf16 v[60:63], v[124:127], v[204:207], v[60:63]
ds_read_b64_tr_b16 v[108:109], v10 offset:224
v_mfma_f32_16x16x32_bf16 v[56:59], v[124:127], v[200:203], v[56:59]
ds_read_b64_tr_b16 v[110:111], v10 offset:4832
s_waitcnt lgkmcnt(4)
v_mfma_f32_16x16x32_bf16 v[64:67], v[128:131], v[200:203], v[64:67]
ds_read_b64_tr_b16 v[112:113], v10 offset:256
v_mfma_f32_16x16x32_bf16 v[68:71], v[128:131], v[204:207], v[68:71]
ds_read_b64_tr_b16 v[114:115], v10 offset:4864
v_mfma_f32_16x16x32_bf16 v[76:79], v[132:135], v[204:207], v[76:79]
ds_read_b64_tr_b16 v[116:117], v10 offset:9216
v_mfma_f32_16x16x32_bf16 v[72:75], v[132:135], v[200:203], v[72:75]
ds_read_b64_tr_b16 v[118:119], v10 offset:13824
s_waitcnt lgkmcnt(4)
v_mfma_f32_16x16x32_bf16 v[80:83], v[104:107], v[200:203], v[80:83]
ds_read_b64_tr_b16 v[120:121], v10 offset:9248
v_mfma_f32_16x16x32_bf16 v[84:87], v[104:107], v[204:207], v[84:87]
ds_read_b64_tr_b16 v[122:123], v10 offset:13856
v_mfma_f32_16x16x32_bf16 v[92:95], v[108:111], v[204:207], v[92:95]
ds_read_b64_tr_b16 v[124:125], v10 offset:9280
v_mfma_f32_16x16x32_bf16 v[88:91], v[108:111], v[200:203], v[88:91]
ds_read_b64_tr_b16 v[126:127], v10 offset:13888
s_waitcnt lgkmcnt(4)
v_mfma_f32_16x16x32_bf16 v[96:99], v[112:115], v[200:203], v[96:99]
ds_read_b64_tr_b16 v[128:129], v10 offset:9312
v_mfma_f32_16x16x32_bf16 v[100:103], v[112:115], v[204:207], v[100:103]
ds_read_b64_tr_b16 v[130:131], v10 offset:13920
s_waitcnt vmcnt(18)
v_mfma_f32_16x16x32_bf16 v[36:39], v[116:119], v[212:215], v[36:39]
ds_read_b64_tr_b16 v[132:133], v10 offset:9344
v_mfma_f32_16x16x32_bf16 v[32:35], v[116:119], v[208:211], v[32:35]
ds_read_b64_tr_b16 v[134:135], v10 offset:13952
s_waitcnt lgkmcnt(4)
v_mfma_f32_16x16x32_bf16 v[40:43], v[120:123], v[208:211], v[40:43]
ds_read_b64_tr_b16 v[104:105], v10 offset:9376
v_mfma_f32_16x16x32_bf16 v[44:47], v[120:123], v[212:215], v[44:47]
ds_read_b64_tr_b16 v[106:107], v10 offset:13984
v_mfma_f32_16x16x32_bf16 v[52:55], v[124:127], v[212:215], v[52:55]
ds_read_b64_tr_b16 v[108:109], v10 offset:9408
v_mfma_f32_16x16x32_bf16 v[48:51], v[124:127], v[208:211], v[48:51]
ds_read_b64_tr_b16 v[110:111], v10 offset:14016
s_waitcnt lgkmcnt(4)
v_mfma_f32_16x16x32_bf16 v[56:59], v[128:131], v[208:211], v[56:59]
ds_read_b64_tr_b16 v[112:113], v10 offset:9440
v_mfma_f32_16x16x32_bf16 v[60:63], v[128:131], v[212:215], v[60:63]
ds_read_b64_tr_b16 v[114:115], v10 offset:14048
v_mfma_f32_16x16x32_bf16 v[68:71], v[132:135], v[212:215], v[68:71]
ds_read_b64_tr_b16 v[116:117], v10 offset:9472
v_mfma_f32_16x16x32_bf16 v[64:67], v[132:135], v[208:211], v[64:67]
ds_read_b64_tr_b16 v[118:119], v10 offset:14080
s_waitcnt lgkmcnt(4)
v_mfma_f32_16x16x32_bf16 v[72:75], v[104:107], v[208:211], v[72:75]
ds_read_b64_tr_b16 v[120:121], v10 offset:18432
v_mfma_f32_16x16x32_bf16 v[76:79], v[104:107], v[212:215], v[76:79]
ds_read_b64_tr_b16 v[122:123], v10 offset:23040
v_mfma_f32_16x16x32_bf16 v[84:87], v[108:111], v[212:215], v[84:87]
ds_read_b64_tr_b16 v[124:125], v10 offset:18464
v_mfma_f32_16x16x32_bf16 v[80:83], v[108:111], v[208:211], v[80:83]
ds_read_b64_tr_b16 v[126:127], v10 offset:23072
s_waitcnt lgkmcnt(4)
v_mfma_f32_16x16x32_bf16 v[88:91], v[112:115], v[208:211], v[88:91]
ds_read_b64_tr_b16 v[128:129], v10 offset:18496
v_mfma_f32_16x16x32_bf16 v[92:95], v[112:115], v[212:215], v[92:95]
ds_read_b64_tr_b16 v[130:131], v10 offset:23104
v_mfma_f32_16x16x32_bf16 v[100:103], v[116:119], v[212:215], v[100:103]
ds_read_b64_tr_b16 v[132:133], v10 offset:18528
v_mfma_f32_16x16x32_bf16 v[96:99], v[116:119], v[208:211], v[96:99]
ds_read_b64_tr_b16 v[134:135], v10 offset:23136
s_waitcnt vmcnt(16)
s_waitcnt lgkmcnt(4)
v_mfma_f32_16x16x32_bf16 v[32:35], v[120:123], v[216:219], v[32:35]
ds_read_b64_tr_b16 v[104:105], v10 offset:18560
v_mfma_f32_16x16x32_bf16 v[36:39], v[120:123], v[220:223], v[36:39]
ds_read_b64_tr_b16 v[106:107], v10 offset:23168
v_mfma_f32_16x16x32_bf16 v[44:47], v[124:127], v[220:223], v[44:47]
ds_read_b64_tr_b16 v[108:109], v10 offset:18592
v_mfma_f32_16x16x32_bf16 v[40:43], v[124:127], v[216:219], v[40:43]
ds_read_b64_tr_b16 v[110:111], v10 offset:23200
s_waitcnt lgkmcnt(4)
v_mfma_f32_16x16x32_bf16 v[48:51], v[128:131], v[216:219], v[48:51]
ds_read_b64_tr_b16 v[112:113], v10 offset:18624
v_mfma_f32_16x16x32_bf16 v[52:55], v[128:131], v[220:223], v[52:55]
ds_read_b64_tr_b16 v[114:115], v10 offset:23232
v_mfma_f32_16x16x32_bf16 v[60:63], v[132:135], v[220:223], v[60:63]
ds_read_b64_tr_b16 v[116:117], v10 offset:18656
v_mfma_f32_16x16x32_bf16 v[56:59], v[132:135], v[216:219], v[56:59]
ds_read_b64_tr_b16 v[118:119], v10 offset:23264
s_waitcnt lgkmcnt(4)
v_mfma_f32_16x16x32_bf16 v[64:67], v[104:107], v[216:219], v[64:67]
ds_read_b64_tr_b16 v[120:121], v10 offset:18688
v_mfma_f32_16x16x32_bf16 v[68:71], v[104:107], v[220:223], v[68:71]
ds_read_b64_tr_b16 v[122:123], v10 offset:23296
v_mfma_f32_16x16x32_bf16 v[76:79], v[108:111], v[220:223], v[76:79]
ds_read_b64_tr_b16 v[124:125], v8 offset:0
v_mfma_f32_16x16x32_bf16 v[72:75], v[108:111], v[216:219], v[72:75]
ds_read_b64_tr_b16 v[126:127], v8 offset:4608
s_waitcnt lgkmcnt(4)
v_mfma_f32_16x16x32_bf16 v[80:83], v[112:115], v[216:219], v[80:83]
ds_read_b64_tr_b16 v[128:129], v8 offset:32
v_mfma_f32_16x16x32_bf16 v[84:87], v[112:115], v[220:223], v[84:87]
ds_read_b64_tr_b16 v[130:131], v8 offset:4640
v_mfma_f32_16x16x32_bf16 v[92:95], v[116:119], v[220:223], v[92:95]
ds_read_b64_tr_b16 v[132:133], v8 offset:64
v_mfma_f32_16x16x32_bf16 v[88:91], v[116:119], v[216:219], v[88:91]
ds_read_b64_tr_b16 v[134:135], v8 offset:4672
s_waitcnt lgkmcnt(4)
v_mfma_f32_16x16x32_bf16 v[96:99], v[120:123], v[216:219], v[96:99]
ds_read_b64_tr_b16 v[104:105], v8 offset:96
v_mfma_f32_16x16x32_bf16 v[100:103], v[120:123], v[220:223], v[100:103]
ds_read_b64_tr_b16 v[106:107], v8 offset:4704
s_waitcnt vmcnt(14)
v_mfma_f32_16x16x32_bf16 v[36:39], v[124:127], v[228:231], v[36:39]
ds_read_b64_tr_b16 v[108:109], v8 offset:128
v_mfma_f32_16x16x32_bf16 v[32:35], v[124:127], v[224:227], v[32:35]
ds_read_b64_tr_b16 v[110:111], v8 offset:4736
s_waitcnt lgkmcnt(4)
v_mfma_f32_16x16x32_bf16 v[40:43], v[128:131], v[224:227], v[40:43]
ds_read_b64_tr_b16 v[112:113], v8 offset:160
v_mfma_f32_16x16x32_bf16 v[44:47], v[128:131], v[228:231], v[44:47]
ds_read_b64_tr_b16 v[114:115], v8 offset:4768
v_mfma_f32_16x16x32_bf16 v[52:55], v[132:135], v[228:231], v[52:55]
ds_read_b64_tr_b16 v[116:117], v8 offset:192
v_mfma_f32_16x16x32_bf16 v[48:51], v[132:135], v[224:227], v[48:51]
ds_read_b64_tr_b16 v[118:119], v8 offset:4800
s_waitcnt lgkmcnt(4)
v_mfma_f32_16x16x32_bf16 v[56:59], v[104:107], v[224:227], v[56:59]
ds_read_b64_tr_b16 v[120:121], v8 offset:224
v_mfma_f32_16x16x32_bf16 v[60:63], v[104:107], v[228:231], v[60:63]
ds_read_b64_tr_b16 v[122:123], v8 offset:4832
v_mfma_f32_16x16x32_bf16 v[68:71], v[108:111], v[228:231], v[68:71]
ds_read_b64_tr_b16 v[124:125], v8 offset:256
v_mfma_f32_16x16x32_bf16 v[64:67], v[108:111], v[224:227], v[64:67]
ds_read_b64_tr_b16 v[126:127], v8 offset:4864
s_waitcnt lgkmcnt(4)
v_mfma_f32_16x16x32_bf16 v[72:75], v[112:115], v[224:227], v[72:75]
ds_read_b64_tr_b16 v[128:129], v8 offset:9216
v_mfma_f32_16x16x32_bf16 v[76:79], v[112:115], v[228:231], v[76:79]
ds_read_b64_tr_b16 v[130:131], v8 offset:13824
v_mfma_f32_16x16x32_bf16 v[84:87], v[116:119], v[228:231], v[84:87]
ds_read_b64_tr_b16 v[132:133], v8 offset:9248
v_mfma_f32_16x16x32_bf16 v[80:83], v[116:119], v[224:227], v[80:83]
ds_read_b64_tr_b16 v[134:135], v8 offset:13856
s_waitcnt lgkmcnt(4)
v_mfma_f32_16x16x32_bf16 v[88:91], v[120:123], v[224:227], v[88:91]
ds_read_b64_tr_b16 v[104:105], v8 offset:9280
v_mfma_f32_16x16x32_bf16 v[92:95], v[120:123], v[228:231], v[92:95]
ds_read_b64_tr_b16 v[106:107], v8 offset:13888
v_mfma_f32_16x16x32_bf16 v[100:103], v[124:127], v[228:231], v[100:103]
ds_read_b64_tr_b16 v[108:109], v8 offset:9312
v_mfma_f32_16x16x32_bf16 v[96:99], v[124:127], v[224:227], v[96:99]
ds_read_b64_tr_b16 v[110:111], v8 offset:13920
s_waitcnt vmcnt(12)
s_waitcnt lgkmcnt(4)
v_mfma_f32_16x16x32_bf16 v[32:35], v[128:131], v[232:235], v[32:35]
ds_read_b64_tr_b16 v[112:113], v8 offset:9344
v_mfma_f32_16x16x32_bf16 v[36:39], v[128:131], v[236:239], v[36:39]
ds_read_b64_tr_b16 v[114:115], v8 offset:13952
v_mfma_f32_16x16x32_bf16 v[44:47], v[132:135], v[236:239], v[44:47]
ds_read_b64_tr_b16 v[116:117], v8 offset:9376
v_mfma_f32_16x16x32_bf16 v[40:43], v[132:135], v[232:235], v[40:43]
ds_read_b64_tr_b16 v[118:119], v8 offset:13984
s_waitcnt lgkmcnt(4)
v_mfma_f32_16x16x32_bf16 v[48:51], v[104:107], v[232:235], v[48:51]
ds_read_b64_tr_b16 v[120:121], v8 offset:9408
v_mfma_f32_16x16x32_bf16 v[52:55], v[104:107], v[236:239], v[52:55]
ds_read_b64_tr_b16 v[122:123], v8 offset:14016
v_mfma_f32_16x16x32_bf16 v[60:63], v[108:111], v[236:239], v[60:63]
ds_read_b64_tr_b16 v[124:125], v8 offset:9440
v_mfma_f32_16x16x32_bf16 v[56:59], v[108:111], v[232:235], v[56:59]
ds_read_b64_tr_b16 v[126:127], v8 offset:14048
s_waitcnt lgkmcnt(4)
v_mfma_f32_16x16x32_bf16 v[64:67], v[112:115], v[232:235], v[64:67]
ds_read_b64_tr_b16 v[128:129], v8 offset:9472
v_mfma_f32_16x16x32_bf16 v[68:71], v[112:115], v[236:239], v[68:71]
ds_read_b64_tr_b16 v[130:131], v8 offset:14080
v_mfma_f32_16x16x32_bf16 v[76:79], v[116:119], v[236:239], v[76:79]
ds_read_b64_tr_b16 v[132:133], v8 offset:18432
v_mfma_f32_16x16x32_bf16 v[72:75], v[116:119], v[232:235], v[72:75]
ds_read_b64_tr_b16 v[134:135], v8 offset:23040
s_waitcnt lgkmcnt(4)
v_mfma_f32_16x16x32_bf16 v[80:83], v[120:123], v[232:235], v[80:83]
ds_read_b64_tr_b16 v[104:105], v8 offset:18464
v_mfma_f32_16x16x32_bf16 v[84:87], v[120:123], v[236:239], v[84:87]
ds_read_b64_tr_b16 v[106:107], v8 offset:23072
v_mfma_f32_16x16x32_bf16 v[92:95], v[124:127], v[236:239], v[92:95]
ds_read_b64_tr_b16 v[108:109], v8 offset:18496
v_mfma_f32_16x16x32_bf16 v[88:91], v[124:127], v[232:235], v[88:91]
ds_read_b64_tr_b16 v[110:111], v8 offset:23104
s_waitcnt lgkmcnt(4)
v_mfma_f32_16x16x32_bf16 v[96:99], v[128:131], v[232:235], v[96:99]
ds_read_b64_tr_b16 v[112:113], v8 offset:18528
v_mfma_f32_16x16x32_bf16 v[100:103], v[128:131], v[236:239], v[100:103]
ds_read_b64_tr_b16 v[114:115], v8 offset:23136
s_waitcnt vmcnt(10)
v_mfma_f32_16x16x32_bf16 v[36:39], v[132:135], v[244:247], v[36:39]
ds_read_b64_tr_b16 v[116:117], v8 offset:18560
v_mfma_f32_16x16x32_bf16 v[32:35], v[132:135], v[240:243], v[32:35]
ds_read_b64_tr_b16 v[118:119], v8 offset:23168
s_waitcnt lgkmcnt(4)
v_mfma_f32_16x16x32_bf16 v[40:43], v[104:107], v[240:243], v[40:43]
ds_read_b64_tr_b16 v[120:121], v8 offset:18592
v_mfma_f32_16x16x32_bf16 v[44:47], v[104:107], v[244:247], v[44:47]
ds_read_b64_tr_b16 v[122:123], v8 offset:23200
v_mfma_f32_16x16x32_bf16 v[52:55], v[108:111], v[244:247], v[52:55]
ds_read_b64_tr_b16 v[124:125], v8 offset:18624
v_mfma_f32_16x16x32_bf16 v[48:51], v[108:111], v[240:243], v[48:51]
ds_read_b64_tr_b16 v[126:127], v8 offset:23232
s_waitcnt lgkmcnt(4)
v_mfma_f32_16x16x32_bf16 v[56:59], v[112:115], v[240:243], v[56:59]
ds_read_b64_tr_b16 v[128:129], v8 offset:18656
v_mfma_f32_16x16x32_bf16 v[60:63], v[112:115], v[244:247], v[60:63]
ds_read_b64_tr_b16 v[130:131], v8 offset:23264
v_mfma_f32_16x16x32_bf16 v[68:71], v[116:119], v[244:247], v[68:71]
ds_read_b64_tr_b16 v[132:133], v8 offset:18688
v_mfma_f32_16x16x32_bf16 v[64:67], v[116:119], v[240:243], v[64:67]
ds_read_b64_tr_b16 v[134:135], v8 offset:23296
s_waitcnt lgkmcnt(4)
v_mfma_f32_16x16x32_bf16 v[72:75], v[120:123], v[240:243], v[72:75]
ds_read_b64_tr_b16 v[104:105], v8 offset:27648
v_mfma_f32_16x16x32_bf16 v[76:79], v[120:123], v[244:247], v[76:79]
ds_read_b64_tr_b16 v[106:107], v8 offset:32256
v_mfma_f32_16x16x32_bf16 v[84:87], v[124:127], v[244:247], v[84:87]
ds_read_b64_tr_b16 v[108:109], v8 offset:27680
v_mfma_f32_16x16x32_bf16 v[80:83], v[124:127], v[240:243], v[80:83]
ds_read_b64_tr_b16 v[110:111], v8 offset:32288
s_waitcnt lgkmcnt(4)
v_mfma_f32_16x16x32_bf16 v[88:91], v[128:131], v[240:243], v[88:91]
ds_read_b64_tr_b16 v[112:113], v8 offset:27712
v_mfma_f32_16x16x32_bf16 v[92:95], v[128:131], v[244:247], v[92:95]
ds_read_b64_tr_b16 v[114:115], v8 offset:32320
v_mfma_f32_16x16x32_bf16 v[100:103], v[132:135], v[244:247], v[100:103]
ds_read_b64_tr_b16 v[116:117], v8 offset:27744
v_mfma_f32_16x16x32_bf16 v[96:99], v[132:135], v[240:243], v[96:99]
ds_read_b64_tr_b16 v[118:119], v8 offset:32352
s_waitcnt vmcnt(8)
s_waitcnt lgkmcnt(4)
v_mfma_f32_16x16x32_bf16 v[32:35], v[104:107], v[248:251], v[32:35]
ds_read_b64_tr_b16 v[120:121], v8 offset:27776
v_mfma_f32_16x16x32_bf16 v[36:39], v[104:107], v[252:255], v[36:39]
ds_read_b64_tr_b16 v[122:123], v8 offset:32384
v_mfma_f32_16x16x32_bf16 v[44:47], v[108:111], v[252:255], v[44:47]
ds_read_b64_tr_b16 v[124:125], v8 offset:27808
v_mfma_f32_16x16x32_bf16 v[40:43], v[108:111], v[248:251], v[40:43]
ds_read_b64_tr_b16 v[126:127], v8 offset:32416
s_waitcnt lgkmcnt(4)
v_mfma_f32_16x16x32_bf16 v[48:51], v[112:115], v[248:251], v[48:51]
ds_read_b64_tr_b16 v[128:129], v8 offset:27840
v_mfma_f32_16x16x32_bf16 v[52:55], v[112:115], v[252:255], v[52:55]
ds_read_b64_tr_b16 v[130:131], v8 offset:32448
v_mfma_f32_16x16x32_bf16 v[60:63], v[116:119], v[252:255], v[60:63]
ds_read_b64_tr_b16 v[132:133], v8 offset:27872
v_mfma_f32_16x16x32_bf16 v[56:59], v[116:119], v[248:251], v[56:59]
ds_read_b64_tr_b16 v[134:135], v8 offset:32480
s_waitcnt lgkmcnt(4)
v_mfma_f32_16x16x32_bf16 v[64:67], v[120:123], v[248:251], v[64:67]
ds_read_b64_tr_b16 v[104:105], v8 offset:27904
v_mfma_f32_16x16x32_bf16 v[68:71], v[120:123], v[252:255], v[68:71]
ds_read_b64_tr_b16 v[106:107], v8 offset:32512
v_mfma_f32_16x16x32_bf16 v[76:79], v[124:127], v[252:255], v[76:79]
ds_read_b64_tr_b16 v[108:109], v8 offset:36864
v_mfma_f32_16x16x32_bf16 v[72:75], v[124:127], v[248:251], v[72:75]
ds_read_b64_tr_b16 v[110:111], v8 offset:41472
s_waitcnt lgkmcnt(4)
v_mfma_f32_16x16x32_bf16 v[80:83], v[128:131], v[248:251], v[80:83]
ds_read_b64_tr_b16 v[112:113], v8 offset:36896
v_mfma_f32_16x16x32_bf16 v[84:87], v[128:131], v[252:255], v[84:87]
ds_read_b64_tr_b16 v[114:115], v8 offset:41504
v_mfma_f32_16x16x32_bf16 v[92:95], v[132:135], v[252:255], v[92:95]
ds_read_b64_tr_b16 v[116:117], v8 offset:36928
v_mfma_f32_16x16x32_bf16 v[88:91], v[132:135], v[248:251], v[88:91]
ds_read_b64_tr_b16 v[118:119], v8 offset:41536
s_waitcnt lgkmcnt(4)
v_mfma_f32_16x16x32_bf16 v[96:99], v[104:107], v[248:251], v[96:99]
ds_read_b64_tr_b16 v[120:121], v8 offset:36960
v_mfma_f32_16x16x32_bf16 v[100:103], v[104:107], v[252:255], v[100:103]
ds_read_b64_tr_b16 v[122:123], v8 offset:41568
s_waitcnt vmcnt(6)
v_mfma_f32_16x16x32_bf16 v[36:39], v[108:111], v[140:143], v[36:39]
ds_read_b64_tr_b16 v[124:125], v8 offset:36992
v_mfma_f32_16x16x32_bf16 v[32:35], v[108:111], v[136:139], v[32:35]
ds_read_b64_tr_b16 v[126:127], v8 offset:41600
s_waitcnt lgkmcnt(4)
v_mfma_f32_16x16x32_bf16 v[40:43], v[112:115], v[136:139], v[40:43]
ds_read_b64_tr_b16 v[128:129], v8 offset:37024
v_mfma_f32_16x16x32_bf16 v[44:47], v[112:115], v[140:143], v[44:47]
ds_read_b64_tr_b16 v[130:131], v8 offset:41632
v_mfma_f32_16x16x32_bf16 v[52:55], v[116:119], v[140:143], v[52:55]
ds_read_b64_tr_b16 v[132:133], v8 offset:37056
v_mfma_f32_16x16x32_bf16 v[48:51], v[116:119], v[136:139], v[48:51]
ds_read_b64_tr_b16 v[134:135], v8 offset:41664
s_waitcnt lgkmcnt(4)
v_mfma_f32_16x16x32_bf16 v[56:59], v[120:123], v[136:139], v[56:59]
ds_read_b64_tr_b16 v[104:105], v8 offset:37088
v_mfma_f32_16x16x32_bf16 v[60:63], v[120:123], v[140:143], v[60:63]
ds_read_b64_tr_b16 v[106:107], v8 offset:41696
v_mfma_f32_16x16x32_bf16 v[68:71], v[124:127], v[140:143], v[68:71]
ds_read_b64_tr_b16 v[108:109], v8 offset:37120
v_mfma_f32_16x16x32_bf16 v[64:67], v[124:127], v[136:139], v[64:67]
ds_read_b64_tr_b16 v[110:111], v8 offset:41728
s_waitcnt lgkmcnt(4)
v_mfma_f32_16x16x32_bf16 v[72:75], v[128:131], v[136:139], v[72:75]
ds_read_b64_tr_b16 v[112:113], v8 offset:46080
v_mfma_f32_16x16x32_bf16 v[76:79], v[128:131], v[140:143], v[76:79]
ds_read_b64_tr_b16 v[114:115], v8 offset:50688
v_mfma_f32_16x16x32_bf16 v[84:87], v[132:135], v[140:143], v[84:87]
ds_read_b64_tr_b16 v[116:117], v8 offset:46112
v_mfma_f32_16x16x32_bf16 v[80:83], v[132:135], v[136:139], v[80:83]
ds_read_b64_tr_b16 v[118:119], v8 offset:50720
s_waitcnt lgkmcnt(4)
v_mfma_f32_16x16x32_bf16 v[88:91], v[104:107], v[136:139], v[88:91]
ds_read_b64_tr_b16 v[120:121], v8 offset:46144
v_mfma_f32_16x16x32_bf16 v[92:95], v[104:107], v[140:143], v[92:95]
ds_read_b64_tr_b16 v[122:123], v8 offset:50752
v_mfma_f32_16x16x32_bf16 v[100:103], v[108:111], v[140:143], v[100:103]
ds_read_b64_tr_b16 v[124:125], v8 offset:46176
v_mfma_f32_16x16x32_bf16 v[96:99], v[108:111], v[136:139], v[96:99]
ds_read_b64_tr_b16 v[126:127], v8 offset:50784
s_waitcnt vmcnt(4)
s_waitcnt lgkmcnt(4)
v_mfma_f32_16x16x32_bf16 v[32:35], v[112:115], v[144:147], v[32:35]
ds_read_b64_tr_b16 v[128:129], v8 offset:46208
v_mfma_f32_16x16x32_bf16 v[36:39], v[112:115], v[148:151], v[36:39]
ds_read_b64_tr_b16 v[130:131], v8 offset:50816
v_mfma_f32_16x16x32_bf16 v[44:47], v[116:119], v[148:151], v[44:47]
ds_read_b64_tr_b16 v[132:133], v8 offset:46240
v_mfma_f32_16x16x32_bf16 v[40:43], v[116:119], v[144:147], v[40:43]
ds_read_b64_tr_b16 v[134:135], v8 offset:50848
s_waitcnt lgkmcnt(4)
v_mfma_f32_16x16x32_bf16 v[48:51], v[120:123], v[144:147], v[48:51]
ds_read_b64_tr_b16 v[104:105], v8 offset:46272
v_mfma_f32_16x16x32_bf16 v[52:55], v[120:123], v[148:151], v[52:55]
ds_read_b64_tr_b16 v[106:107], v8 offset:50880
v_mfma_f32_16x16x32_bf16 v[60:63], v[124:127], v[148:151], v[60:63]
ds_read_b64_tr_b16 v[108:109], v8 offset:46304
v_mfma_f32_16x16x32_bf16 v[56:59], v[124:127], v[144:147], v[56:59]
ds_read_b64_tr_b16 v[110:111], v8 offset:50912
s_waitcnt lgkmcnt(4)
v_mfma_f32_16x16x32_bf16 v[64:67], v[128:131], v[144:147], v[64:67]
ds_read_b64_tr_b16 v[112:113], v8 offset:46336
v_mfma_f32_16x16x32_bf16 v[68:71], v[128:131], v[148:151], v[68:71]
ds_read_b64_tr_b16 v[114:115], v8 offset:50944
v_mfma_f32_16x16x32_bf16 v[76:79], v[132:135], v[148:151], v[76:79]
ds_read_b64_tr_b16 v[116:117], v9 offset:0
v_mfma_f32_16x16x32_bf16 v[72:75], v[132:135], v[144:147], v[72:75]
ds_read_b64_tr_b16 v[118:119], v9 offset:4608
s_waitcnt lgkmcnt(4)
v_mfma_f32_16x16x32_bf16 v[80:83], v[104:107], v[144:147], v[80:83]
ds_read_b64_tr_b16 v[120:121], v9 offset:32
v_mfma_f32_16x16x32_bf16 v[84:87], v[104:107], v[148:151], v[84:87]
ds_read_b64_tr_b16 v[122:123], v9 offset:4640
v_mfma_f32_16x16x32_bf16 v[92:95], v[108:111], v[148:151], v[92:95]
ds_read_b64_tr_b16 v[124:125], v9 offset:64
v_mfma_f32_16x16x32_bf16 v[88:91], v[108:111], v[144:147], v[88:91]
ds_read_b64_tr_b16 v[126:127], v9 offset:4672
s_waitcnt lgkmcnt(4)
v_mfma_f32_16x16x32_bf16 v[96:99], v[112:115], v[144:147], v[96:99]
ds_read_b64_tr_b16 v[128:129], v9 offset:96
v_mfma_f32_16x16x32_bf16 v[100:103], v[112:115], v[148:151], v[100:103]
ds_read_b64_tr_b16 v[130:131], v9 offset:4704
s_waitcnt vmcnt(0)
v_mfma_f32_16x16x32_bf16 v[36:39], v[116:119], v[156:159], v[36:39]
ds_read_b64_tr_b16 v[132:133], v9 offset:128
v_mfma_f32_16x16x32_bf16 v[32:35], v[116:119], v[152:155], v[32:35]
ds_read_b64_tr_b16 v[134:135], v9 offset:4736
s_waitcnt lgkmcnt(4)
v_mfma_f32_16x16x32_bf16 v[40:43], v[120:123], v[152:155], v[40:43]
ds_read_b64_tr_b16 v[104:105], v9 offset:160
v_mfma_f32_16x16x32_bf16 v[44:47], v[120:123], v[156:159], v[44:47]
ds_read_b64_tr_b16 v[106:107], v9 offset:4768
v_mfma_f32_16x16x32_bf16 v[52:55], v[124:127], v[156:159], v[52:55]
ds_read_b64_tr_b16 v[108:109], v9 offset:192
v_mfma_f32_16x16x32_bf16 v[48:51], v[124:127], v[152:155], v[48:51]
ds_read_b64_tr_b16 v[110:111], v9 offset:4800
s_waitcnt lgkmcnt(4)
v_mfma_f32_16x16x32_bf16 v[56:59], v[128:131], v[152:155], v[56:59]
ds_read_b64_tr_b16 v[112:113], v9 offset:224
v_mfma_f32_16x16x32_bf16 v[60:63], v[128:131], v[156:159], v[60:63]
ds_read_b64_tr_b16 v[114:115], v9 offset:4832
v_mfma_f32_16x16x32_bf16 v[68:71], v[132:135], v[156:159], v[68:71]
ds_read_b64_tr_b16 v[116:117], v9 offset:256
v_mfma_f32_16x16x32_bf16 v[64:67], v[132:135], v[152:155], v[64:67]
ds_read_b64_tr_b16 v[118:119], v9 offset:4864
s_waitcnt lgkmcnt(4)
v_mfma_f32_16x16x32_bf16 v[72:75], v[104:107], v[152:155], v[72:75]
v_mfma_f32_16x16x32_bf16 v[76:79], v[104:107], v[156:159], v[76:79]
v_mfma_f32_16x16x32_bf16 v[84:87], v[108:111], v[156:159], v[84:87]
v_mfma_f32_16x16x32_bf16 v[80:83], v[108:111], v[152:155], v[80:83]
s_waitcnt lgkmcnt(0)
v_mfma_f32_16x16x32_bf16 v[88:91], v[112:115], v[152:155], v[88:91]
v_mfma_f32_16x16x32_bf16 v[92:95], v[112:115], v[156:159], v[92:95]
v_mfma_f32_16x16x32_bf16 v[100:103], v[116:119], v[156:159], v[100:103]
v_mfma_f32_16x16x32_bf16 v[96:99], v[116:119], v[152:155], v[96:99]
s_mul_i32 s59, s3, 9216
s_add_u32 s59, s59, 29360128
s_mul_i32 s33, s30, 4352
s_add_u32 s59, s59, s33
s_lshl_b32 s33, s29, 1
s_cmp_eq_u32 s33, s30
s_cselect_b32 s56, 0x7f000000, s59
s_add_u32 s33, s33, 1
s_cmp_eq_u32 s33, s30
s_cselect_b32 s57, 0x7f000000, s59
v_add_u32 v30, 73728, v3
v_cvt_pk_bf16_f32 v136, v32, v33
v_cvt_pk_bf16_f32 v137, v34, v35
v_cvt_pk_bf16_f32 v138, v40, v41
v_cvt_pk_bf16_f32 v139, v42, v43
buffer_store_dwordx4 v[136:139], v3, s[16:19], s56 offen offset:0 sc1
v_cvt_pk_bf16_f32 v140, v48, v49
v_cvt_pk_bf16_f32 v141, v50, v51
v_cvt_pk_bf16_f32 v142, v56, v57
v_cvt_pk_bf16_f32 v143, v58, v59
buffer_store_dwordx4 v[140:143], v3, s[16:19], s56 offen offset:1024 sc1
v_cvt_pk_bf16_f32 v144, v64, v65
v_cvt_pk_bf16_f32 v145, v66, v67
v_cvt_pk_bf16_f32 v146, v72, v73
v_cvt_pk_bf16_f32 v147, v74, v75
buffer_store_dwordx4 v[144:147], v3, s[16:19], s56 offen offset:2048 sc1
v_cvt_pk_bf16_f32 v148, v80, v81
v_cvt_pk_bf16_f32 v149, v82, v83
v_cvt_pk_bf16_f32 v150, v88, v89
v_cvt_pk_bf16_f32 v151, v90, v91
buffer_store_dwordx4 v[148:151], v3, s[16:19], s56 offen offset:3072 sc1
v_cvt_pk_bf16_f32 v168, v96, v97
v_cvt_pk_bf16_f32 v169, v98, v99
v_cvt_pk_bf16_f32 v152, v36, v37
v_cvt_pk_bf16_f32 v153, v38, v39
v_cvt_pk_bf16_f32 v154, v44, v45
v_cvt_pk_bf16_f32 v155, v46, v47
buffer_store_dwordx4 v[152:155], v4, s[16:19], s57 offen offset:0 sc1
v_cvt_pk_bf16_f32 v156, v52, v53
v_cvt_pk_bf16_f32 v157, v54, v55
v_cvt_pk_bf16_f32 v158, v60, v61
v_cvt_pk_bf16_f32 v159, v62, v63
buffer_store_dwordx4 v[156:159], v4, s[16:19], s57 offen offset:1024 sc1
v_cvt_pk_bf16_f32 v160, v68, v69
v_cvt_pk_bf16_f32 v161, v70, v71
v_cvt_pk_bf16_f32 v162, v76, v77
v_cvt_pk_bf16_f32 v163, v78, v79
buffer_store_dwordx4 v[160:163], v4, s[16:19], s57 offen offset:2048 sc1
v_cvt_pk_bf16_f32 v164, v84, v85
v_cvt_pk_bf16_f32 v165, v86, v87
v_cvt_pk_bf16_f32 v166, v92, v93
v_cvt_pk_bf16_f32 v167, v94, v95
buffer_store_dwordx4 v[164:167], v4, s[16:19], s57 offen offset:3072 sc1
v_cvt_pk_bf16_f32 v170, v100, v101
v_cvt_pk_bf16_f32 v171, v102, v103
s_nop 0
v_permlane32_swap_b32 v168, v170
v_permlane32_swap_b32 v169, v171
buffer_store_dwordx4 v[168:171], v5, s[16:19], s59 offen sc1
s_cmp_lg_u32 s56, 0x7f000000
s_cbranch_scc1 Lo_126
ds_write_b128 v30, v[136:139] offset:0
ds_write_b128 v30, v[140:143] offset:1024
ds_write_b128 v30, v[144:147] offset:2048
ds_write_b128 v30, v[148:151] offset:3072
Lo_126:
s_cmp_lg_u32 s57, 0x7f000000
s_cbranch_scc1 Lo_127
ds_write_b128 v30, v[152:155] offset:0
ds_write_b128 v30, v[156:159] offset:1024
ds_write_b128 v30, v[160:163] offset:2048
ds_write_b128 v30, v[164:167] offset:3072
Lo_127:
s_waitcnt lgkmcnt(0)
s_lshl_b32 s33, s32, 2
s_add_u32 s33, s33, s31
s_lshl_b32 s33, s33, 3
s_lshr_b32 s59, s30, 1
s_add_u32 s33, s33, s59
s_add_u32 s38, s33, 4
s_waitcnt vmcnt(0)
s_lshl_b32 s33, s97, 2
s_add_u32 s33, s33, 51052544
v_mov_b32 v30, 0
v_mov_b32 v31, s68
s_mov_b64 exec, 1
buffer_store_dword v31, v30, s[16:19], s33 offen sc1
s_mov_b64 exec, -1
s_barrier
s_andn2_b32 s33, s2, 7
s_lshr_b32 s59, s30, 1
s_add_u32 s33, s33, s59
s_add_u32 s33, s33, 4
s_lshl_b32 s33, s33, 5
s_add_u32 s33, s33, 12763136
v_lshlrev_b32 v32, 0, v2
v_add_lshl_u32 v32, s33, v32, 2
s_mul_i32 s59, s38, 9216
s_add_u32 s59, s59, 29360128
s_and_b32 s33, s30, 1
s_lshl_b32 s38, s33, 12
s_add_u32 s60, s59, s38
s_lshl_b32 s33, s33, 9
s_add_u32 s59, s59, s33
v_and_b32 v37, 31, v2
v_lshlrev_b32 v37, 4, v37
v_lshrrev_b32 v38, 5, v2
v_lshl_add_u32 v37, v38, 3, v37
v_add_u32 v37, 8192, v37
s_mov_b64 exec, 0xff
buffer_load_dword v33, v32, s[16:19], 0 offen sc1
s_mov_b64 exec, -1
s_waitcnt vmcnt(0)
s_mov_b64 exec, 0xff
s_mov_b32 s58, 0x8000
LLp_128:
v_cmp_ne_u32 vcc, s68, v33
s_nop 4
s_cbranch_vccz LBq_129
buffer_load_dword v33, v32, s[16:19], 0 offen sc1
s_sub_u32 s58, s58, 1
s_waitcnt vmcnt(0)
s_cmp_gt_i32 s58, 0
s_cbranch_scc1 LLp_128
LBq_129:
s_mov_b64 exec, -1
s_add_u32 s39, s60, s37
s_add_u32 s33, s37, 73728
v_add_u32 v36, s33, v3
s_cmp_eq_u32 s30, 0
s_cbranch_scc1 Lo_130
buffer_load_dwordx4 v[136:139], v3, s[16:19], s39 offen sc1
Lo_130:
s_cbranch_scc0 Lo_131
ds_read_b128 v[136:139], v36
Lo_131:
s_add_u32 s39, s39, 2363648
s_cmp_eq_u32 s30, 1
s_cbranch_scc1 Lo_132
buffer_load_dwordx4 v[140:143], v3, s[16:19], s39 offen sc1
Lo_132:
s_cbranch_scc0 Lo_133
ds_read_b128 v[140:143], v36
Lo_133:
s_add_u32 s39, s39, 2363648
s_cmp_eq_u32 s30, 2
s_cbranch_scc1 Lo_134
buffer_load_dwordx4 v[144:147], v3, s[16:19], s39 offen sc1
Lo_134:
s_cbranch_scc0 Lo_135
ds_read_b128 v[144:147], v36
Lo_135:
s_add_u32 s39, s39, 2363648
s_cmp_eq_u32 s30, 3
s_cbranch_scc1 Lo_136
buffer_load_dwordx4 v[148:151], v3, s[16:19], s39 offen sc1
Lo_136:
s_cbranch_scc0 Lo_137
ds_read_b128 v[148:151], v36
Lo_137:
s_add_u32 s39, s39, 2363648
s_cmp_eq_u32 s30, 4
s_cbranch_scc1 Lo_138
buffer_load_dwordx4 v[152:155], v3, s[16:19], s39 offen sc1
Lo_138:
s_cbranch_scc0 Lo_139
ds_read_b128 v[152:155], v36
Lo_139:
s_add_u32 s39, s39, 2363648
s_cmp_eq_u32 s30, 5
s_cbranch_scc1 Lo_140
buffer_load_dwordx4 v[156:159], v3, s[16:19], s39 offen sc1
Lo_140:
s_cbranch_scc0 Lo_141
ds_read_b128 v[156:159], v36
Lo_141:
s_add_u32 s39, s39, 2363648
s_cmp_eq_u32 s30, 6
s_cbranch_scc1 Lo_142
buffer_load_dwordx4 v[160:163], v3, s[16:19], s39 offen sc1
Lo_142:
s_cbranch_scc0 Lo_143
ds_read_b128 v[160:163], v36
Lo_143:
s_add_u32 s39, s39, 2363648
s_cmp_eq_u32 s30, 7
s_cbranch_scc1 Lo_144
buffer_load_dwordx4 v[164:167], v3, s[16:19], s39 offen sc1
Lo_144:
s_cbranch_scc0 Lo_145
ds_read_b128 v[164:167], v36
Lo_145:
s_cmp_lg_u32 s29, 0
s_cbranch_scc1 Lv_146
buffer_load_dwordx2 v[168:169], v37, s[16:19], s59 offen sc1
s_add_u32 s59, s59, 2363648
buffer_load_dwordx2 v[170:171], v37, s[16:19], s59 offen sc1
s_add_u32 s59, s59, 2363648
buffer_load_dwordx2 v[172:173], v37, s[16:19], s59 offen sc1
s_add_u32 s59, s59, 2363648
buffer_load_dwordx2 v[174:175], v37, s[16:19], s59 offen sc1
s_add_u32 s59, s59, 2363648
buffer_load_dwordx2 v[176:177], v37, s[16:19], s59 offen sc1
s_add_u32 s59, s59, 2363648
buffer_load_dwordx2 v[178:179], v37, s[16:19], s59 offen sc1
s_add_u32 s59, s59, 2363648
buffer_load_dwordx2 v[180:181], v37, s[16:19], s59 offen sc1
s_add_u32 s59, s59, 2363648
buffer_load_dwordx2 v[182:183], v37, s[16:19], s59 offen sc1
Lv_146:
v_lshlrev_b32 v34, 3, v2
s_add_u32 s33, s37, 143360
v_add_u32 v34, s33, v34
s_mov_b32 s62, 0x00003f80
s_mov_b32 s63, 0x3f800000
s_mov_b32 s56, 0xbfb8aa3b
s_mov_b32 s57, 0x3f317218
ds_read_b64_tr_b16 v[40:41], v34
ds_read_b64_tr_b16 v[42:43], v34 offset:512
s_waitcnt vmcnt(0) lgkmcnt(0)
v_dot2_f32_bf16 v48, v136, s62, 0
v_dot2_f32_bf16 v49, v136, s63, 0
v_dot2_f32_bf16 v50, v137, s62, 0
v_dot2_f32_bf16 v51, v137, s63, 0
v_dot2_f32_bf16 v52, v138, s62, 0
v_dot2_f32_bf16 v53, v138, s63, 0
v_dot2_f32_bf16 v54, v139, s62, 0
v_dot2_f32_bf16 v55, v139, s63, 0
v_dot2_f32_bf16 v48, v140, s62, v48
v_dot2_f32_bf16 v49, v140, s63, v49
v_dot2_f32_bf16 v50, v141, s62, v50
v_dot2_f32_bf16 v51, v141, s63, v51
v_dot2_f32_bf16 v52, v142, s62, v52
v_dot2_f32_bf16 v53, v142, s63, v53
v_dot2_f32_bf16 v54, v143, s62, v54
v_dot2_f32_bf16 v55, v143, s63, v55
v_dot2_f32_bf16 v48, v144, s62, v48
v_dot2_f32_bf16 v49, v144, s63, v49
v_dot2_f32_bf16 v50, v145, s62, v50
v_dot2_f32_bf16 v51, v145, s63, v51
v_dot2_f32_bf16 v52, v146, s62, v52
v_dot2_f32_bf16 v53, v146, s63, v53
v_dot2_f32_bf16 v54, v147, s62, v54
v_dot2_f32_bf16 v55, v147, s63, v55
v_dot2_f32_bf16 v48, v148, s62, v48
v_dot2_f32_bf16 v49, v148, s63, v49
v_dot2_f32_bf16 v50, v149, s62, v50
v_dot2_f32_bf16 v51, v149, s63, v51
v_dot2_f32_bf16 v52, v150, s62, v52
v_dot2_f32_bf16 v53, v150, s63, v53
v_dot2_f32_bf16 v54, v151, s62, v54
v_dot2_f32_bf16 v55, v151, s63, v55
v_dot2_f32_bf16 v48, v152, s62, v48
v_dot2_f32_bf16 v49, v152, s63, v49
v_dot2_f32_bf16 v50, v153, s62, v50
v_dot2_f32_bf16 v51, v153, s63, v51
v_dot2_f32_bf16 v52, v154, s62, v52
v_dot2_f32_bf16 v53, v154, s63, v53
v_dot2_f32_bf16 v54, v155, s62, v54
v_dot2_f32_bf16 v55, v155, s63, v55
v_dot2_f32_bf16 v48, v156, s62, v48
v_dot2_f32_bf16 v49, v156, s63, v49
v_dot2_f32_bf16 v50, v157, s62, v50
v_dot2_f32_bf16 v51, v157, s63, v51
v_dot2_f32_bf16 v52, v158, s62, v52
v_dot2_f32_bf16 v53, v158, s63, v53
v_dot2_f32_bf16 v54, v159, s62, v54
v_dot2_f32_bf16 v55, v159, s63, v55
v_dot2_f32_bf16 v48, v160, s62, v48
v_dot2_f32_bf16 v49, v160, s63, v49
v_dot2_f32_bf16 v50, v161, s62, v50
v_dot2_f32_bf16 v51, v161, s63, v51
v_dot2_f32_bf16 v52, v162, s62, v52
v_dot2_f32_bf16 v53, v162, s63, v53
v_dot2_f32_bf16 v54, v163, s62, v54
v_dot2_f32_bf16 v55, v163, s63, v55
v_dot2_f32_bf16 v48, v164, s62, v48
v_dot2_f32_bf16 v49, v164, s63, v49
v_dot2_f32_bf16 v50, v165, s62, v50
v_dot2_f32_bf16 v51, v165, s63, v51
v_dot2_f32_bf16 v52, v166, s62, v52
v_dot2_f32_bf16 v53, v166, s63, v53
v_dot2_f32_bf16 v54, v167, s62, v54
v_dot2_f32_bf16 v55, v167, s63, v55
s_waitcnt lgkmcnt(0)
v_mul_f32 v48, s57, v48
v_mul_f32 v49, s57, v49
v_mul_f32 v50, s57, v50
v_mul_f32 v51, s57, v51
v_mul_f32 v52, s57, v52
v_mul_f32 v53, s57, v53
v_mul_f32 v54, s57, v54
v_mul_f32 v55, s57, v55
v_cvt_pk_bf16_f32 v64, v48, v49
v_cvt_pk_bf16_f32 v65, v50, v51
v_cvt_pk_bf16_f32 v66, v52, v53
v_cvt_pk_bf16_f32 v67, v54, v55
v_lshlrev_b32 v48, 16, v64
v_and_b32 v49, 0xffff0000, v64
v_lshlrev_b32 v50, 16, v65
v_and_b32 v51, 0xffff0000, v65
v_lshlrev_b32 v52, 16, v66
v_and_b32 v53, 0xffff0000, v66
v_lshlrev_b32 v54, 16, v67
v_and_b32 v55, 0xffff0000, v67
v_mul_f32 v80, s56, v48
v_mul_f32 v81, s56, v49
v_mul_f32 v82, s56, v50
v_mul_f32 v83, s56, v51
v_mul_f32 v84, s56, v52
v_mul_f32 v85, s56, v53
v_mul_f32 v86, s56, v54
v_mul_f32 v87, s56, v55
v_exp_f32 v80, v80
v_exp_f32 v81, v81
v_exp_f32 v82, v82
v_exp_f32 v83, v83
v_exp_f32 v84, v84
v_exp_f32 v85, v85
v_exp_f32 v86, v86
v_exp_f32 v87, v87
v_add_f32 v80, 1.0, v80
v_add_f32 v81, 1.0, v81
v_add_f32 v82, 1.0, v82
v_add_f32 v83, 1.0, v83
v_add_f32 v84, 1.0, v84
v_add_f32 v85, 1.0, v85
v_add_f32 v86, 1.0, v86
v_add_f32 v87, 1.0, v87
v_rcp_f32 v80, v80
v_rcp_f32 v81, v81
v_rcp_f32 v82, v82
v_rcp_f32 v83, v83
v_rcp_f32 v84, v84
v_rcp_f32 v85, v85
v_rcp_f32 v86, v86
v_rcp_f32 v87, v87
v_mul_f32 v48, v48, v80
v_mul_f32 v49, v49, v81
v_mul_f32 v50, v50, v82
v_mul_f32 v51, v51, v83
v_mul_f32 v52, v52, v84
v_mul_f32 v53, v53, v85
v_mul_f32 v54, v54, v86
v_mul_f32 v55, v55, v87
v_cvt_pk_bf16_f32 v64, v48, v49
v_cvt_pk_bf16_f32 v65, v50, v51
v_cvt_pk_bf16_f32 v66, v52, v53
v_cvt_pk_bf16_f32 v67, v54, v55
v_lshlrev_b32 v48, 16, v64
v_and_b32 v49, 0xffff0000, v64
v_lshlrev_b32 v80, 16, v40
v_and_b32 v81, 0xffff0000, v40
v_lshlrev_b32 v50, 16, v65
v_and_b32 v51, 0xffff0000, v65
v_lshlrev_b32 v82, 16, v41
v_and_b32 v83, 0xffff0000, v41
v_lshlrev_b32 v52, 16, v66
v_and_b32 v53, 0xffff0000, v66
v_lshlrev_b32 v84, 16, v42
v_and_b32 v85, 0xffff0000, v42
v_lshlrev_b32 v54, 16, v67
v_and_b32 v55, 0xffff0000, v67
v_lshlrev_b32 v86, 16, v43
v_and_b32 v87, 0xffff0000, v43
v_mul_f32 v48, v48, v80
v_mul_f32 v49, v49, v81
v_mul_f32 v50, v50, v82
v_mul_f32 v51, v51, v83
v_mul_f32 v52, v52, v84
v_mul_f32 v53, v53, v85
v_mul_f32 v54, v54, v86
v_mul_f32 v55, v55, v87
v_cvt_pk_bf16_f32 v64, v48, v49
v_cvt_pk_bf16_f32 v65, v50, v51
v_cvt_pk_bf16_f32 v66, v52, v53
v_cvt_pk_bf16_f32 v67, v54, v55
v_lshlrev_b32 v48, 16, v64
v_and_b32 v49, 0xffff0000, v64
v_lshlrev_b32 v80, 16, v22
v_and_b32 v81, 0xffff0000, v22
v_lshlrev_b32 v50, 16, v65
v_and_b32 v51, 0xffff0000, v65
v_lshlrev_b32 v82, 16, v23
v_and_b32 v83, 0xffff0000, v23
v_lshlrev_b32 v52, 16, v66
v_and_b32 v53, 0xffff0000, v66
v_lshlrev_b32 v84, 16, v24
v_and_b32 v85, 0xffff0000, v24
v_lshlrev_b32 v54, 16, v67
v_and_b32 v55, 0xffff0000, v67
v_lshlrev_b32 v86, 16, v25
v_and_b32 v87, 0xffff0000, v25
v_add_f32 v48, v48, v80
v_add_f32 v49, v49, v81
v_add_f32 v50, v50, v82
v_add_f32 v51, v51, v83
v_add_f32 v52, v52, v84
v_add_f32 v53, v53, v85
v_add_f32 v54, v54, v86
v_add_f32 v55, v55, v87
v_cvt_pk_bf16_f32 v96, v48, v49
v_cvt_pk_bf16_f32 v97, v50, v51
v_cvt_pk_bf16_f32 v98, v52, v53
v_cvt_pk_bf16_f32 v99, v54, v55
buffer_store_dwordx2 v[96:97], v20, s[24:27], s61 offen
buffer_store_dwordx2 v[98:99], v20, s[24:27], s61 offen offset:32
s_cmp_lg_u32 s29, 0
s_cbranch_scc1 LBw_147
ds_read_b64_tr_b16 v[44:45], v34 offset:4096
v_dot2_f32_bf16 v48, v168, s62, 0
v_dot2_f32_bf16 v49, v168, s63, 0
v_dot2_f32_bf16 v50, v169, s62, 0
v_dot2_f32_bf16 v51, v169, s63, 0
v_dot2_f32_bf16 v48, v170, s62, v48
v_dot2_f32_bf16 v49, v170, s63, v49
v_dot2_f32_bf16 v50, v171, s62, v50
v_dot2_f32_bf16 v51, v171, s63, v51
v_dot2_f32_bf16 v48, v172, s62, v48
v_dot2_f32_bf16 v49, v172, s63, v49
v_dot2_f32_bf16 v50, v173, s62, v50
v_dot2_f32_bf16 v51, v173, s63, v51
v_dot2_f32_bf16 v48, v174, s62, v48
v_dot2_f32_bf16 v49, v174, s63, v49
v_dot2_f32_bf16 v50, v175, s62, v50
v_dot2_f32_bf16 v51, v175, s63, v51
v_dot2_f32_bf16 v48, v176, s62, v48
v_dot2_f32_bf16 v49, v176, s63, v49
v_dot2_f32_bf16 v50, v177, s62, v50
v_dot2_f32_bf16 v51, v177, s63, v51
v_dot2_f32_bf16 v48, v178, s62, v48
v_dot2_f32_bf16 v49, v178, s63, v49
v_dot2_f32_bf16 v50, v179, s62, v50
v_dot2_f32_bf16 v51, v179, s63, v51
v_dot2_f32_bf16 v48, v180, s62, v48
v_dot2_f32_bf16 v49, v180, s63, v49
v_dot2_f32_bf16 v50, v181, s62, v50
v_dot2_f32_bf16 v51, v181, s63, v51
v_dot2_f32_bf16 v48, v182, s62, v48
v_dot2_f32_bf16 v49, v182, s63, v49
v_dot2_f32_bf16 v50, v183, s62, v50
v_dot2_f32_bf16 v51, v183, s63, v51
s_waitcnt lgkmcnt(0)
v_mul_f32 v48, s57, v48
v_mul_f32 v49, s57, v49
v_mul_f32 v50, s57, v50
v_mul_f32 v51, s57, v51
v_cvt_pk_bf16_f32 v64, v48, v49
v_cvt_pk_bf16_f32 v65, v50, v51
v_lshlrev_b32 v48, 16, v64
v_and_b32 v49, 0xffff0000, v64
v_lshlrev_b32 v50, 16, v65
v_and_b32 v51, 0xffff0000, v65
v_mul_f32 v80, s56, v48
v_mul_f32 v81, s56, v49
v_mul_f32 v82, s56, v50
v_mul_f32 v83, s56, v51
v_exp_f32 v80, v80
v_exp_f32 v81, v81
v_exp_f32 v82, v82
v_exp_f32 v83, v83
v_add_f32 v80, 1.0, v80
v_add_f32 v81, 1.0, v81
v_add_f32 v82, 1.0, v82
v_add_f32 v83, 1.0, v83
v_rcp_f32 v80, v80
v_rcp_f32 v81, v81
v_rcp_f32 v82, v82
v_rcp_f32 v83, v83
v_mul_f32 v48, v48, v80
v_mul_f32 v49, v49, v81
v_mul_f32 v50, v50, v82
v_mul_f32 v51, v51, v83
v_cvt_pk_bf16_f32 v64, v48, v49
v_cvt_pk_bf16_f32 v65, v50, v51
v_lshlrev_b32 v48, 16, v64
v_and_b32 v49, 0xffff0000, v64
v_lshlrev_b32 v80, 16, v44
v_and_b32 v81, 0xffff0000, v44
v_lshlrev_b32 v50, 16, v65
v_and_b32 v51, 0xffff0000, v65
v_lshlrev_b32 v82, 16, v45
v_and_b32 v83, 0xffff0000, v45
v_mul_f32 v48, v48, v80
v_mul_f32 v49, v49, v81
v_mul_f32 v50, v50, v82
v_mul_f32 v51, v51, v83
v_cvt_pk_bf16_f32 v64, v48, v49
v_cvt_pk_bf16_f32 v65, v50, v51
v_lshlrev_b32 v48, 16, v64
v_and_b32 v49, 0xffff0000, v64
v_lshlrev_b32 v80, 16, v26
v_and_b32 v81, 0xffff0000, v26
v_lshlrev_b32 v50, 16, v65
v_and_b32 v51, 0xffff0000, v65
v_lshlrev_b32 v82, 16, v27
v_and_b32 v83, 0xffff0000, v27
v_add_f32 v48, v48, v80
v_add_f32 v49, v49, v81
v_add_f32 v50, v50, v82
v_add_f32 v51, v51, v83
v_cvt_pk_bf16_f32 v100, v48, v49
v_cvt_pk_bf16_f32 v101, v50, v51
buffer_store_dwordx2 v[100:101], v20, s[24:27], 0 offen offset:256
LBw_147:
LB_end:
s_endpgm
.p2align 6
idx_table:
.short 1280, 1280, 1280, 1280, 1278, 1278, 1278, 1278, 1278, 1278, 1278, 0, 0, 0, 0, 0
.short 1278, 1278, 1278, 1276, 1276, 1276, 1276, 1276, 1276, 1276, 1276, 0, 0, 0, 0, 0
.short 1276, 1276, 1276, 1276, 1274, 1274, 1274, 1274, 1274, 1274, 1274, 0, 0, 0, 0, 0
.short 1274, 1274, 1274, 1272, 1272, 1272, 1272, 1272, 1272, 1272, 1272, 0, 0, 0, 0, 0
.short 1272, 1272, 1272, 1272, 1270, 1270, 1270, 1270, 1270, 1270, 1270, 0, 0, 0, 0, 0
.short 1270, 1270, 1270, 1268, 1268, 1268, 1268, 1268, 1268, 1268, 1268, 0, 0, 0, 0, 0
.short 1268, 1268, 1268, 1268, 1266, 1266, 1266, 1266, 1266, 1266, 1266, 0, 0, 0, 0, 0
.short 1266, 1266, 1266, 1264, 1264, 1264, 1264, 1264, 1264, 1264, 1264, 0, 0, 0, 0, 0
.short 1264, 1264, 1264, 1264, 1262, 1262, 1262, 1262, 1262, 1262, 1262, 0, 0, 0, 0, 0
.short 1262, 1262, 1262, 1260, 1260, 1260, 1260, 1260, 1260, 1260, 1260, 0, 0, 0, 0, 0
.short 1260, 1260, 1260, 1260, 1258, 1258, 1258, 1258, 1258, 1258, 1258, 0, 0, 0, 0, 0
.short 1258, 1258, 1258, 1256, 1256, 1256, 1256, 1256, 1256, 1256, 1256, 0, 0, 0, 0, 0
.short 1256, 1256, 1256, 1256, 1254, 1254, 1254, 1254, 1254, 1254, 1254, 0, 0, 0, 0, 0
.short 1254, 1254, 1254, 1252, 1252, 1252, 1252, 1252, 1252, 1252, 1252, 0, 0, 0, 0, 0
.short 1252, 1252, 1252, 1252, 1250, 1250, 1250, 1250, 1250, 1250, 1250, 0, 0, 0, 0, 0
.short 1250, 1250, 1250, 1248, 1248, 1248, 1248, 1248, 1248, 1248, 1248, 0, 0, 0, 0, 0
.short 1248, 1248, 1248, 1248, 1246, 1246, 1246, 1246, 1246, 1246, 1246, 0, 0, 0, 0, 0
.short 1246, 1246, 1246, 1244, 1244, 1244, 1244, 1244, 1244, 1244, 1244, 0, 0, 0, 0, 0
.short 1244, 1244, 1244, 1244, 1242, 1242, 1242, 1242, 1242, 1242, 1242, 0, 0, 0, 0, 0
.short 1242, 1242, 1242, 1240, 1240, 1240, 1240, 1240, 1240, 1240, 1240, 0, 0, 0, 0, 0
.short 1240, 1240, 1240, 1240, 1238, 1238, 1238, 1238, 1238, 1238, 1238, 0, 0, 0, 0, 0
.short 1238, 1238, 1238, 1236, 1236, 1236, 1236, 1236, 1236, 1236, 1236, 0, 0, 0, 0, 0
.short 1236, 1236, 1236, 1236, 1234, 1234, 1234, 1234, 1234, 1234, 1234, 0, 0, 0, 0, 0
.short 1234, 1234, 1234, 1232, 1232, 1232, 1232, 1232, 1232, 1232, 1232, 0, 0, 0, 0, 0
.short 1232, 1232, 1232, 1232, 1230, 1230, 1230, 1230, 1230, 1230, 1230, 0, 0, 0, 0, 0
.short 1230, 1230, 1230, 1228, 1228, 1228, 1228, 1228, 1228, 1228, 1228, 0, 0, 0, 0, 0
.short 1228, 1228, 1228, 1228, 1226, 1226, 1226, 1226, 1226, 1226, 1226, 0, 0, 0, 0, 0
.short 1226, 1226, 1226, 1224, 1224, 1224, 1224, 1224, 1224, 1224, 1224, 0, 0, 0, 0, 0
.short 1224, 1224, 1224, 1224, 1222, 1222, 1222, 1222, 1222, 1222, 1222, 0, 0, 0, 0, 0
.short 1222, 1222, 1222, 1220, 1220, 1220, 1220, 1220, 1220, 1220, 1220, 0, 0, 0, 0, 0
.short 1220, 1220, 1220, 1220, 1218, 1218, 1218, 1218, 1218, 1218, 1218, 0, 0, 0, 0, 0
.short 1218, 1218, 1218, 1216, 1216, 1216, 1216, 1216, 1216, 1216, 1216, 0, 0, 0, 0, 0
.short 1216, 1216, 1216, 1216, 1214, 1214, 1214, 1214, 1214, 1214, 1214, 0, 0, 0, 0, 0
.short 1214, 1214, 1214, 1212, 1212, 1212, 1212, 1212, 1212, 1212, 1212, 0, 0, 0, 0, 0
.short 1212, 1212, 1212, 1212, 1210, 1210, 1210, 1210, 1210, 1210, 1210, 0, 0, 0, 0, 0
.short 1210, 1210, 1210, 1208, 1208, 1208, 1208, 1208, 1208, 1208, 1208, 0, 0, 0, 0, 0
.short 1208, 1208, 1208, 1208, 1206, 1206, 1206, 1206, 1206, 1206, 1206, 0, 0, 0, 0, 0
.short 1206, 1206, 1206, 1204, 1204, 1204, 1204, 1204, 1204, 1204, 1204, 0, 0, 0, 0, 0
.short 1204, 1204, 1204, 1204, 1202, 1202, 1202, 1202, 1202, 1202, 1202, 0, 0, 0, 0, 0
.short 1202, 1202, 1202, 1200, 1200, 1200, 1200, 1200, 1200, 1200, 1200, 0, 0, 0, 0, 0
.short 1200, 1200, 1200, 1200, 1198, 1198, 1198, 1198, 1198, 1198, 1198, 0, 0, 0, 0, 0
.short 1198, 1198, 1198, 1196, 1196, 1196, 1196, 1196, 1196, 1196, 1196, 0, 0, 0, 0, 0
.short 1196, 1196, 1196, 1196, 1194, 1194, 1194, 1194, 1194, 1194, 1194, 0, 0, 0, 0, 0
.short 1194, 1194, 1194, 1192, 1192, 1192, 1192, 1192, 1192, 1192, 1192, 0, 0, 0, 0, 0
.short 1192, 1192, 1192, 1192, 1190, 1190, 1190, 1190, 1190, 1190, 1190, 0, 0, 0, 0, 0
.short 1190, 1190, 1190, 1188, 1188, 1188, 1188, 1188, 1188, 1188, 1188, 0, 0, 0, 0, 0
.short 1188, 1188, 1188, 1188, 1186, 1186, 1186, 1186, 1186, 1186, 1186, 0, 0, 0, 0, 0
.short 1186, 1186, 1186, 1184, 1184, 1184, 1184, 1184, 1184, 1184, 1184, 0, 0, 0, 0, 0
.short 1184, 1184, 1184, 1184, 1182, 1182, 1182, 1182, 1182, 1182, 1182, 0, 0, 0, 0, 0
.short 1182, 1182, 1182, 1180, 1180, 1180, 1180, 1180, 1180, 1180, 1180, 0, 0, 0, 0, 0
.short 1180, 1180, 1180, 1180, 1178, 1178, 1178, 1178, 1178, 1178, 1178, 0, 0, 0, 0, 0
.short 1178, 1178, 1178, 1176, 1176, 1176, 1176, 1176, 1176, 1176, 1176, 0, 0, 0, 0, 0
.short 1176, 1176, 1176, 1176, 1174, 1174, 1174, 1174, 1174, 1174, 1174, 0, 0, 0, 0, 0
.short 1174, 1174, 1174, 1172, 1172, 1172, 1172, 1172, 1172, 1172, 1172, 0, 0, 0, 0, 0
.short 1172, 1172, 1172, 1172, 1170, 1170, 1170, 1170, 1170, 1170, 1170, 0, 0, 0, 0, 0
.short 1170, 1170, 1170, 1168, 1168, 1168, 1168, 1168, 1168, 1168, 1168, 0, 0, 0, 0, 0
.short 1168, 1168, 1168, 1168, 1166, 1166, 1166, 1166, 1166, 1166, 1166, 0, 0, 0, 0, 0
.short 1166, 1166, 1166, 1164, 1164, 1164, 1164, 1164, 1164, 1164, 1164, 0, 0, 0, 0, 0
.short 1164, 1164, 1164, 1164, 1162, 1162, 1162, 1162, 1162, 1162, 1162, 0, 0, 0, 0, 0
.short 1162, 1162, 1162, 1160, 1160, 1160, 1160, 1160, 1160, 1160, 1160, 0, 0, 0, 0, 0
.short 1160, 1160, 1160, 1160, 1158, 1158, 1158, 1158, 1158, 1158, 1158, 0, 0, 0, 0, 0
.short 1158, 1158, 1158, 1156, 1156, 1156, 1156, 1156, 1156, 1156, 1156, 0, 0, 0, 0, 0
.short 1156, 1156, 1156, 1156, 1154, 1154, 1154, 1154, 1154, 1154, 1154, 0, 0, 0, 0, 0
.short 1154, 1154, 1154, 1152, 1152, 1152, 1152, 1152, 1152, 1152, 1152, 0, 0, 0, 0, 0
.short 1152, 1152, 1152, 1152, 1150, 1150, 1150, 1150, 1150, 1150, 1150, 0, 0, 0, 0, 0
.short 1150, 1150, 1150, 1148, 1148, 1148, 1148, 1148, 1148, 1148, 1148, 0, 0, 0, 0, 0
.short 1148, 1148, 1148, 1148, 1146, 1146, 1146, 1146, 1146, 1146, 1146, 0, 0, 0, 0, 0
.short 1146, 1146, 1146, 1144, 1144, 1144, 1144, 1144, 1144, 1144, 1144, 0, 0, 0, 0, 0
.short 1144, 1144, 1144, 1144, 1142, 1142, 1142, 1142, 1142, 1142, 1142, 0, 0, 0, 0, 0
.short 1142, 1142, 1142, 1140, 1140, 1140, 1140, 1140, 1140, 1140, 1140, 0, 0, 0, 0, 0
.short 1140, 1140, 1140, 1140, 1138, 1138, 1138, 1138, 1138, 1138, 1138, 0, 0, 0, 0, 0
.short 1138, 1138, 1138, 1136, 1136, 1136, 1136, 1136, 1136, 1136, 1136, 0, 0, 0, 0, 0
.short 1136, 1136, 1136, 1136, 1134, 1134, 1134, 1134, 1134, 1134, 1134, 0, 0, 0, 0, 0
.short 1134, 1134, 1134, 1132, 1132, 1132, 1132, 1132, 1132, 1132, 1132, 0, 0, 0, 0, 0
.short 1132, 1132, 1132, 1132, 1130, 1130, 1130, 1130, 1130, 1130, 1130, 0, 0, 0, 0, 0
.short 1130, 1130, 1130, 1128, 1128, 1128, 1128, 1128, 1128, 1128, 1128, 0, 0, 0, 0, 0
.short 1128, 1128, 1128, 1128, 1126, 1126, 1126, 1126, 1126, 1126, 1126, 0, 0, 0, 0, 0
.short 1126, 1126, 1126, 1124, 1124, 1124, 1124, 1124, 1124, 1124, 1124, 0, 0, 0, 0, 0
.short 1124, 1124, 1124, 1124, 1122, 1122, 1122, 1122, 1122, 1122, 1122, 0, 0, 0, 0, 0
.short 1122, 1122, 1122, 1120, 1120, 1120, 1120, 1120, 1120, 1120, 1120, 0, 0, 0, 0, 0
.short 1120, 1120, 1120, 1120, 1118, 1118, 1118, 1118, 1118, 1118, 1118, 0, 0, 0, 0, 0
.short 1118, 1118, 1118, 1116, 1116, 1116, 1116, 1116, 1116, 1116, 1116, 0, 0, 0, 0, 0
.short 1116, 1116, 1116, 1116, 1114, 1114, 1114, 1114, 1114, 1114, 1114, 0, 0, 0, 0, 0
.short 1114, 1114, 1114, 1112, 1112, 1112, 1112, 1112, 1112, 1112, 1112, 0, 0, 0, 0, 0
.short 1112, 1112, 1112, 1112, 1110, 1110, 1110, 1110, 1110, 1110, 1110, 0, 0, 0, 0, 0
.short 1110, 1110, 1110, 1108, 1108, 1108, 1108, 1108, 1108, 1108, 1108, 0, 0, 0, 0, 0
.short 1108, 1108, 1108, 1108, 1106, 1106, 1106, 1106, 1106, 1106, 1106, 0, 0, 0, 0, 0
.short 1106, 1106, 1106, 1104, 1104, 1104, 1104, 1104, 1104, 1104, 1104, 0, 0, 0, 0, 0
.short 1104, 1104, 1104, 1104, 1102, 1102, 1102, 1102, 1102, 1102, 1102, 0, 0, 0, 0, 0
.short 1102, 1102, 1102, 1100, 1100, 1100, 1100, 1100, 1100, 1100, 1100, 0, 0, 0, 0, 0
.short 1100, 1100, 1100, 1100, 1098, 1098, 1098, 1098, 1098, 1098, 1098, 0, 0, 0, 0, 0
.short 1098, 1098, 1098, 1096, 1096, 1096, 1096, 1096, 1096, 1096, 1096, 0, 0, 0, 0, 0
.short 1096, 1096, 1096, 1096, 1094, 1094, 1094, 1094, 1094, 1094, 1094, 0, 0, 0, 0, 0
.short 1094, 1094, 1094, 1092, 1092, 1092, 1092, 1092, 1092, 1092, 1092, 0, 0, 0, 0, 0
.short 1092, 1092, 1092, 1092, 1090, 1090, 1090, 1090, 1090, 1090, 1090, 0, 0, 0, 0, 0
.short 1090, 1090, 1090, 1088, 1088, 1088, 1088, 1088, 1088, 1088, 1088, 0, 0, 0, 0, 0
.short 1088, 1088, 1088, 1088, 1086, 1086, 1086, 1086, 1086, 1086, 1086, 0, 0, 0, 0, 0
.short 1086, 1086, 1086, 1084, 1084, 1084, 1084, 1084, 1084, 1084, 1084, 0, 0, 0, 0, 0
.short 1084, 1084, 1084, 1084, 1082, 1082, 1082, 1082, 1082, 1082, 1082, 0, 0, 0, 0, 0
.short 1082, 1082, 1082, 1080, 1080, 1080, 1080, 1080, 1080, 1080, 1080, 0, 0, 0, 0, 0
.short 1080, 1080, 1080, 1080, 1078, 1078, 1078, 1078, 1078, 1078, 1078, 0, 0, 0, 0, 0
.short 1078, 1078, 1078, 1076, 1076, 1076, 1076, 1076, 1076, 1076, 1076, 0, 0, 0, 0, 0
.short 1076, 1076, 1076, 1076, 1074, 1074, 1074, 1074, 1074, 1074, 1074, 0, 0, 0, 0, 0
.short 1074, 1074, 1074, 1072, 1072, 1072, 1072, 1072, 1072, 1072, 1072, 0, 0, 0, 0, 0
.short 1072, 1072, 1072, 1072, 1070, 1070, 1070, 1070, 1070, 1070, 1070, 0, 0, 0, 0, 0
.short 1070, 1070, 1070, 1068, 1068, 1068, 1068, 1068, 1068, 1068, 1068, 0, 0, 0, 0, 0
.short 1068, 1068, 1068, 1068, 1066, 1066, 1066, 1066, 1066, 1066, 1066, 0, 0, 0, 0, 0
.short 1066, 1066, 1066, 1064, 1064, 1064, 1064, 1064, 1064, 1064, 1064, 0, 0, 0, 0, 0
.short 1064, 1064, 1064, 1064, 1062, 1062, 1062, 1062, 1062, 1062, 1062, 0, 0, 0, 0, 0
.short 1062, 1062, 1062, 1060, 1060, 1060, 1060, 1060, 1060, 1060, 1060, 0, 0, 0, 0, 0
.short 1060, 1060, 1060, 1060, 1058, 1058, 1058, 1058, 1058, 1058, 1058, 0, 0, 0, 0, 0
.short 1058, 1058, 1058, 1056, 1056, 1056, 1056, 1056, 1056, 1056, 1056, 0, 0, 0, 0, 0
.short 1056, 1056, 1056, 1056, 1054, 1054, 1054, 1054, 1054, 1054, 1054, 0, 0, 0, 0, 0
.short 1054, 1054, 1054, 1052, 1052, 1052, 1052, 1052, 1052, 1052, 1052, 0, 0, 0, 0, 0
.short 1052, 1052, 1052, 1052, 1050, 1050, 1050, 1050, 1050, 1050, 1050, 0, 0, 0, 0, 0
.short 1050, 1050, 1050, 1048, 1048, 1048, 1048, 1048, 1048, 1048, 1048, 0, 0, 0, 0, 0
.short 1048, 1048, 1048, 1048, 1046, 1046, 1046, 1046, 1046, 1046, 1046, 0, 0, 0, 0, 0
.short 1046, 1046, 1046, 1044, 1044, 1044, 1044, 1044, 1044, 1044, 1044, 0, 0, 0, 0, 0
.short 1044, 1044, 1044, 1044, 1042, 1042, 1042, 1042, 1042, 1042, 1042, 0, 0, 0, 0, 0
.short 1042, 1042, 1042, 1040, 1040, 1040, 1040, 1040, 1040, 1040, 1040, 0, 0, 0, 0, 0
.short 1040, 1040, 1040, 1040, 1038, 1038, 1038, 1038, 1038, 1038, 1038, 0, 0, 0, 0, 0
.short 1038, 1038, 1038, 1036, 1036, 1036, 1036, 1036, 1036, 1036, 1036, 0, 0, 0, 0, 0
.short 1036, 1036, 1036, 1036, 1034, 1034, 1034, 1034, 1034, 1034, 1034, 0, 0, 0, 0, 0
.short 1034, 1034, 1034, 1032, 1032, 1032, 1032, 1032, 1032, 1032, 1032, 0, 0, 0, 0, 0
.short 1032, 1032, 1032, 1032, 1030, 1030, 1030, 1030, 1030, 1030, 1030, 0, 0, 0, 0, 0
.short 1030, 1030, 1030, 1028, 1028, 1028, 1028, 1028, 1028, 1028, 1028, 0, 0, 0, 0, 0
.short 1028, 1028, 1028, 1028, 1026, 1026, 1026, 1026, 1026, 1026, 1026, 0, 0, 0, 0, 0
.short 1026, 1026, 1026, 1024, 1024, 1024, 1024, 1024, 1024, 1024, 1022, 0, 0, 0, 0, 0
.short 1024, 1024, 1022, 1022, 1022, 958, 958, 958, 958, 958, 1020, 0, 0, 0, 0, 0
.short 958, 958, 1020, 1020, 1020, 956, 956, 956, 956, 956, 1018, 0, 0, 0, 0, 0
.short 956, 956, 1018, 1018, 1018, 954, 954, 954, 954, 954, 1016, 0, 0, 0, 0, 0
.short 954, 954, 1016, 1016, 1016, 952, 952, 952, 952, 952, 1014, 0, 0, 0, 0, 0
.short 952, 952, 1014, 1014, 1014, 950, 950, 950, 950, 950, 1012, 0, 0, 0, 0, 0
.short 950, 950, 1012, 1012, 1012, 948, 948, 948, 948, 948, 1010, 0, 0, 0, 0, 0
.short 948, 948, 1010, 1010, 1010, 946, 946, 946, 946, 946, 1008, 0, 0, 0, 0, 0
.short 946, 946, 1008, 1008, 1008, 944, 944, 944, 944, 944, 1006, 0, 0, 0, 0, 0
.short 944, 944, 1006, 1006, 1006, 942, 942, 942, 942, 942, 1004, 0, 0, 0, 0, 0
.short 942, 942, 1004, 1004, 1004, 940, 940, 940, 940, 940, 1002, 0, 0, 0, 0, 0
.short 940, 940, 1002, 1002, 1002, 938, 938, 938, 938, 938, 1000, 0, 0, 0, 0, 0
.short 938, 938, 1000, 1000, 1000, 936, 936, 936, 936, 936, 998, 0, 0, 0, 0, 0
.short 936, 936, 998, 998, 998, 934, 934, 934, 934, 934, 996, 0, 0, 0, 0, 0
.short 934, 934, 996, 996, 996, 932, 932, 932, 932, 932, 994, 0, 0, 0, 0, 0
.short 932, 932, 994, 994, 994, 930, 930, 930, 930, 930, 992, 0, 0, 0, 0, 0
.short 930, 930, 992, 992, 992, 928, 928, 928, 928, 928, 990, 0, 0, 0, 0, 0
.short 928, 928, 990, 990, 990, 926, 926, 926, 926, 926, 988, 0, 0, 0, 0, 0
.short 926, 926, 988, 988, 988, 924, 924, 924, 924, 924, 986, 0, 0, 0, 0, 0
.short 924, 924, 986, 986, 986, 922, 922, 922, 922, 922, 984, 0, 0, 0, 0, 0
.short 922, 922, 984, 984, 984, 920, 920, 920, 920, 920, 982, 0, 0, 0, 0, 0
.short 920, 920, 982, 982, 982, 918, 918, 918, 918, 918, 980, 0, 0, 0, 0, 0
.short 918, 918, 980, 980, 980, 916, 916, 916, 916, 916, 978, 0, 0, 0, 0, 0
.short 916, 916, 978, 978, 978, 914, 914, 914, 914, 914, 976, 0, 0, 0, 0, 0
.short 914, 914, 976, 976, 976, 912, 912, 912, 912, 912, 974, 0, 0, 0, 0, 0
.short 912, 912, 974, 974, 974, 910, 910, 910, 910, 910, 972, 0, 0, 0, 0, 0
.short 910, 910, 972, 972, 972, 908, 908, 908, 908, 908, 970, 0, 0, 0, 0, 0
.short 908, 908, 970, 970, 970, 906, 906, 906, 906, 906, 968, 0, 0, 0, 0, 0
.short 906, 906, 968, 968, 968, 904, 904, 904, 904, 904, 966, 0, 0, 0, 0, 0
.short 904, 904, 966, 966, 966, 902, 902, 902, 902, 902, 964, 0, 0, 0, 0, 0
.short 902, 902, 964, 964, 964, 900, 900, 900, 900, 900, 962, 0, 0, 0, 0, 0
.short 900, 900, 962, 962, 962, 898, 898, 898, 898, 898, 960, 0, 0, 0, 0, 0
.short 898, 898, 960, 960, 960, 896, 896, 896, 896, 896, 894, 0, 0, 0, 0, 0
.short 896, 896, 894, 894, 894, 830, 830, 830, 830, 830, 892, 0, 0, 0, 0, 0
.short 830, 830, 892, 892, 892, 828, 828, 828, 828, 828, 890, 0, 0, 0, 0, 0
.short 828, 828, 890, 890, 890, 826, 826, 826, 826, 826, 888, 0, 0, 0, 0, 0
.short 826, 826, 888, 888, 888, 824, 824, 824, 824, 824, 886, 0, 0, 0, 0, 0
.short 824, 824, 886, 886, 886, 822, 822, 822, 822, 822, 884, 0, 0, 0, 0, 0
.short 822, 822, 884, 884, 884, 820, 820, 820, 820, 820, 882, 0, 0, 0, 0, 0
.short 820, 820, 882, 882, 882, 818, 818, 818, 818, 818, 880, 0, 0, 0, 0, 0
.short 818, 818, 880, 880, 880, 816, 816, 816, 816, 816, 878, 0, 0, 0, 0, 0
.short 816, 816, 878, 878, 878, 814, 814, 814, 814, 814, 876, 0, 0, 0, 0, 0
.short 814, 814, 876, 876, 876, 812, 812, 812, 812, 812, 874, 0, 0, 0, 0, 0
.short 812, 812, 874, 874, 874, 810, 810, 810, 810, 810, 872, 0, 0, 0, 0, 0
.short 810, 810, 872, 872, 872, 808, 808, 808, 808, 808, 870, 0, 0, 0, 0, 0
.short 808, 808, 870, 870, 870, 806, 806, 806, 806, 806, 868, 0, 0, 0, 0, 0
.short 806, 806, 868, 868, 868, 804, 804, 804, 804, 804, 866, 0, 0, 0, 0, 0
.short 804, 804, 866, 866, 866, 802, 802, 802, 802, 802, 864, 0, 0, 0, 0, 0
.short 802, 802, 864, 864, 864, 800, 800, 800, 800, 800, 862, 0, 0, 0, 0, 0
.short 800, 800, 862, 862, 862, 798, 798, 798, 798, 798, 860, 0, 0, 0, 0, 0
.short 798, 798, 860, 860, 860, 796, 796, 796, 796, 796, 858, 0, 0, 0, 0, 0
.short 796, 796, 858, 858, 858, 794, 794, 794, 794, 794, 856, 0, 0, 0, 0, 0
.short 794, 794, 856, 856, 856, 792, 792, 792, 792, 792, 854, 0, 0, 0, 0, 0
.short 792, 792, 854, 854, 854, 790, 790, 790, 790, 790, 852, 0, 0, 0, 0, 0
.short 790, 790, 852, 852, 852, 788, 788, 788, 788, 788, 850, 0, 0, 0, 0, 0
.short 788, 788, 850, 850, 850, 786, 786, 786, 786, 786, 848, 0, 0, 0, 0, 0
.short 786, 786, 848, 848, 848, 784, 784, 784, 784, 784, 846, 0, 0, 0, 0, 0
.short 784, 784, 846, 846, 846, 782, 782, 782, 782, 782, 844, 0, 0, 0, 0, 0
.short 782, 782, 844, 844, 844, 780, 780, 780, 780, 780, 842, 0, 0, 0, 0, 0
.short 780, 780, 842, 842, 842, 778, 778, 778, 778, 778, 840, 0, 0, 0, 0, 0
.short 778, 778, 840, 840, 840, 776, 776, 776, 776, 776, 838, 0, 0, 0, 0, 0
.short 776, 776, 838, 838, 838, 774, 774, 774, 774, 774, 836, 0, 0, 0, 0, 0
.short 774, 774, 836, 836, 836, 772, 772, 772, 772, 772, 834, 0, 0, 0, 0, 0
.short 772, 772, 834, 834, 834, 770, 770, 770, 770, 770, 832, 0, 0, 0, 0, 0
.short 770, 770, 832, 832, 832, 768, 768, 768, 768, 766, 702, 0, 0, 0, 0, 0
.short 768, 766, 702, 702, 702, 638, 574, 574, 574, 764, 700, 0, 0, 0, 0, 0
.short 574, 764, 700, 700, 700, 636, 572, 572, 572, 762, 698, 0, 0, 0, 0, 0
.short 572, 762, 698, 698, 698, 634, 570, 570, 570, 760, 696, 0, 0, 0, 0, 0
.short 570, 760, 696, 696, 696, 632, 568, 568, 568, 758, 694, 0, 0, 0, 0, 0
.short 568, 758, 694, 694, 694, 630, 566, 566, 566, 756, 692, 0, 0, 0, 0, 0
.short 566, 756, 692, 692, 692, 628, 564, 564, 564, 754, 690, 0, 0, 0, 0, 0
.short 564, 754, 690, 690, 690, 626, 562, 562, 562, 752, 688, 0, 0, 0, 0, 0
.short 562, 752, 688, 688, 688, 624, 560, 560, 560, 750, 686, 0, 0, 0, 0, 0
.short 560, 750, 686, 686, 686, 622, 558, 558, 558, 748, 684, 0, 0, 0, 0, 0
.short 558, 748, 684, 684, 684, 620, 556, 556, 556, 746, 682, 0, 0, 0, 0, 0
.short 556, 746, 682, 682, 682, 618, 554, 554, 554, 744, 680, 0, 0, 0, 0, 0
.short 554, 744, 680, 680, 680, 616, 552, 552, 552, 742, 678, 0, 0, 0, 0, 0
.short 552, 742, 678, 678, 678, 614, 550, 550, 550, 740, 676, 0, 0, 0, 0, 0
.short 550, 740, 676, 676, 676, 612, 548, 548, 548, 738, 674, 0, 0, 0, 0, 0
.short 548, 738, 674, 674, 674, 610, 546, 546, 546, 736, 672, 0, 0, 0, 0, 0
.short 546, 736, 672, 672, 672, 608, 544, 544, 544, 734, 670, 0, 0, 0, 0, 0
.short 544, 734, 670, 670, 670, 606, 542, 542, 542, 732, 668, 0, 0, 0, 0, 0
.short 542, 732, 668, 668, 668, 604, 540, 540, 540, 730, 666, 0, 0, 0, 0, 0
.short 540, 730, 666, 666, 666, 602, 538, 538, 538, 728, 664, 0, 0, 0, 0, 0
.short 538, 728, 664, 664, 664, 600, 536, 536, 536, 726, 662, 0, 0, 0, 0, 0
.short 536, 726, 662, 662, 662, 598, 534, 534, 534, 724, 660, 0, 0, 0, 0, 0
.short 534, 724, 660, 660, 660, 596, 532, 532, 532, 722, 658, 0, 0, 0, 0, 0
.short 532, 722, 658, 658, 658, 594, 530, 530, 530, 720, 656, 0, 0, 0, 0, 0
.short 530, 720, 656, 656, 656, 592, 528, 528, 528, 718, 654, 0, 0, 0, 0, 0
.short 528, 718, 654, 654, 654, 590, 526, 526, 526, 716, 652, 0, 0, 0, 0, 0
.short 526, 716, 652, 652, 652, 588, 524, 524, 524, 714, 650, 0, 0, 0, 0, 0
.short 524, 714, 650, 650, 650, 586, 522, 522, 522, 712, 648, 0, 0, 0, 0, 0
.short 522, 712, 648, 648, 648, 584, 520, 520, 520, 710, 646, 0, 0, 0, 0, 0
.short 520, 710, 646, 646, 646, 582, 518, 518, 518, 708, 644, 0, 0, 0, 0, 0
.short 518, 708, 644, 644, 644, 580, 516, 516, 516, 706, 642, 0, 0, 0, 0, 0
.short 516, 706, 642, 642, 642, 578, 514, 514, 514, 704, 640, 0, 0, 0, 0, 0
.short 514, 704, 640, 640, 640, 576, 512, 512, 510, 446, 382, 0, 0, 0, 0, 0
.short 510, 446, 382, 318, 254, 190, 126, 62, 508, 444, 380, 0, 0, 0, 0, 0
.short 508, 444, 380, 316, 252, 188, 124, 60, 506, 442, 378, 0, 0, 0, 0, 0
.short 506, 442, 378, 314, 250, 186, 122, 58, 504, 440, 376, 0, 0, 0, 0, 0
.short 504, 440, 376, 312, 248, 184, 120, 56, 502, 438, 374, 0, 0, 0, 0, 0
.short 502, 438, 374, 310, 246, 182, 118, 54, 500, 436, 372, 0, 0, 0, 0, 0
.short 500, 436, 372, 308, 244, 180, 116, 52, 498, 434, 370, 0, 0, 0, 0, 0
.short 498, 434, 370, 306, 242, 178, 114, 50, 496, 432, 368, 0, 0, 0, 0, 0
.short 496, 432, 368, 304, 240, 176, 112, 48, 494, 430, 366, 0, 0, 0, 0, 0
.short 494, 430, 366, 302, 238, 174, 110, 46, 492, 428, 364, 0, 0, 0, 0, 0
.short 492, 428, 364, 300, 236, 172, 108, 44, 490, 426, 362, 0, 0, 0, 0, 0
.short 490, 426, 362, 298, 234, 170, 106, 42, 488, 424, 360, 0, 0, 0, 0, 0
.short 488, 424, 360, 296, 232, 168, 104, 40, 486, 422, 358, 0, 0, 0, 0, 0
.short 486, 422, 358, 294, 230, 166, 102, 38, 484, 420, 356, 0, 0, 0, 0, 0
.short 484, 420, 356, 292, 228, 164, 100, 36, 482, 418, 354, 0, 0, 0, 0, 0
.short 482, 418, 354, 290, 226, 162, 98, 34, 480, 416, 352, 0, 0, 0, 0, 0
.short 480, 416, 352, 288, 224, 160, 96, 32, 478, 414, 350, 0, 0, 0, 0, 0
.short 478, 414, 350, 286, 222, 158, 94, 30, 476, 412, 348, 0, 0, 0, 0, 0
.short 476, 412, 348, 284, 220, 156, 92, 28, 474, 410, 346, 0, 0, 0, 0, 0
.short 474, 410, 346, 282, 218, 154, 90, 26, 472, 408, 344, 0, 0, 0, 0, 0
.short 472, 408, 344, 280, 216, 152, 88, 24, 470, 406, 342, 0, 0, 0, 0, 0
.short 470, 406, 342, 278, 214, 150, 86, 22, 468, 404, 340, 0, 0, 0, 0, 0
.short 468, 404, 340, 276, 212, 148, 84, 20, 466, 402, 338, 0, 0, 0, 0, 0
.short 466, 402, 338, 274, 210, 146, 82, 18, 464, 400, 336, 0, 0, 0, 0, 0
.short 464, 400, 336, 272, 208, 144, 80, 16, 462, 398, 334, 0, 0, 0, 0, 0
.short 462, 398, 334, 270, 206, 142, 78, 14, 460, 396, 332, 0, 0, 0, 0, 0
.short 460, 396, 332, 268, 204, 140, 76, 12, 458, 394, 330, 0, 0, 0, 0, 0
.short 458, 394, 330, 266, 202, 138, 74, 10, 456, 392, 328, 0, 0, 0, 0, 0
.short 456, 392, 328, 264, 200, 136, 72, 8, 454, 390, 326, 0, 0, 0, 0, 0
.short 454, 390, 326, 262, 198, 134, 70, 6, 452, 388, 324, 0, 0, 0, 0, 0
.short 452, 388, 324, 260, 196, 132, 68, 4, 450, 386, 322, 0, 0, 0, 0, 0
.short 450, 386, 322, 258, 194, 130, 66, 2, 448, 384, 320, 0, 0, 0, 0, 0
.short 448, 384, 320, 256, 192, 128, 64, 0, 1344, 1344, 1344, 0, 0, 0, 0, 0
code_end:
.section .rodata,"a"
.p2align 6
.amdhsa_kernel recurrent_scan__ssm_conv_s4__dense_activation_silu__prompt_kernel
  .amdhsa_next_free_vgpr 256
  .amdhsa_next_free_sgpr 102
  .amdhsa_accum_offset 256
  .amdhsa_group_segment_fixed_size 0
  .amdhsa_kernarg_size 120
  .amdhsa_user_sgpr_count 2
  .amdhsa_user_sgpr_kernarg_segment_ptr 1
  .amdhsa_system_sgpr_workgroup_id_x 1
  .amdhsa_float_denorm_mode_32 3
.end_amdhsa_kernel
```
